```python
import torch

def _softmax(x, axis=-1):
    return torch.softmax(x, dim=axis)
def _gelu(x):
    return torch.nn.functional.gelu(x, approximate="tanh")
def _silu(x):
    return torch.nn.functional.silu(x)
def _sigmoid(x):
    return torch.sigmoid(x)
def _layernorm(x, axis=-1, eps=1e-5):
    m = x.mean(dim=axis, keepdim=True)
    v = x.var(dim=axis, keepdim=True, unbiased=False)
    return (x - m) / torch.sqrt(v + eps)
def _scatter_add(tgt, idx, src, axis=0):
    return tgt.clone().index_add_(axis, idx, src)
def _segment_sum(src, seg, n):
    out = torch.zeros((n,) + src.shape[1:], dtype=src.dtype)
    return out.index_add_(0, seg, src)
def _pad(x, pw):
    flat = tuple(v for pair in reversed(pw) for v in pair)
    return torch.nn.functional.pad(x, flat)

kernel_name = 'interleave_layers__spectral_fnet__dense_activation_relu__prompt'

def setup_inputs():

    _w = (lambda a: (lambda t: t.to(torch.bfloat16) if t.is_floating_point() else t)(torch.as_tensor(a)))
    def _A_setup():
        B, S, D = 1, 2048, 576
        ns = torch.arange(S)[:, None] * torch.arange(S)[None, :]
        nd = torch.arange(D)[:, None] * torch.arange(D)[None, :]
        Ws_re = torch.cos(-2.0 * torch.pi * ns / S).to(float)
        Ws_im = torch.sin(-2.0 * torch.pi * ns / S).to(float)
        Wd_re = torch.cos(-2.0 * torch.pi * nd / D).to(float)
        Wd_im = torch.sin(-2.0 * torch.pi * nd / D).to(float)
        return {
            "x": _w((lambda *s: torch.randn(*s, dtype=torch.bfloat16) * 0.05)(B, S, D)),
            "dft_seq_re": _w(Ws_re),
            "dft_seq_im": _w(Ws_im),
            "dft_hid_re": _w(Wd_re),
            "dft_hid_im": _w(Wd_im),
        }
    _A_in = _A_setup()

    def _B_setup():
        B, S, D, Dff = 1, 2048, 576, 4608
        return {
            "x": _w((lambda *s: torch.randn(*s, dtype=torch.bfloat16) * 0.05)(B, S, D)),
            "w1": _w((lambda *s: torch.randn(*s, dtype=torch.bfloat16) * 1.6)(D, Dff)),
            "w2": _w((lambda *s: torch.randn(*s, dtype=torch.bfloat16) * 1.6)(Dff, D)),
        }
    _B_in = _B_setup()

    return {
        "A_x": _A_in["x"],
        "A_dft_seq_re": _A_in["dft_seq_re"],
        "A_dft_seq_im": _A_in["dft_seq_im"],
        "A_dft_hid_re": _A_in["dft_hid_re"],
        "A_dft_hid_im": _A_in["dft_hid_im"],
        "B_x": _B_in["x"],
        "B_w1": _B_in["w1"],
        "B_w2": _B_in["w2"],
    }

def reference(A_x, A_dft_seq_re, A_dft_seq_im, A_dft_hid_re, A_dft_hid_im, B_x, B_w1, B_w2):
    def _A_ref(x, dft_seq_re, dft_seq_im, dft_hid_re, dft_hid_im):
        a = torch.einsum("bsd,ed->bse", x, dft_hid_re)
        b = torch.einsum("bsd,ed->bse", x, dft_hid_im)
        y = torch.einsum("ts,bse->bte", dft_seq_re, a) - torch.einsum("ts,bse->bte", dft_seq_im, b)
        return y

    def _B_ref(x, w1, w2):
        h = torch.einsum("bsd,df->bsf", x, w1)
        zero = torch.zeros_like(h)
        h = torch.maximum(h, zero)
        return torch.einsum("bsf,fd->bsd", h, w2)

    x = A_x
    x = x + _A_ref(_layernorm(x, axis=-1), A_dft_seq_re, A_dft_seq_im, A_dft_hid_re, A_dft_hid_im)
    x = x + _B_ref(_layernorm(x, axis=-1), B_w1, B_w2)
    x = x + _A_ref(_layernorm(x, axis=-1), A_dft_seq_re, A_dft_seq_im, A_dft_hid_re, A_dft_hid_im)
    x = x + _B_ref(_layernorm(x, axis=-1), B_w1, B_w2)
    return x
```

```asm
; @launch kernel=ka1_kernel grid=(256,1,1) block=(640,1,1) lds=82560
; @launch kernel=kf_kernel grid=(256,1,1) block=(256,1,1) lds=151552
; @launch kernel=ka2_kernel grid=(192,1,1) block=(384,1,1) lds=42112
; @launch kernel=kf_kernel grid=(256,1,1) block=(256,1,1) lds=151552
; @launch kernel=k7_kernel grid=(256,1,1) block=(576,1,1) lds=0
.amdgcn_target "amdgcn-amd-amdhsa--gfx950"
.text
.globl ka1_kernel
.p2align 8
.type ka1_kernel,@function
ka1_kernel:
    s_cmp_ge_u32 s2, 256
    s_cbranch_scc1 ka1_kernel_done
    s_load_dwordx2 s[4:5], s[0:1], 80
    s_load_dwordx2 s[52:53], s[0:1], 0
    s_load_dwordx4 s[60:63], s[0:1], 48
    v_lshrrev_b32 v2, 6, v0
    v_and_b32 v14, 63, v0
    v_readfirstlane_b32 s6, v2
    v_lshlrev_b32 v1, 4, v14
    v_and_b32 v12, 15, v14
    v_lshrrev_b32 v13, 4, v14
    s_cmp_lt_u32 s2, 192
    s_cselect_b32 s64, 6, 0
    s_cmp_lt_u32 s6, s64
    s_cbranch_scc1 ka1_kernel_ka
    s_lshl_b32 s64, s2, 2
    s_add_u32 s64, s64, s6
    s_sub_u32 s64, s64, 6
    s_mul_i32 s65, s2, 9
    s_add_u32 s65, s65, s6
    s_sub_u32 s65, s65, 963
    s_cmp_eq_u32 s6, 9
    s_cselect_b32 s65, 2000, s65
    s_cmp_ge_u32 s2, 192
    s_cselect_b32 s64, s65, s64
    s_cmp_ge_u32 s64, 1296
    s_cbranch_scc1 ka1_kernel_warm1
    v_lshrrev_b32 v9, 2, v12
    v_and_b32 v10, 3, v12
    s_cmp_ge_u32 s64, 648
    s_cbranch_scc1 ka1_kernel_w21
    s_mul_i32 s66, s64, 911
    s_lshr_b32 s66, s66, 15
    s_mul_i32 s71, s66, 36
    s_sub_u32 s65, s64, s71
    s_lshl_b32 s65, s65, 2
    v_add_u32 v2, s65, v9
    v_lshlrev_b32 v4, 6, v2
    v_lshl_add_u32 v8, v10, 4, v4
    s_lshl_b32 s65, s66, 5
    v_lshl_add_u32 v4, v13, 3, s65
    v_sub_u32 v5, 864, v4
    v_cmp_le_u32 vcc, 288, v4
    v_mov_b32 v6, 9216
    v_mov_b32 v7, -9216
    v_cndmask_b32 v5, v4, v5, vcc
    v_cndmask_b32 v7, v6, v7, vcc
    v_cmp_eq_u32 vcc, 288, v4
    v_mad_u32_u24 v97, v5, v6, v8
    v_mad_u32_u24 v4, v4, v6, v8
    v_cndmask_b32 v96, v97, v4, vcc
    s_mov_b64 s[68:69], 0
    s_waitcnt lgkmcnt(0)
    s_mov_b32 s24, s60
    s_and_b32 s25, s61, 0xffff
    s_branch ka1_kernel_ld2
ka1_kernel_w21:
    s_sub_u32 s65, s64, 648
    s_mul_i32 s7, s65, 405
    s_lshr_b32 s7, s7, 15
    s_mul_i32 s71, s7, 81
    s_sub_u32 s65, s65, s71
    s_mul_i32 s66, s65, 57
    s_lshr_b32 s66, s66, 9
    s_mul_i32 s71, s66, 9
    s_sub_u32 s67, s65, s71
    v_and_b32 v2, 1, v9
    s_lshl_b32 s67, s67, 1
    v_add_u32 v2, s67, v2
    v_lshrrev_b32 v3, 1, v9
    s_lshl_b32 s66, s66, 1
    v_add_u32 v3, s66, v3
    v_cmp_le_u32 vcc, 9, v2
    v_sub_u32 v4, 26, v2
    s_nop 0
    v_cndmask_b32 v2, v2, v4, vcc
    s_mul_i32 s65, s7, 576
    v_lshlrev_b32 v8, 5, v3
    v_lshl_add_u32 v8, v13, 3, v8
    v_add_u32 v8, s65, v8
    v_mul_u32_u24 v8, 1152, v8
    v_lshlrev_b32 v4, 6, v2
    v_lshl_add_u32 v4, v10, 4, v4
    v_sub_u32 v5, 1712, v4
    s_mov_b64 s[68:69], vcc
    v_cndmask_b32 v5, v4, v5, vcc
    v_add_u32 v96, v8, v5
    v_mov_b32 v97, v96
    v_mov_b32 v7, 1152
    s_waitcnt lgkmcnt(0)
    s_mov_b32 s24, s62
    s_and_b32 s25, s63, 0xffff
ka1_kernel_ld2:
    s_mov_b32 s26, 5308416
    s_mov_b32 s27, 0x20000
    s_barrier
    buffer_load_dwordx4 v[16:19], v96, s[24:27], 0 offen
    v_add_u32 v97, v97, v7
    buffer_load_dwordx4 v[20:23], v97, s[24:27], 0 offen
    v_add_u32 v98, v97, v7
    buffer_load_dwordx4 v[24:27], v98, s[24:27], 0 offen
    v_add_u32 v99, v98, v7
    buffer_load_dwordx4 v[28:31], v99, s[24:27], 0 offen
    v_add_u32 v100, v99, v7
    buffer_load_dwordx4 v[32:35], v100, s[24:27], 0 offen
    v_add_u32 v101, v100, v7
    buffer_load_dwordx4 v[36:39], v101, s[24:27], 0 offen
    v_add_u32 v102, v101, v7
    buffer_load_dwordx4 v[40:43], v102, s[24:27], 0 offen
    v_add_u32 v103, v102, v7
    buffer_load_dwordx4 v[44:47], v103, s[24:27], 0 offen
    s_cmp_eq_u64 s[68:69], 0
    s_cbranch_scc1 ka1_kernel_nx3
    v_cmp_eq_u32 vcc, 576, v4
    v_add_u32 v5, 16, v96
    v_add_u32 v6, 576, v8
    v_cndmask_b32 v5, v5, v6, vcc
    v_add_u32 v6, 3456, v5
    v_add_u32 v7, 6912, v5
    s_mov_b64 exec, s[68:69]
    buffer_load_dword v48, v5, s[24:27], 0 offen offset:0
    buffer_load_dword v49, v5, s[24:27], 0 offen offset:1152
    buffer_load_dword v50, v5, s[24:27], 0 offen offset:2304
    buffer_load_dword v51, v6, s[24:27], 0 offen offset:0
    buffer_load_dword v52, v6, s[24:27], 0 offen offset:1152
    buffer_load_dword v53, v6, s[24:27], 0 offen offset:2304
    buffer_load_dword v54, v7, s[24:27], 0 offen offset:0
    buffer_load_dword v55, v7, s[24:27], 0 offen offset:1152
    s_mov_b64 exec, -1
ka1_kernel_nx3:
    s_cmp_ge_u32 s64, 648
    s_cbranch_scc1 ka1_kernel_d24
    v_mul_u32_u24 v5, 57, v2
    v_lshrrev_b32 v5, 10, v5
    v_mul_u32_u24 v6, 18, v5
    v_sub_u32 v2, v2, v6
    v_mul_u32_u24 v5, 1296, v5
    v_mov_b32 v3, s66
    v_mov_b32 v4, s66
    s_branch ka1_kernel_do5
ka1_kernel_d24:
    s_mul_i32 s65, s7, 1296
    s_add_u32 s65, s65, 162
    v_mov_b32 v5, s65
    v_lshrrev_b32 v6, 2, v3
    v_sub_u32 v7, v3, v6
    v_add_u32 v6, 14, v6
    v_and_b32 v4, 3, v3
    v_cmp_eq_u32 vcc, 3, v4
    s_nop 1
    v_cndmask_b32 v4, v7, v6, vcc
ka1_kernel_do5:
    v_and_b32 v64, 3, v2
    v_lshrrev_b32 v65, 2, v2
    v_lshlrev_b32 v66, 2, v4
    v_lshl_add_u32 v66, v64, 1, v66
    v_mul_u32_u24 v67, 3, v3
    v_add_u32 v67, 72, v67
    v_lshlrev_b32 v68, 1, v3
    v_add_u32 v68, 126, v68
    v_cmp_eq_u32 vcc, 2, v64
    s_nop 1
    v_cndmask_b32 v66, v66, v67, vcc
    v_cmp_eq_u32 vcc, 3, v64
    s_nop 1
    v_cndmask_b32 v66, v66, v68, vcc
    v_add_u32 v67, 2, v67
    v_lshlrev_b32 v64, 1, v64
    v_cmp_le_u32 vcc, 16, v2
    s_nop 1
    v_cndmask_b32 v66, v66, v67, vcc
    v_cndmask_b32 v65, v65, v64, vcc
    v_mov_b32 v67, 1024
    v_mov_b32 v68, 331776
    v_cndmask_b32 v67, v67, v68, vcc
    v_mul_u32_u24 v65, 324, v65
    v_add3_u32 v66, v66, v65, v5
    v_lshlrev_b32 v15, 10, v66
    v_add_u32 v11, v15, v67
    s_mul_i32 s70, s6, 8256
    s_sub_u32 s66, s70, 7424
    s_cmp_ge_u32 s2, 192
    s_cselect_b32 s70, s70, s66
    v_mul_u32_u24 v8, 2064, v9
    v_lshl_add_u32 v8, v13, 8, v8
    v_lshl_add_u32 v8, v10, 6, v8
    v_add_u32 v8, s70, v8
    v_add_u32 v9, s70, v1
    v_readlane_b32 s40, v15, 0
    v_readlane_b32 s41, v11, 0
    v_readlane_b32 s42, v15, 4
    v_readlane_b32 s43, v11, 4
    v_readlane_b32 s44, v15, 8
    v_readlane_b32 s45, v11, 8
    v_readlane_b32 s46, v15, 12
    v_readlane_b32 s47, v11, 12
    s_add_u32 s20, s4, 0x0
    s_addc_u32 s21, s5, 0
    s_and_b32 s21, s21, 0xffff
    s_mov_b32 s22, 0xa20000
    s_mov_b32 s23, 0x20000
    s_mov_b32 s36, 0x05040100
    s_mov_b32 s37, 0x07060302
    s_barrier
    s_barrier
    s_waitcnt vmcnt(0)
    s_not_b64 exec, s[68:69]
    s_cbranch_execz ka1_kernel_up6
    v_perm_b32 v64, v20, v16, s36
    v_perm_b32 v65, v28, v24, s36
    v_perm_b32 v66, v36, v32, s36
    v_perm_b32 v67, v44, v40, s36
    ds_write_b128 v8, v[64:67] offset:0
    v_perm_b32 v68, v20, v16, s37
    v_perm_b32 v69, v28, v24, s37
    v_perm_b32 v70, v36, v32, s37
    v_perm_b32 v71, v44, v40, s37
    ds_write_b128 v8, v[68:71] offset:16
    v_perm_b32 v72, v21, v17, s36
    v_perm_b32 v73, v29, v25, s36
    v_perm_b32 v74, v37, v33, s36
    v_perm_b32 v75, v45, v41, s36
    ds_write_b128 v8, v[72:75] offset:32
    v_perm_b32 v76, v21, v17, s37
    v_perm_b32 v77, v29, v25, s37
    v_perm_b32 v78, v37, v33, s37
    v_perm_b32 v79, v45, v41, s37
    ds_write_b128 v8, v[76:79] offset:48
    v_perm_b32 v80, v22, v18, s36
    v_perm_b32 v81, v30, v26, s36
    v_perm_b32 v82, v38, v34, s36
    v_perm_b32 v83, v46, v42, s36
    ds_write_b128 v8, v[80:83] offset:1024
    v_perm_b32 v84, v22, v18, s37
    v_perm_b32 v85, v30, v26, s37
    v_perm_b32 v86, v38, v34, s37
    v_perm_b32 v87, v46, v42, s37
    ds_write_b128 v8, v[84:87] offset:1040
    v_perm_b32 v88, v23, v19, s36
    v_perm_b32 v89, v31, v27, s36
    v_perm_b32 v90, v39, v35, s36
    v_perm_b32 v91, v47, v43, s36
    ds_write_b128 v8, v[88:91] offset:1056
    v_perm_b32 v92, v23, v19, s37
    v_perm_b32 v93, v31, v27, s37
    v_perm_b32 v94, v39, v35, s37
    v_perm_b32 v95, v47, v43, s37
    ds_write_b128 v8, v[92:95] offset:1072
ka1_kernel_up6:
    s_mov_b64 exec, s[68:69]
    s_cbranch_execz ka1_kernel_st7
    s_waitcnt lgkmcnt(4)
    v_perm_b32 v64, v49, v48, s36
    v_perm_b32 v65, v51, v50, s36
    v_perm_b32 v66, v53, v52, s36
    v_perm_b32 v67, v55, v54, s36
    ds_write_b128 v8, v[64:67] offset:0
    v_perm_b32 v68, v23, v19, s37
    v_perm_b32 v69, v31, v27, s37
    v_perm_b32 v70, v39, v35, s37
    v_perm_b32 v71, v47, v43, s37
    ds_write_b128 v8, v[68:71] offset:16
    v_perm_b32 v72, v23, v19, s36
    v_perm_b32 v73, v31, v27, s36
    v_perm_b32 v74, v39, v35, s36
    v_perm_b32 v75, v47, v43, s36
    ds_write_b128 v8, v[72:75] offset:32
    v_perm_b32 v76, v22, v18, s37
    v_perm_b32 v77, v30, v26, s37
    v_perm_b32 v78, v38, v34, s37
    v_perm_b32 v79, v46, v42, s37
    ds_write_b128 v8, v[76:79] offset:48
    v_perm_b32 v80, v22, v18, s36
    v_perm_b32 v81, v30, v26, s36
    v_perm_b32 v82, v38, v34, s36
    v_perm_b32 v83, v46, v42, s36
    ds_write_b128 v8, v[80:83] offset:1024
    v_perm_b32 v84, v21, v17, s37
    v_perm_b32 v85, v29, v25, s37
    v_perm_b32 v86, v37, v33, s37
    v_perm_b32 v87, v45, v41, s37
    ds_write_b128 v8, v[84:87] offset:1040
    v_perm_b32 v88, v21, v17, s36
    v_perm_b32 v89, v29, v25, s36
    v_perm_b32 v90, v37, v33, s36
    v_perm_b32 v91, v45, v41, s36
    ds_write_b128 v8, v[88:91] offset:1056
    v_perm_b32 v92, v20, v16, s37
    v_perm_b32 v93, v28, v24, s37
    v_perm_b32 v94, v36, v32, s37
    v_perm_b32 v95, v44, v40, s37
    ds_write_b128 v8, v[92:95] offset:1072
ka1_kernel_st7:
    s_mov_b64 exec, -1
    s_waitcnt lgkmcnt(4)
    ds_read_b128 v[104:107], v9 offset:0
    ds_read_b128 v[108:111], v9 offset:1024
    ds_read_b128 v[112:115], v9 offset:2064
    ds_read_b128 v[116:119], v9 offset:3088
    ds_read_b128 v[120:123], v9 offset:4128
    ds_read_b128 v[124:127], v9 offset:5152
    ds_read_b128 v[128:131], v9 offset:6192
    ds_read_b128 v[132:135], v9 offset:7216
    s_waitcnt lgkmcnt(7)
    buffer_store_dwordx4 v[104:107], v1, s[20:23], s40 offen sc1
    s_waitcnt lgkmcnt(6)
    buffer_store_dwordx4 v[108:111], v1, s[20:23], s41 offen sc1
    s_waitcnt lgkmcnt(5)
    buffer_store_dwordx4 v[112:115], v1, s[20:23], s42 offen sc1
    s_waitcnt lgkmcnt(4)
    buffer_store_dwordx4 v[116:119], v1, s[20:23], s43 offen sc1
    s_waitcnt lgkmcnt(3)
    buffer_store_dwordx4 v[120:123], v1, s[20:23], s44 offen sc1
    s_waitcnt lgkmcnt(2)
    buffer_store_dwordx4 v[124:127], v1, s[20:23], s45 offen sc1
    s_waitcnt lgkmcnt(1)
    buffer_store_dwordx4 v[128:131], v1, s[20:23], s46 offen sc1
    s_waitcnt lgkmcnt(0)
    buffer_store_dwordx4 v[132:135], v1, s[20:23], s47 offen sc1
    s_lshr_b32 s64, s2, 3
    s_lshl_b32 s65, s64, 2
    s_sub_u32 s65, s65, 6
    s_mul_i32 s64, s64, 9
    s_sub_u32 s64, s64, 120
    s_cmp_lt_u32 s2, 192
    s_cselect_b32 s64, s65, s64
    s_add_u32 s64, s64, s6
    s_min_u32 s64, s64, 167
    s_lshl_b32 s64, s64, 2
    s_add_u32 s64, s64, 12
    s_mov_b64 exec, 0
    s_getpc_b64 s[66:67]
    s_add_u32 s66, s66, s64
    s_addc_u32 s67, s67, 0
    s_setpc_b64 s[66:67]
    s_branch pad0_0
    s_branch pad0_0
    s_branch pad0_1
    s_branch pad0_2
    s_branch pad0_3
    s_branch pad0_4
    s_branch pad0_5
    s_branch pad0_6
    s_branch pad0_7
    s_branch pad0_7
    s_branch pad0_8
    s_branch pad0_9
    s_branch pad0_10
    s_branch pad0_11
    s_branch pad0_12
    s_branch pad0_13
    s_branch pad0_14
    s_branch pad0_14
    s_branch pad0_15
    s_branch pad0_16
    s_branch pad0_17
    s_branch pad0_18
    s_branch pad0_19
    s_branch pad0_20
    s_branch pad0_21
    s_branch pad0_22
    s_branch pad0_22
    s_branch pad0_23
    s_branch pad0_24
    s_branch pad0_25
    s_branch pad0_26
    s_branch pad0_27
    s_branch pad0_28
    s_branch pad0_29
    s_branch pad0_29
    s_branch pad0_30
    s_branch pad0_31
    s_branch pad0_32
    s_branch pad0_33
    s_branch pad0_34
    s_branch pad0_35
    s_branch pad0_36
    s_branch pad0_37
    s_branch pad0_37
    s_branch pad0_38
    s_branch pad0_39
    s_branch pad0_40
    s_branch pad0_41
    s_branch pad0_42
    s_branch pad0_43
    s_branch pad0_44
    s_branch pad0_44
    s_branch pad0_45
    s_branch pad0_46
    s_branch pad0_47
    s_branch pad0_48
    s_branch pad0_49
    s_branch pad0_50
    s_branch pad0_51
    s_branch pad0_51
    s_branch pad0_52
    s_branch pad0_53
    s_branch pad0_54
    s_branch pad0_55
    s_branch pad0_56
    s_branch pad0_57
    s_branch pad0_58
    s_branch pad0_59
    s_branch pad0_59
    s_branch pad0_60
    s_branch pad0_61
    s_branch pad0_62
    s_branch pad0_63
    s_branch pad0_64
    s_branch pad0_65
    s_branch pad0_66
    s_branch pad0_66
    s_branch pad0_67
    s_branch pad0_68
    s_branch pad0_69
    s_branch pad0_70
    s_branch pad0_71
    s_branch pad0_72
    s_branch pad0_73
    s_branch pad0_74
    s_branch pad0_74
    s_branch pad0_75
    s_branch pad0_76
    s_branch pad0_77
    s_branch pad0_78
    s_branch pad0_79
    s_branch pad0_80
    s_branch pad0_81
    s_branch pad0_81
    s_branch pad0_82
    s_branch pad0_83
    s_branch pad0_84
    s_branch pad0_85
    s_branch pad0_86
    s_branch pad0_87
    s_branch pad0_88
    s_branch pad0_88
    s_branch pad0_89
    s_branch pad0_90
    s_branch pad0_91
    s_branch pad0_92
    s_branch pad0_93
    s_branch pad0_94
    s_branch pad0_95
    s_branch pad0_96
    s_branch pad0_96
    s_branch pad0_97
    s_branch pad0_98
    s_branch pad0_99
    s_branch pad0_100
    s_branch pad0_101
    s_branch pad0_102
    s_branch pad0_103
    s_branch pad0_103
    s_branch pad0_104
    s_branch pad0_105
    s_branch pad0_106
    s_branch pad0_107
    s_branch pad0_108
    s_branch pad0_109
    s_branch pad0_110
    s_branch pad0_111
    s_branch pad0_111
    s_branch pad0_112
    s_branch pad0_113
    s_branch pad0_114
    s_branch pad0_115
    s_branch pad0_116
    s_branch pad0_117
    s_branch pad0_118
    s_branch pad0_118
    s_branch pad0_119
    s_branch pad0_120
    s_branch pad0_121
    s_branch pad0_122
    s_branch pad0_123
    s_branch pad0_124
    s_branch pad0_125
    s_branch pad0_125
    s_branch pad0_126
    s_branch pad0_127
    s_branch pad0_128
    s_branch pad0_129
    s_branch pad0_130
    s_branch pad0_131
    s_branch pad0_132
    s_branch pad0_133
    s_branch pad0_133
    s_branch pad0_134
    s_branch pad0_135
    s_branch pad0_136
    s_branch pad0_137
    s_branch pad0_138
    s_branch pad0_139
    s_branch pad0_140
    s_branch pad0_140
    s_branch pad0_141
    s_branch pad0_142
    s_branch pad0_143
    s_branch pad0_144
    s_branch pad0_145
    s_branch pad0_146
    s_branch pad0_147
ka1_kernel_warm1:
    s_mul_i32 s64, s2, 10
    s_add_u32 s64, s64, s6
    s_and_b32 s64, s64, 127
    s_lshl_b32 s64, s64, 2
    s_add_u32 s64, s64, 12
    s_mov_b64 exec, 0
    s_getpc_b64 s[66:67]
    s_add_u32 s66, s66, s64
    s_addc_u32 s67, s67, 0
    s_setpc_b64 s[66:67]
    s_branch pad1_0
    s_branch pad1_0
    s_branch pad1_0
    s_branch pad1_0
    s_branch pad1_0
    s_branch pad1_1
    s_branch pad1_1
    s_branch pad1_1
    s_branch pad1_1
    s_branch pad1_2
    s_branch pad1_2
    s_branch pad1_2
    s_branch pad1_2
    s_branch pad1_3
    s_branch pad1_3
    s_branch pad1_3
    s_branch pad1_3
    s_branch pad1_3
    s_branch pad1_4
    s_branch pad1_4
    s_branch pad1_4
    s_branch pad1_4
    s_branch pad1_5
    s_branch pad1_5
    s_branch pad1_5
    s_branch pad1_5
    s_branch pad1_6
    s_branch pad1_6
    s_branch pad1_6
    s_branch pad1_6
    s_branch pad1_7
    s_branch pad1_7
    s_branch pad1_7
    s_branch pad1_7
    s_branch pad1_7
    s_branch pad1_8
    s_branch pad1_8
    s_branch pad1_8
    s_branch pad1_8
    s_branch pad1_9
    s_branch pad1_9
    s_branch pad1_9
    s_branch pad1_9
    s_branch pad1_10
    s_branch pad1_10
    s_branch pad1_10
    s_branch pad1_10
    s_branch pad1_11
    s_branch pad1_11
    s_branch pad1_11
    s_branch pad1_11
    s_branch pad1_11
    s_branch pad1_12
    s_branch pad1_12
    s_branch pad1_12
    s_branch pad1_12
    s_branch pad1_13
    s_branch pad1_13
    s_branch pad1_13
    s_branch pad1_13
    s_branch pad1_14
    s_branch pad1_14
    s_branch pad1_14
    s_branch pad1_14
    s_branch pad1_15
    s_branch pad1_15
    s_branch pad1_15
    s_branch pad1_15
    s_branch pad1_15
    s_branch pad1_16
    s_branch pad1_16
    s_branch pad1_16
    s_branch pad1_16
    s_branch pad1_17
    s_branch pad1_17
    s_branch pad1_17
    s_branch pad1_17
    s_branch pad1_18
    s_branch pad1_18
    s_branch pad1_18
    s_branch pad1_18
    s_branch pad1_18
    s_branch pad1_19
    s_branch pad1_19
    s_branch pad1_19
    s_branch pad1_19
    s_branch pad1_20
    s_branch pad1_20
    s_branch pad1_20
    s_branch pad1_20
    s_branch pad1_21
    s_branch pad1_21
    s_branch pad1_21
    s_branch pad1_21
    s_branch pad1_22
    s_branch pad1_22
    s_branch pad1_22
    s_branch pad1_22
    s_branch pad1_22
    s_branch pad1_23
    s_branch pad1_23
    s_branch pad1_23
    s_branch pad1_23
    s_branch pad1_24
    s_branch pad1_24
    s_branch pad1_24
    s_branch pad1_24
    s_branch pad1_25
    s_branch pad1_25
    s_branch pad1_25
    s_branch pad1_25
    s_branch pad1_26
    s_branch pad1_26
    s_branch pad1_26
    s_branch pad1_26
    s_branch pad1_26
    s_branch pad1_27
    s_branch pad1_27
    s_branch pad1_27
    s_branch pad1_27
    s_branch pad1_28
    s_branch pad1_28
    s_branch pad1_28
    s_branch pad1_28
    s_branch pad1_29
    s_branch pad1_29
    s_branch pad1_29
    s_branch pad1_29
ka1_kernel_ka:
pad1_0:
    s_cbranch_execz ka1_kernel_done
    s_and_b32 s7, s2, 7
    s_lshr_b32 s8, s2, 3
    s_and_b32 s9, s8, 7
    s_lshl_b32 s10, s7, 3
    s_add_u32 s9, s9, s10
    s_lshr_b32 s10, s8, 3
    s_and_b32 s11, s6, 1
    s_lshr_b32 s32, s6, 1
    s_and_b32 s33, s9, 31
    s_lshr_b32 s34, s9, 5
    s_lshl_b32 s34, s34, 1
    s_add_u32 s34, s34, s11
    s_mul_i32 s35, s33, 73728
    s_mul_i32 s36, s32, 12288
    s_add_u32 s35, s35, s36
    s_lshl_b32 s36, s34, 10
    s_add_u32 s35, s35, s36
    s_add_u32 s36, s35, 0
    v_add_u32 v2, s36, v1
    v_add_u32 v5, 36864, v2
    s_add_u32 s36, s35, 4096
    v_add_u32 v3, s36, v1
    v_add_u32 v6, 36864, v3
    s_add_u32 s36, s35, 8192
    v_add_u32 v4, s36, v1
    v_add_u32 v7, 36864, v4
    s_lshl_b32 s36, s11, 4
    v_add_u32 v8, s36, v12
    v_lshl_add_u32 v8, v8, 6, s9
    v_mul_u32_u24 v8, 1152, v8
    s_mul_i32 s36, s32, 192
    v_lshl_add_u32 v9, v13, 4, s36
    v_add_u32 v10, v8, v9
    v_sub_u32 v11, v8, v9
    v_add_u32 v11, 1008, v11
    v_cmp_eq_u32 vcc, 0, v9
    v_add_u32 v9, 144, v11
    v_add_u32 v15, 576, v8
pad1_1:
    s_cbranch_execz ka1_kernel_done
    v_cndmask_b32 v9, v9, v15, vcc
    s_waitcnt lgkmcnt(0)
    s_add_u32 s20, s52, 0x0
    s_addc_u32 s21, s53, 0
    s_and_b32 s21, s21, 0xffff
    s_mov_b32 s22, 0x240000
    s_mov_b32 s23, 0x20000
    buffer_load_dwordx4 v[136:139], v10, s[20:23], 0 offen offset:0
    buffer_load_dwordx4 v[140:143], v11, s[20:23], 0 offen offset:128
    buffer_load_dwordx4 v[144:147], v10, s[20:23], 0 offen offset:64
    buffer_load_dwordx4 v[148:151], v11, s[20:23], 0 offen offset:64
    buffer_load_dwordx4 v[152:155], v10, s[20:23], 0 offen offset:128
    buffer_load_dwordx4 v[156:159], v11, s[20:23], 0 offen offset:0
    buffer_load_dword v160, v9, s[20:23], 0 offen
    buffer_load_dword v161, v11, s[20:23], 0 offen offset:80
    buffer_load_dword v162, v11, s[20:23], 0 offen offset:16
    s_barrier
    s_lshl_b32 s36, s11, 4
    v_add_u32 v24, s36, v12
    s_and_b32 s36, s32, 1
    s_mul_i32 s36, s36, 0xbe800000
    v_lshlrev_b32 v25, 2, v13
    s_mov_b32 s37, 0x3d000000
    v_add_u32 v16, 0, v25
    v_add_u32 v17, 1, v25
    v_add_u32 v18, 2, v25
    v_add_u32 v19, 3, v25
    v_add_u32 v20, 16, v25
    v_add_u32 v21, 17, v25
    v_add_u32 v22, 18, v25
    v_add_u32 v23, 19, v25
    v_mul_u32_u24 v16, v16, v24
    v_mul_u32_u24 v17, v17, v24
    v_mul_u32_u24 v18, v18, v24
    v_mul_u32_u24 v19, v19, v24
    v_mul_u32_u24 v20, v20, v24
    v_mul_u32_u24 v21, v21, v24
    v_mul_u32_u24 v22, v22, v24
    v_mul_u32_u24 v23, v23, v24
    v_cvt_f32_u32 v16, v16
    v_cvt_f32_u32 v17, v17
    v_cvt_f32_u32 v18, v18
    v_cvt_f32_u32 v19, v19
    v_cvt_f32_u32 v20, v20
    v_cvt_f32_u32 v21, v21
    v_cvt_f32_u32 v22, v22
    v_cvt_f32_u32 v23, v23
    v_mov_b32 v25, s36
    v_fma_f32 v16, s37, v16, v25
pad1_2:
    s_cbranch_execz ka1_kernel_done
    v_fma_f32 v17, s37, v17, v25
    v_fma_f32 v18, s37, v18, v25
    v_fma_f32 v19, s37, v19, v25
    v_fma_f32 v20, s37, v20, v25
    v_fma_f32 v21, s37, v21, v25
    v_fma_f32 v22, s37, v22, v25
    v_fma_f32 v23, s37, v23, v25
    v_cos_f32 v16, v16
    v_cos_f32 v17, v17
    v_cos_f32 v18, v18
    v_cos_f32 v19, v19
    v_cos_f32 v20, v20
    v_cos_f32 v21, v21
    v_cos_f32 v22, v22
    v_cos_f32 v23, v23
    v_cvt_pk_bf16_f32 v28, v16, v17
    v_cvt_pk_bf16_f32 v29, v18, v19
    v_cvt_pk_bf16_f32 v30, v20, v21
    v_cvt_pk_bf16_f32 v31, v22, v23
    s_and_b32 s36, s6, 3
    s_lshl_b32 s36, s36, 10
    v_add_u32 v24, s36, v1
    ds_write_b128 v24, v[28:31] offset:36864
    s_mul_i32 s36, s10, 3
    s_add_u32 s36, s36, s32
    s_lshl_b32 s36, s36, 5
    s_lshl_b32 s37, s11, 2
    s_add_u32 s36, s36, s37
    v_lshrrev_b32 v32, 2, v12
    v_lshlrev_b32 v32, 3, v32
    v_and_b32 v33, 3, v12
    v_add3_u32 v32, v32, v33, s36
    v_cvt_f32_u32 v32, v32
    v_mul_f32 v32, 0xbae38e39, v32
    v_lshlrev_b32 v33, 3, v13
    v_cvt_f32_u32 v33, v33
    v_mul_f32 v33, v32, v33
    v_mov_b32 v34, v33
    v_fmamk_f32 v35, v32, 0x3f800000, v33
    v_fmamk_f32 v36, v32, 0x40000000, v33
    v_fmamk_f32 v37, v32, 0x40400000, v33
    v_cos_f32 v38, v34
    v_sin_f32 v42, v34
    v_cos_f32 v39, v35
    v_sin_f32 v43, v35
pad1_3:
    s_cbranch_execz ka1_kernel_done
    v_cos_f32 v40, v36
    v_sin_f32 v44, v36
    v_cos_f32 v41, v37
    v_sin_f32 v45, v37
    v_cvt_pk_bf16_f32 v64, v38, v39
    v_cvt_pk_bf16_f32 v65, v40, v41
    v_cvt_pk_bf16_f32 v100, v42, v43
    v_cvt_pk_bf16_f32 v101, v44, v45
    v_fmamk_f32 v34, v32, 0x40800000, v33
    v_fmamk_f32 v35, v32, 0x40a00000, v33
    v_fmamk_f32 v36, v32, 0x40c00000, v33
    v_fmamk_f32 v37, v32, 0x40e00000, v33
    v_cos_f32 v38, v34
    v_sin_f32 v42, v34
    v_cos_f32 v39, v35
    v_sin_f32 v43, v35
    v_cos_f32 v40, v36
    v_sin_f32 v44, v36
    v_cos_f32 v41, v37
    v_sin_f32 v45, v37
    v_cvt_pk_bf16_f32 v66, v38, v39
    v_cvt_pk_bf16_f32 v67, v40, v41
    v_cvt_pk_bf16_f32 v102, v42, v43
    v_cvt_pk_bf16_f32 v103, v44, v45
    v_fmamk_f32 v34, v32, 0x42000000, v33
    v_fmamk_f32 v35, v32, 0x42040000, v33
    v_fmamk_f32 v36, v32, 0x42080000, v33
    v_fmamk_f32 v37, v32, 0x420c0000, v33
    v_cos_f32 v38, v34
    v_sin_f32 v42, v34
    v_cos_f32 v39, v35
    v_sin_f32 v43, v35
    v_cos_f32 v40, v36
    v_sin_f32 v44, v36
    v_cos_f32 v41, v37
    v_sin_f32 v45, v37
    v_cvt_pk_bf16_f32 v68, v38, v39
    v_cvt_pk_bf16_f32 v69, v40, v41
    v_cvt_pk_bf16_f32 v104, v42, v43
    v_cvt_pk_bf16_f32 v105, v44, v45
    v_fmamk_f32 v34, v32, 0x42100000, v33
    v_fmamk_f32 v35, v32, 0x42140000, v33
pad1_4:
    s_cbranch_execz ka1_kernel_done
    v_fmamk_f32 v36, v32, 0x42180000, v33
    v_fmamk_f32 v37, v32, 0x421c0000, v33
    v_cos_f32 v38, v34
    v_sin_f32 v42, v34
    v_cos_f32 v39, v35
    v_sin_f32 v43, v35
    v_cos_f32 v40, v36
    v_sin_f32 v44, v36
    v_cos_f32 v41, v37
    v_sin_f32 v45, v37
    v_cvt_pk_bf16_f32 v70, v38, v39
    v_cvt_pk_bf16_f32 v71, v40, v41
    v_cvt_pk_bf16_f32 v106, v42, v43
    v_cvt_pk_bf16_f32 v107, v44, v45
    v_fmamk_f32 v34, v32, 0x42800000, v33
    v_fmamk_f32 v35, v32, 0x42820000, v33
    v_fmamk_f32 v36, v32, 0x42840000, v33
    v_fmamk_f32 v37, v32, 0x42860000, v33
    v_cos_f32 v38, v34
    v_sin_f32 v42, v34
    v_cos_f32 v39, v35
    v_sin_f32 v43, v35
    v_cos_f32 v40, v36
    v_sin_f32 v44, v36
    v_cos_f32 v41, v37
    v_sin_f32 v45, v37
    v_cvt_pk_bf16_f32 v72, v38, v39
    v_cvt_pk_bf16_f32 v73, v40, v41
    v_cvt_pk_bf16_f32 v108, v42, v43
    v_cvt_pk_bf16_f32 v109, v44, v45
    v_fmamk_f32 v34, v32, 0x42880000, v33
    v_fmamk_f32 v35, v32, 0x428a0000, v33
    v_fmamk_f32 v36, v32, 0x428c0000, v33
    v_fmamk_f32 v37, v32, 0x428e0000, v33
    v_cos_f32 v38, v34
    v_sin_f32 v42, v34
    v_cos_f32 v39, v35
    v_sin_f32 v43, v35
    v_cos_f32 v40, v36
    v_sin_f32 v44, v36
    v_cos_f32 v41, v37
    v_sin_f32 v45, v37
    v_cvt_pk_bf16_f32 v74, v38, v39
pad1_5:
    s_cbranch_execz ka1_kernel_done
    v_cvt_pk_bf16_f32 v75, v40, v41
    v_cvt_pk_bf16_f32 v110, v42, v43
    v_cvt_pk_bf16_f32 v111, v44, v45
    v_fmamk_f32 v34, v32, 0x42c00000, v33
    v_fmamk_f32 v35, v32, 0x42c20000, v33
    v_fmamk_f32 v36, v32, 0x42c40000, v33
    v_fmamk_f32 v37, v32, 0x42c60000, v33
    v_cos_f32 v38, v34
    v_sin_f32 v42, v34
    v_cos_f32 v39, v35
    v_sin_f32 v43, v35
    v_cos_f32 v40, v36
    v_sin_f32 v44, v36
    v_cos_f32 v41, v37
    v_sin_f32 v45, v37
    v_cvt_pk_bf16_f32 v76, v38, v39
    v_cvt_pk_bf16_f32 v77, v40, v41
    v_cvt_pk_bf16_f32 v112, v42, v43
    v_cvt_pk_bf16_f32 v113, v44, v45
    v_fmamk_f32 v34, v32, 0x42c80000, v33
    v_fmamk_f32 v35, v32, 0x42ca0000, v33
    v_fmamk_f32 v36, v32, 0x42cc0000, v33
    v_fmamk_f32 v37, v32, 0x42ce0000, v33
    v_cos_f32 v38, v34
    v_sin_f32 v42, v34
    v_cos_f32 v39, v35
    v_sin_f32 v43, v35
    v_cos_f32 v40, v36
    v_sin_f32 v44, v36
    v_cos_f32 v41, v37
    v_sin_f32 v45, v37
    v_cvt_pk_bf16_f32 v78, v38, v39
    v_cvt_pk_bf16_f32 v79, v40, v41
    v_cvt_pk_bf16_f32 v114, v42, v43
    v_cvt_pk_bf16_f32 v115, v44, v45
    v_fmamk_f32 v34, v32, 0x43000000, v33
    v_fmamk_f32 v35, v32, 0x43010000, v33
    v_fmamk_f32 v36, v32, 0x43020000, v33
    v_fmamk_f32 v37, v32, 0x43030000, v33
    v_cos_f32 v38, v34
pad1_6:
    s_cbranch_execz ka1_kernel_done
    v_sin_f32 v42, v34
    v_cos_f32 v39, v35
    v_sin_f32 v43, v35
    v_cos_f32 v40, v36
    v_sin_f32 v44, v36
    v_cos_f32 v41, v37
    v_sin_f32 v45, v37
    v_cvt_pk_bf16_f32 v80, v38, v39
    v_cvt_pk_bf16_f32 v81, v40, v41
    v_cvt_pk_bf16_f32 v116, v42, v43
    v_cvt_pk_bf16_f32 v117, v44, v45
    v_fmamk_f32 v34, v32, 0x43040000, v33
    v_fmamk_f32 v35, v32, 0x43050000, v33
    v_fmamk_f32 v36, v32, 0x43060000, v33
    v_fmamk_f32 v37, v32, 0x43070000, v33
    v_cos_f32 v38, v34
    v_sin_f32 v42, v34
    v_cos_f32 v39, v35
    v_sin_f32 v43, v35
    v_cos_f32 v40, v36
    v_sin_f32 v44, v36
    v_cos_f32 v41, v37
    v_sin_f32 v45, v37
    v_cvt_pk_bf16_f32 v82, v38, v39
    v_cvt_pk_bf16_f32 v83, v40, v41
    v_cvt_pk_bf16_f32 v118, v42, v43
    v_cvt_pk_bf16_f32 v119, v44, v45
    v_fmamk_f32 v34, v32, 0x43200000, v33
    v_fmamk_f32 v35, v32, 0x43210000, v33
    v_fmamk_f32 v36, v32, 0x43220000, v33
    v_fmamk_f32 v37, v32, 0x43230000, v33
    v_cos_f32 v38, v34
    v_sin_f32 v42, v34
    v_cos_f32 v39, v35
    v_sin_f32 v43, v35
    v_cos_f32 v40, v36
    v_sin_f32 v44, v36
    v_cos_f32 v41, v37
    v_sin_f32 v45, v37
    v_cvt_pk_bf16_f32 v84, v38, v39
    v_cvt_pk_bf16_f32 v85, v40, v41
    v_cvt_pk_bf16_f32 v120, v42, v43
    v_cvt_pk_bf16_f32 v121, v44, v45
pad1_7:
    s_cbranch_execz ka1_kernel_done
    v_fmamk_f32 v34, v32, 0x43240000, v33
    v_fmamk_f32 v35, v32, 0x43250000, v33
    v_fmamk_f32 v36, v32, 0x43260000, v33
    v_fmamk_f32 v37, v32, 0x43270000, v33
    v_cos_f32 v38, v34
    v_sin_f32 v42, v34
    v_cos_f32 v39, v35
    v_sin_f32 v43, v35
    v_cos_f32 v40, v36
    v_sin_f32 v44, v36
    v_cos_f32 v41, v37
    v_sin_f32 v45, v37
    v_cvt_pk_bf16_f32 v86, v38, v39
    v_cvt_pk_bf16_f32 v87, v40, v41
    v_cvt_pk_bf16_f32 v122, v42, v43
    v_cvt_pk_bf16_f32 v123, v44, v45
    v_fmamk_f32 v34, v32, 0x43400000, v33
    v_fmamk_f32 v35, v32, 0x43410000, v33
    v_fmamk_f32 v36, v32, 0x43420000, v33
    v_fmamk_f32 v37, v32, 0x43430000, v33
    v_cos_f32 v38, v34
    v_sin_f32 v42, v34
    v_cos_f32 v39, v35
    v_sin_f32 v43, v35
    v_cos_f32 v40, v36
    v_sin_f32 v44, v36
    v_cos_f32 v41, v37
    v_sin_f32 v45, v37
    v_cvt_pk_bf16_f32 v88, v38, v39
    v_cvt_pk_bf16_f32 v89, v40, v41
    v_cvt_pk_bf16_f32 v124, v42, v43
    v_cvt_pk_bf16_f32 v125, v44, v45
    v_fmamk_f32 v34, v32, 0x43440000, v33
    v_fmamk_f32 v35, v32, 0x43450000, v33
    v_fmamk_f32 v36, v32, 0x43460000, v33
    v_fmamk_f32 v37, v32, 0x43470000, v33
    v_cos_f32 v38, v34
    v_sin_f32 v42, v34
    v_cos_f32 v39, v35
    v_sin_f32 v43, v35
    v_cos_f32 v40, v36
    v_sin_f32 v44, v36
    v_cos_f32 v41, v37
pad1_8:
    s_cbranch_execz ka1_kernel_done
    v_sin_f32 v45, v37
    v_cvt_pk_bf16_f32 v90, v38, v39
    v_cvt_pk_bf16_f32 v91, v40, v41
    v_cvt_pk_bf16_f32 v126, v42, v43
    v_cvt_pk_bf16_f32 v127, v44, v45
    v_fmamk_f32 v34, v32, 0x43600000, v33
    v_fmamk_f32 v35, v32, 0x43610000, v33
    v_fmamk_f32 v36, v32, 0x43620000, v33
    v_fmamk_f32 v37, v32, 0x43630000, v33
    v_cos_f32 v38, v34
    v_sin_f32 v42, v34
    v_cos_f32 v39, v35
    v_sin_f32 v43, v35
    v_cos_f32 v40, v36
    v_sin_f32 v44, v36
    v_cos_f32 v41, v37
    v_sin_f32 v45, v37
    v_cvt_pk_bf16_f32 v92, v38, v39
    v_cvt_pk_bf16_f32 v93, v40, v41
    v_cvt_pk_bf16_f32 v128, v42, v43
    v_cvt_pk_bf16_f32 v129, v44, v45
    v_fmamk_f32 v34, v32, 0x43640000, v33
    v_fmamk_f32 v35, v32, 0x43650000, v33
    v_fmamk_f32 v36, v32, 0x43660000, v33
    v_fmamk_f32 v37, v32, 0x43670000, v33
    v_cos_f32 v38, v34
    v_sin_f32 v42, v34
    v_cos_f32 v39, v35
    v_sin_f32 v43, v35
    v_cos_f32 v40, v36
    v_sin_f32 v44, v36
    v_cos_f32 v41, v37
    v_sin_f32 v45, v37
    v_cvt_pk_bf16_f32 v94, v38, v39
    v_cvt_pk_bf16_f32 v95, v40, v41
    v_cvt_pk_bf16_f32 v130, v42, v43
    v_cvt_pk_bf16_f32 v131, v44, v45
    v_fmamk_f32 v34, v32, 0x43800000, v33
    v_fmamk_f32 v35, v32, 0x43808000, v33
    v_fmamk_f32 v36, v32, 0x43810000, v33
pad1_9:
    s_cbranch_execz ka1_kernel_done
    v_fmamk_f32 v37, v32, 0x43818000, v33
    v_cos_f32 v38, v34
    v_sin_f32 v42, v34
    v_cos_f32 v39, v35
    v_sin_f32 v43, v35
    v_cos_f32 v40, v36
    v_sin_f32 v44, v36
    v_cos_f32 v41, v37
    v_sin_f32 v45, v37
    v_cvt_pk_bf16_f32 v96, v38, v39
    v_cvt_pk_bf16_f32 v97, v40, v41
    v_cvt_pk_bf16_f32 v132, v42, v43
    v_cvt_pk_bf16_f32 v133, v44, v45
    v_fmamk_f32 v34, v32, 0x43820000, v33
    v_fmamk_f32 v35, v32, 0x43828000, v33
    v_fmamk_f32 v36, v32, 0x43830000, v33
    v_fmamk_f32 v37, v32, 0x43838000, v33
    v_cos_f32 v38, v34
    v_sin_f32 v42, v34
    v_cos_f32 v39, v35
    v_sin_f32 v43, v35
    v_cos_f32 v40, v36
    v_sin_f32 v44, v36
    v_cos_f32 v41, v37
    v_sin_f32 v45, v37
    v_cvt_pk_bf16_f32 v98, v38, v39
    v_cvt_pk_bf16_f32 v99, v40, v41
    v_cvt_pk_bf16_f32 v134, v42, v43
    v_cvt_pk_bf16_f32 v135, v44, v45
    s_waitcnt vmcnt(0)
    s_waitcnt lgkmcnt(0)
    v_lshlrev_b32 v16, 16, v136
    v_and_b32 v17, 0xffff0000, v136
    v_lshlrev_b32 v24, 16, v160
    v_and_b32 v25, 0xffff0000, v143
    v_lshlrev_b32 v18, 16, v137
    v_and_b32 v19, 0xffff0000, v137
    v_lshlrev_b32 v26, 16, v143
    v_and_b32 v27, 0xffff0000, v142
    v_lshlrev_b32 v20, 16, v138
    v_and_b32 v21, 0xffff0000, v138
    v_lshlrev_b32 v28, 16, v142
    v_and_b32 v29, 0xffff0000, v141
    v_lshlrev_b32 v22, 16, v139
pad1_10:
    s_cbranch_execz ka1_kernel_done
    v_and_b32 v23, 0xffff0000, v139
    v_lshlrev_b32 v30, 16, v141
    v_and_b32 v31, 0xffff0000, v140
    v_lshlrev_b32 v32, 16, v144
    v_and_b32 v33, 0xffff0000, v144
    v_lshlrev_b32 v40, 16, v161
    v_and_b32 v41, 0xffff0000, v151
    v_lshlrev_b32 v34, 16, v145
    v_and_b32 v35, 0xffff0000, v145
    v_lshlrev_b32 v42, 16, v151
    v_and_b32 v43, 0xffff0000, v150
    v_lshlrev_b32 v36, 16, v146
    v_and_b32 v37, 0xffff0000, v146
    v_lshlrev_b32 v44, 16, v150
    v_and_b32 v45, 0xffff0000, v149
    v_lshlrev_b32 v38, 16, v147
    v_and_b32 v39, 0xffff0000, v147
    v_lshlrev_b32 v46, 16, v149
    v_and_b32 v47, 0xffff0000, v148
    v_lshlrev_b32 v48, 16, v152
    v_and_b32 v49, 0xffff0000, v152
    v_lshlrev_b32 v56, 16, v162
    v_and_b32 v57, 0xffff0000, v159
    v_lshlrev_b32 v50, 16, v153
    v_and_b32 v51, 0xffff0000, v153
    v_lshlrev_b32 v58, 16, v159
    v_and_b32 v59, 0xffff0000, v158
    v_lshlrev_b32 v52, 16, v154
    v_and_b32 v53, 0xffff0000, v154
    v_lshlrev_b32 v60, 16, v158
    v_and_b32 v61, 0xffff0000, v157
    v_lshlrev_b32 v54, 16, v155
    v_and_b32 v55, 0xffff0000, v155
    v_lshlrev_b32 v62, 16, v157
    v_and_b32 v63, 0xffff0000, v156
    v_pk_add_f32 v[136:137], v[16:17], v[18:19]
    v_pk_mul_f32 v[138:139], v[16:17], v[16:17]
    v_pk_add_f32 v[140:141], v[20:21], v[22:23]
    v_pk_mul_f32 v[142:143], v[18:19], v[18:19]
    v_pk_fma_f32 v[138:139], v[20:21], v[20:21], v[138:139]
pad1_11:
    s_cbranch_execz ka1_kernel_done
    v_pk_fma_f32 v[142:143], v[22:23], v[22:23], v[142:143]
    v_pk_add_f32 v[136:137], v[136:137], v[24:25]
    v_pk_fma_f32 v[138:139], v[24:25], v[24:25], v[138:139]
    v_pk_add_f32 v[140:141], v[140:141], v[26:27]
    v_pk_fma_f32 v[142:143], v[26:27], v[26:27], v[142:143]
    v_pk_add_f32 v[136:137], v[136:137], v[28:29]
    v_pk_fma_f32 v[138:139], v[28:29], v[28:29], v[138:139]
    v_pk_add_f32 v[140:141], v[140:141], v[30:31]
    v_pk_fma_f32 v[142:143], v[30:31], v[30:31], v[142:143]
    v_pk_add_f32 v[136:137], v[136:137], v[32:33]
    v_pk_fma_f32 v[138:139], v[32:33], v[32:33], v[138:139]
    v_pk_add_f32 v[140:141], v[140:141], v[34:35]
    v_pk_fma_f32 v[142:143], v[34:35], v[34:35], v[142:143]
    v_pk_add_f32 v[136:137], v[136:137], v[36:37]
    v_pk_fma_f32 v[138:139], v[36:37], v[36:37], v[138:139]
    v_pk_add_f32 v[140:141], v[140:141], v[38:39]
    v_pk_fma_f32 v[142:143], v[38:39], v[38:39], v[142:143]
    v_pk_add_f32 v[136:137], v[136:137], v[40:41]
    v_pk_fma_f32 v[138:139], v[40:41], v[40:41], v[138:139]
    v_pk_add_f32 v[140:141], v[140:141], v[42:43]
    v_pk_fma_f32 v[142:143], v[42:43], v[42:43], v[142:143]
    v_pk_add_f32 v[136:137], v[136:137], v[44:45]
    v_pk_fma_f32 v[138:139], v[44:45], v[44:45], v[138:139]
    v_pk_add_f32 v[140:141], v[140:141], v[46:47]
    v_pk_fma_f32 v[142:143], v[46:47], v[46:47], v[142:143]
    v_pk_add_f32 v[136:137], v[136:137], v[48:49]
    v_pk_fma_f32 v[138:139], v[48:49], v[48:49], v[138:139]
    v_pk_add_f32 v[140:141], v[140:141], v[50:51]
    v_pk_fma_f32 v[142:143], v[50:51], v[50:51], v[142:143]
    v_pk_add_f32 v[136:137], v[136:137], v[52:53]
    v_pk_fma_f32 v[138:139], v[52:53], v[52:53], v[138:139]
    v_pk_add_f32 v[140:141], v[140:141], v[54:55]
pad1_12:
    s_cbranch_execz ka1_kernel_done
    v_pk_fma_f32 v[142:143], v[54:55], v[54:55], v[142:143]
    v_pk_add_f32 v[136:137], v[136:137], v[56:57]
    v_pk_fma_f32 v[138:139], v[56:57], v[56:57], v[138:139]
    v_pk_add_f32 v[140:141], v[140:141], v[58:59]
    v_pk_fma_f32 v[142:143], v[58:59], v[58:59], v[142:143]
    v_pk_add_f32 v[136:137], v[136:137], v[60:61]
    v_pk_fma_f32 v[138:139], v[60:61], v[60:61], v[138:139]
    v_pk_add_f32 v[140:141], v[140:141], v[62:63]
    v_pk_fma_f32 v[142:143], v[62:63], v[62:63], v[142:143]
    v_pk_add_f32 v[136:137], v[136:137], v[140:141]
    v_pk_add_f32 v[138:139], v[138:139], v[142:143]
    v_add_f32 v136, v136, v137
    v_add_f32 v137, v138, v139
    s_lshl_b32 s36, s11, 9
    s_add_u32 s36, s36, 40960
    v_lshl_add_u32 v8, v12, 5, s36
    v_permlane32_swap_b32 v136, v137
    v_add_f32 v136, v136, v137
    v_mov_b32 v137, v136
    v_lshrrev_b32 v9, 1, v13
    s_lshl_b32 s36, s32, 3
    v_lshl_add_u32 v9, v9, 2, s36
    v_add_u32 v9, v9, v8
    v_permlane16_swap_b32 v136, v137
    v_add_f32 v136, v136, v137
    ds_write_b32 v9, v136
    s_add_u32 s20, s4, 0x1100000
    s_addc_u32 s21, s5, 0
    s_and_b32 s21, s21, 0xffff
    s_mov_b32 s22, 0x240000
    s_mov_b32 s23, 0x20000
ka1_kernel_x8:
    s_cmp_lg_u32 s10, 0
    s_cbranch_scc1 ka1_kernel_x9
    v_cvt_pk_bf16_f32 v152, v16, v17
    v_cvt_pk_bf16_f32 v153, v18, v19
    v_cvt_pk_bf16_f32 v154, v20, v21
    v_cvt_pk_bf16_f32 v155, v22, v23
    v_cvt_pk_bf16_f32 v156, v24, v25
pad1_13:
    s_cbranch_execz ka1_kernel_done
    v_cvt_pk_bf16_f32 v157, v26, v27
    v_cvt_pk_bf16_f32 v158, v28, v29
    v_cvt_pk_bf16_f32 v159, v30, v31
    buffer_store_dwordx4 v[152:155], v2, s[20:23], 0 offen sc1
    buffer_store_dwordx4 v[156:159], v5, s[20:23], 0 offen sc1
    s_branch ka1_kernel_x11
ka1_kernel_x9:
    s_cmp_lg_u32 s10, 1
    s_cbranch_scc1 ka1_kernel_x10
    v_cvt_pk_bf16_f32 v152, v32, v33
    v_cvt_pk_bf16_f32 v153, v34, v35
    v_cvt_pk_bf16_f32 v154, v36, v37
    v_cvt_pk_bf16_f32 v155, v38, v39
    v_cvt_pk_bf16_f32 v156, v40, v41
    v_cvt_pk_bf16_f32 v157, v42, v43
    v_cvt_pk_bf16_f32 v158, v44, v45
    v_cvt_pk_bf16_f32 v159, v46, v47
    buffer_store_dwordx4 v[152:155], v3, s[20:23], 0 offen sc1
    buffer_store_dwordx4 v[156:159], v6, s[20:23], 0 offen sc1
    s_branch ka1_kernel_x11
ka1_kernel_x10:
    v_cvt_pk_bf16_f32 v152, v48, v49
    v_cvt_pk_bf16_f32 v153, v50, v51
    v_cvt_pk_bf16_f32 v154, v52, v53
    v_cvt_pk_bf16_f32 v155, v54, v55
    v_cvt_pk_bf16_f32 v156, v56, v57
    v_cvt_pk_bf16_f32 v157, v58, v59
    v_cvt_pk_bf16_f32 v158, v60, v61
    v_cvt_pk_bf16_f32 v159, v62, v63
    buffer_store_dwordx4 v[152:155], v4, s[20:23], 0 offen sc1
    buffer_store_dwordx4 v[156:159], v7, s[20:23], 0 offen sc1
ka1_kernel_x11:
    s_waitcnt lgkmcnt(0)
    s_barrier
    ds_read_b128 v[136:139], v8
    ds_read_b64 v[148:149], v8 offset:16
    s_lshl_b32 s36, s11, 6
    s_add_u32 s36, s36, 41984
pad1_14:
    s_cbranch_execz ka1_kernel_done
    v_lshl_add_u32 v15, v12, 2, s36
    s_mul_i32 s36, s32, 6144
    s_lshl_b32 s37, s11, 10
    s_add_u32 s36, s36, s37
    v_add_u32 v9, s36, v1
    s_cmp_eq_u32 s32, 0
    s_cselect_b32 s36, 0xffff, 0
    s_mov_b32 s37, 0
    s_waitcnt lgkmcnt(0)
    v_pk_add_f32 v[136:137], v[136:137], v[138:139]
    v_pk_add_f32 v[136:137], v[136:137], v[148:149]
    v_mul_f32 v136, 0x3ae38e39, v136
    v_mul_f32 v137, 0x3ae38e39, v137
    v_fma_f32 v137, -v136, v136, v137
    v_max_f32 v137, 0, v137
    v_cvt_pk_bf16_f32 v138, v136, v137
    v_lshlrev_b32 v136, 16, v138
    v_and_b32 v137, 0xffff0000, v138
    v_add_f32 v137, 0x3727c5ac, v137
    v_cvt_pk_bf16_f32 v138, v137, v137
    v_and_b32 v137, 0xffff0000, v138
    v_sqrt_f32 v137, v137
    s_nop 0
    v_cvt_pk_bf16_f32 v138, v137, v137
    v_and_b32 v137, 0xffff0000, v138
    v_rcp_f32 v148, v137
    v_mov_b32 v150, v136
    v_mul_f32 v149, -v136, v148
    v_fma_f32 v136, v24, v148, v149
    v_cndmask_b32 v24, v24, v150, s[36:37]
    s_cmp_lg_u32 s32, 0
    s_cbranch_scc1 ka1_kernel_k12
    s_mov_b64 exec, 0xffff
    ds_write_b32 v15, v136
    s_mov_b64 exec, -1
ka1_kernel_k12:
    v_add_f32 v149, v149, v149
    v_pk_add_f32 v[164:165], v[16:17], v[24:25]
    v_pk_add_f32 v[166:167], v[24:25], v[16:17] neg_lo:[0,1] neg_hi:[0,1]
    v_pk_fma_f32 v[164:165], v[164:165], v[148:149], v[148:149] op_sel:[0,0,1] op_sel_hi:[1,0,1]
    v_pk_mul_f32 v[166:167], v[166:167], v[148:149] op_sel_hi:[1,0]
pad1_15:
    s_cbranch_execz ka1_kernel_done
    v_cvt_pk_bf16_f32 v136, v164, v165
    v_cvt_pk_bf16_f32 v152, v166, v167
    v_pk_add_f32 v[144:145], v[18:19], v[26:27]
    v_pk_add_f32 v[146:147], v[26:27], v[18:19] neg_lo:[0,1] neg_hi:[0,1]
    v_pk_fma_f32 v[144:145], v[144:145], v[148:149], v[148:149] op_sel:[0,0,1] op_sel_hi:[1,0,1]
    v_pk_mul_f32 v[146:147], v[146:147], v[148:149] op_sel_hi:[1,0]
    v_cvt_pk_bf16_f32 v137, v144, v145
    v_cvt_pk_bf16_f32 v153, v146, v147
    v_pk_add_f32 v[164:165], v[20:21], v[28:29]
    v_pk_add_f32 v[166:167], v[28:29], v[20:21] neg_lo:[0,1] neg_hi:[0,1]
    v_pk_fma_f32 v[164:165], v[164:165], v[148:149], v[148:149] op_sel:[0,0,1] op_sel_hi:[1,0,1]
    v_pk_mul_f32 v[166:167], v[166:167], v[148:149] op_sel_hi:[1,0]
    v_cvt_pk_bf16_f32 v138, v164, v165
    v_cvt_pk_bf16_f32 v154, v166, v167
    v_pk_add_f32 v[144:145], v[22:23], v[30:31]
    v_pk_add_f32 v[146:147], v[30:31], v[22:23] neg_lo:[0,1] neg_hi:[0,1]
    v_pk_fma_f32 v[144:145], v[144:145], v[148:149], v[148:149] op_sel:[0,0,1] op_sel_hi:[1,0,1]
    v_pk_mul_f32 v[146:147], v[146:147], v[148:149] op_sel_hi:[1,0]
    v_cvt_pk_bf16_f32 v139, v144, v145
    v_cvt_pk_bf16_f32 v155, v146, v147
    ds_write_b128 v9, v[136:139] offset:0
    ds_write_b128 v9, v[152:155] offset:18432
    v_pk_add_f32 v[164:165], v[32:33], v[40:41]
    v_pk_add_f32 v[166:167], v[40:41], v[32:33] neg_lo:[0,1] neg_hi:[0,1]
    v_pk_fma_f32 v[164:165], v[164:165], v[148:149], v[148:149] op_sel:[0,0,1] op_sel_hi:[1,0,1]
    v_pk_mul_f32 v[166:167], v[166:167], v[148:149] op_sel_hi:[1,0]
    v_cvt_pk_bf16_f32 v140, v164, v165
    v_cvt_pk_bf16_f32 v156, v166, v167
    v_pk_add_f32 v[144:145], v[34:35], v[42:43]
    v_pk_add_f32 v[146:147], v[42:43], v[34:35] neg_lo:[0,1] neg_hi:[0,1]
    v_pk_fma_f32 v[144:145], v[144:145], v[148:149], v[148:149] op_sel:[0,0,1] op_sel_hi:[1,0,1]
pad1_16:
    s_cbranch_execz ka1_kernel_done
    v_pk_mul_f32 v[146:147], v[146:147], v[148:149] op_sel_hi:[1,0]
    v_cvt_pk_bf16_f32 v141, v144, v145
    v_cvt_pk_bf16_f32 v157, v146, v147
    v_pk_add_f32 v[164:165], v[36:37], v[44:45]
    v_pk_add_f32 v[166:167], v[44:45], v[36:37] neg_lo:[0,1] neg_hi:[0,1]
    v_pk_fma_f32 v[164:165], v[164:165], v[148:149], v[148:149] op_sel:[0,0,1] op_sel_hi:[1,0,1]
    v_pk_mul_f32 v[166:167], v[166:167], v[148:149] op_sel_hi:[1,0]
    v_cvt_pk_bf16_f32 v142, v164, v165
    v_cvt_pk_bf16_f32 v158, v166, v167
    v_pk_add_f32 v[144:145], v[38:39], v[46:47]
    v_pk_add_f32 v[146:147], v[46:47], v[38:39] neg_lo:[0,1] neg_hi:[0,1]
    v_pk_fma_f32 v[144:145], v[144:145], v[148:149], v[148:149] op_sel:[0,0,1] op_sel_hi:[1,0,1]
    v_pk_mul_f32 v[146:147], v[146:147], v[148:149] op_sel_hi:[1,0]
    v_cvt_pk_bf16_f32 v143, v144, v145
    v_cvt_pk_bf16_f32 v159, v146, v147
    ds_write_b128 v9, v[140:143] offset:2048
    ds_write_b128 v9, v[156:159] offset:20480
    v_pk_add_f32 v[164:165], v[48:49], v[56:57]
    v_pk_add_f32 v[166:167], v[56:57], v[48:49] neg_lo:[0,1] neg_hi:[0,1]
    v_pk_fma_f32 v[164:165], v[164:165], v[148:149], v[148:149] op_sel:[0,0,1] op_sel_hi:[1,0,1]
    v_pk_mul_f32 v[166:167], v[166:167], v[148:149] op_sel_hi:[1,0]
    v_cvt_pk_bf16_f32 v136, v164, v165
    v_cvt_pk_bf16_f32 v160, v166, v167
    v_pk_add_f32 v[144:145], v[50:51], v[58:59]
    v_pk_add_f32 v[146:147], v[58:59], v[50:51] neg_lo:[0,1] neg_hi:[0,1]
    v_pk_fma_f32 v[144:145], v[144:145], v[148:149], v[148:149] op_sel:[0,0,1] op_sel_hi:[1,0,1]
    v_pk_mul_f32 v[146:147], v[146:147], v[148:149] op_sel_hi:[1,0]
    v_cvt_pk_bf16_f32 v137, v144, v145
    v_cvt_pk_bf16_f32 v161, v146, v147
    v_pk_add_f32 v[164:165], v[52:53], v[60:61]
    v_pk_add_f32 v[166:167], v[60:61], v[52:53] neg_lo:[0,1] neg_hi:[0,1]
    v_pk_fma_f32 v[164:165], v[164:165], v[148:149], v[148:149] op_sel:[0,0,1] op_sel_hi:[1,0,1]
pad1_17:
    s_cbranch_execz ka1_kernel_done
    v_pk_mul_f32 v[166:167], v[166:167], v[148:149] op_sel_hi:[1,0]
    v_cvt_pk_bf16_f32 v138, v164, v165
    v_cvt_pk_bf16_f32 v162, v166, v167
    v_pk_add_f32 v[144:145], v[54:55], v[62:63]
    v_pk_add_f32 v[146:147], v[62:63], v[54:55] neg_lo:[0,1] neg_hi:[0,1]
    v_pk_fma_f32 v[144:145], v[144:145], v[148:149], v[148:149] op_sel:[0,0,1] op_sel_hi:[1,0,1]
    v_pk_mul_f32 v[146:147], v[146:147], v[148:149] op_sel_hi:[1,0]
    v_cvt_pk_bf16_f32 v139, v144, v145
    v_cvt_pk_bf16_f32 v163, v146, v147
    ds_write_b128 v9, v[136:139] offset:4096
    ds_write_b128 v9, v[160:163] offset:22528
    s_add_u32 s20, s4, 0xb00000
    s_addc_u32 s21, s5, 0
    s_and_b32 s21, s21, 0xffff
    s_mov_b32 s22, 0x480000
    s_mov_b32 s23, 0x20000
    s_mul_i32 s38, s10, 3
    s_add_u32 s38, s38, s32
    s_lshl_b32 s38, s38, 1
    s_add_u32 s38, s38, s11
    s_lshl_b32 s38, s38, 12
    s_lshr_b32 s39, s9, 2
    s_lshl_b32 s39, s39, 8
    s_add_u32 s38, s38, s39
    s_and_b32 s39, s9, 3
    s_lshl_b32 s39, s39, 2
    s_add_u32 s38, s38, s39
    s_mov_b32 s39, 589824
    v_lshl_add_u32 v2, v12, 4, s38
    v_mad_u32_u24 v2, v13, s39, v2
    v_add_u32 v3, 73728, v2
    s_mov_b32 s40, 0
    s_mov_b32 s41, 147456
    s_mov_b32 s42, 294912
    s_mov_b32 s43, 442368
    s_mov_b32 s44, 2359296
    s_mov_b32 s45, 2506752
    s_mov_b32 s46, 2654208
pad1_18:
    s_cbranch_execz ka1_kernel_done
    s_mov_b32 s47, 2801664
    v_lshlrev_b32 v8, 4, v13
    v_lshlrev_b32 v9, 31, v12
    s_waitcnt lgkmcnt(0)
    s_barrier
    ds_read_b128 v[16:19], v8 offset:41984
    ds_read_b128 v[20:23], v8 offset:42048
    ds_read_b128 v[136:139], v1 offset:0
    ds_read_b128 v[140:143], v1 offset:18432
    ds_read_b128 v[144:147], v1 offset:1024
    ds_read_b128 v[148:151], v1 offset:19456
    ds_read_b128 v[152:155], v1 offset:2048
    ds_read_b128 v[156:159], v1 offset:20480
    ds_read_b128 v[160:163], v1 offset:3072
    ds_read_b128 v[164:167], v1 offset:21504
    ds_read_b128 v[44:47], v1 offset:36864
    ds_read_b128 v[48:51], v1 offset:37888
    ds_read_b128 v[52:55], v1 offset:38912
    ds_read_b128 v[56:59], v1 offset:39936
    s_or_b32 s38, s10, s6
    s_cmp_eq_u32 s38, 0
    s_cbranch_scc1 ka1_kernel_sp13
    s_waitcnt lgkmcnt(12)
    v_xor_b32 v16, v9, v16
    v_xor_b32 v17, v9, v17
    v_xor_b32 v18, v9, v18
    v_xor_b32 v19, v9, v19
    v_xor_b32 v20, v9, v20
    v_xor_b32 v21, v9, v21
    v_xor_b32 v22, v9, v22
    v_xor_b32 v23, v9, v23
    s_waitcnt lgkmcnt(11)
    v_mfma_f32_16x16x32_bf16 v[16:19], v[136:139], v[64:67], v[16:19]
    ds_read_b128 v[136:139], v1 offset:4096
    s_waitcnt lgkmcnt(11)
    v_mfma_f32_16x16x32_bf16 v[24:27], v[140:143], v[100:103], 0
    ds_read_b128 v[140:143], v1 offset:22528
    s_waitcnt lgkmcnt(11)
    v_mfma_f32_16x16x32_bf16 v[20:23], v[144:147], v[64:67], v[20:23]
    ds_read_b128 v[144:147], v1 offset:5120
    s_waitcnt lgkmcnt(11)
pad1_19:
    s_cbranch_execz ka1_kernel_done
    v_mfma_f32_16x16x32_bf16 v[28:31], v[148:151], v[100:103], 0
    ds_read_b128 v[148:151], v1 offset:23552
    s_waitcnt lgkmcnt(11)
    v_mfma_f32_16x16x32_bf16 v[16:19], v[152:155], v[68:71], v[16:19]
    ds_read_b128 v[152:155], v1 offset:6144
    s_waitcnt lgkmcnt(11)
    v_mfma_f32_16x16x32_bf16 v[24:27], v[156:159], v[104:107], v[24:27]
    ds_read_b128 v[156:159], v1 offset:24576
    s_waitcnt lgkmcnt(11)
    v_mfma_f32_16x16x32_bf16 v[20:23], v[160:163], v[68:71], v[20:23]
    ds_read_b128 v[160:163], v1 offset:7168
    s_waitcnt lgkmcnt(11)
    v_mfma_f32_16x16x32_bf16 v[28:31], v[164:167], v[104:107], v[28:31]
    ds_read_b128 v[164:167], v1 offset:25600
    s_waitcnt lgkmcnt(7)
    v_mfma_f32_16x16x32_bf16 v[16:19], v[136:139], v[72:75], v[16:19]
    ds_read_b128 v[136:139], v1 offset:8192
    s_waitcnt lgkmcnt(7)
    v_mfma_f32_16x16x32_bf16 v[24:27], v[140:143], v[108:111], v[24:27]
    ds_read_b128 v[140:143], v1 offset:26624
    s_waitcnt lgkmcnt(7)
    v_mfma_f32_16x16x32_bf16 v[20:23], v[144:147], v[72:75], v[20:23]
    ds_read_b128 v[144:147], v1 offset:9216
    s_waitcnt lgkmcnt(7)
    v_mfma_f32_16x16x32_bf16 v[28:31], v[148:151], v[108:111], v[28:31]
    ds_read_b128 v[148:151], v1 offset:27648
    s_waitcnt lgkmcnt(7)
    v_mfma_f32_16x16x32_bf16 v[16:19], v[152:155], v[76:79], v[16:19]
    ds_read_b128 v[152:155], v1 offset:10240
    s_waitcnt lgkmcnt(7)
    v_mfma_f32_16x16x32_bf16 v[24:27], v[156:159], v[112:115], v[24:27]
    ds_read_b128 v[156:159], v1 offset:28672
    s_waitcnt lgkmcnt(7)
    v_mfma_f32_16x16x32_bf16 v[20:23], v[160:163], v[76:79], v[20:23]
    ds_read_b128 v[160:163], v1 offset:11264
    s_waitcnt lgkmcnt(7)
    v_mfma_f32_16x16x32_bf16 v[28:31], v[164:167], v[112:115], v[28:31]
    ds_read_b128 v[164:167], v1 offset:29696
pad1_20:
    s_cbranch_execz ka1_kernel_done
    s_waitcnt lgkmcnt(7)
    v_mfma_f32_16x16x32_bf16 v[16:19], v[136:139], v[80:83], v[16:19]
    ds_read_b128 v[136:139], v1 offset:12288
    s_waitcnt lgkmcnt(7)
    v_mfma_f32_16x16x32_bf16 v[24:27], v[140:143], v[116:119], v[24:27]
    ds_read_b128 v[140:143], v1 offset:30720
    s_waitcnt lgkmcnt(7)
    v_mfma_f32_16x16x32_bf16 v[20:23], v[144:147], v[80:83], v[20:23]
    ds_read_b128 v[144:147], v1 offset:13312
    s_waitcnt lgkmcnt(7)
    v_mfma_f32_16x16x32_bf16 v[28:31], v[148:151], v[116:119], v[28:31]
    ds_read_b128 v[148:151], v1 offset:31744
    s_waitcnt lgkmcnt(7)
    v_mfma_f32_16x16x32_bf16 v[16:19], v[152:155], v[84:87], v[16:19]
    ds_read_b128 v[152:155], v1 offset:14336
    s_waitcnt lgkmcnt(7)
    v_mfma_f32_16x16x32_bf16 v[24:27], v[156:159], v[120:123], v[24:27]
    ds_read_b128 v[156:159], v1 offset:32768
    s_waitcnt lgkmcnt(7)
    v_mfma_f32_16x16x32_bf16 v[20:23], v[160:163], v[84:87], v[20:23]
    ds_read_b128 v[160:163], v1 offset:15360
    s_waitcnt lgkmcnt(7)
    v_mfma_f32_16x16x32_bf16 v[28:31], v[164:167], v[120:123], v[28:31]
    ds_read_b128 v[164:167], v1 offset:33792
    s_waitcnt lgkmcnt(7)
    v_mfma_f32_16x16x32_bf16 v[16:19], v[136:139], v[88:91], v[16:19]
    ds_read_b128 v[136:139], v1 offset:16384
    s_waitcnt lgkmcnt(7)
    v_mfma_f32_16x16x32_bf16 v[24:27], v[140:143], v[124:127], v[24:27]
    ds_read_b128 v[140:143], v1 offset:34816
    s_waitcnt lgkmcnt(7)
    v_mfma_f32_16x16x32_bf16 v[20:23], v[144:147], v[88:91], v[20:23]
    ds_read_b128 v[144:147], v1 offset:17408
    s_waitcnt lgkmcnt(7)
    v_mfma_f32_16x16x32_bf16 v[28:31], v[148:151], v[124:127], v[28:31]
    ds_read_b128 v[148:151], v1 offset:35840
    s_waitcnt lgkmcnt(7)
    v_mfma_f32_16x16x32_bf16 v[16:19], v[152:155], v[92:95], v[16:19]
pad1_21:
    s_cbranch_execz ka1_kernel_done
    s_waitcnt lgkmcnt(6)
    v_mfma_f32_16x16x32_bf16 v[24:27], v[156:159], v[128:131], v[24:27]
    s_waitcnt lgkmcnt(5)
    v_mfma_f32_16x16x32_bf16 v[20:23], v[160:163], v[92:95], v[20:23]
    s_waitcnt lgkmcnt(4)
    v_mfma_f32_16x16x32_bf16 v[28:31], v[164:167], v[128:131], v[28:31]
    s_waitcnt lgkmcnt(3)
    v_mfma_f32_16x16x32_bf16 v[16:19], v[136:139], v[96:99], v[16:19]
    s_waitcnt lgkmcnt(2)
    v_mfma_f32_16x16x32_bf16 v[24:27], v[140:143], v[132:135], v[24:27]
    s_waitcnt lgkmcnt(1)
    v_mfma_f32_16x16x32_bf16 v[20:23], v[144:147], v[96:99], v[20:23]
    s_waitcnt lgkmcnt(0)
    v_mfma_f32_16x16x32_bf16 v[28:31], v[148:151], v[132:135], v[28:31]
    s_nop 1
    v_cvt_pk_bf16_f32 v36, v16, v17
    v_cvt_pk_bf16_f32 v37, v18, v19
    s_nop 1
    v_cvt_pk_bf16_f32 v38, v20, v21
    v_cvt_pk_bf16_f32 v39, v22, v23
    v_cvt_pk_bf16_f32 v40, v24, v25
    v_cvt_pk_bf16_f32 v41, v26, v27
    v_cvt_pk_bf16_f32 v42, v28, v29
    v_cvt_pk_bf16_f32 v43, v30, v31
    v_mfma_f32_16x16x32_bf16 v[64:67], v[44:47], v[36:39], 0
    v_mfma_f32_16x16x32_bf16 v[68:71], v[52:55], v[36:39], 0
    v_mfma_f32_16x16x32_bf16 v[72:75], v[52:55], v[40:43], 0
    v_mfma_f32_16x16x32_bf16 v[76:79], v[44:47], v[40:43], 0
    v_mfma_f32_16x16x32_bf16 v[80:83], v[48:51], v[36:39], 0
    v_mfma_f32_16x16x32_bf16 v[84:87], v[56:59], v[36:39], 0
    v_mfma_f32_16x16x32_bf16 v[88:91], v[56:59], v[40:43], 0
    v_mfma_f32_16x16x32_bf16 v[92:95], v[48:51], v[40:43], 0
    s_nop 2
    v_sub_f32 v96, v64, v72
    v_add_f32 v97, v68, v76
    v_add_f32 v98, v64, v72
    v_sub_f32 v99, v68, v76
    v_cvt_pk_bf16_f32 v100, v96, v97
pad1_22:
    s_cbranch_execz ka1_kernel_done
    v_cvt_pk_bf16_f32 v101, v98, v99
    buffer_store_dword v100, v2, s[20:23], s40 offen
    buffer_store_dword v101, v3, s[20:23], s40 offen
    v_sub_f32 v102, v65, v73
    v_add_f32 v103, v69, v77
    v_add_f32 v104, v65, v73
    v_sub_f32 v105, v69, v77
    v_cvt_pk_bf16_f32 v106, v102, v103
    v_cvt_pk_bf16_f32 v107, v104, v105
    buffer_store_dword v106, v2, s[20:23], s41 offen
    buffer_store_dword v107, v3, s[20:23], s41 offen
    v_sub_f32 v108, v66, v74
    v_add_f32 v109, v70, v78
    v_add_f32 v110, v66, v74
    v_sub_f32 v111, v70, v78
    v_cvt_pk_bf16_f32 v112, v108, v109
    v_cvt_pk_bf16_f32 v113, v110, v111
    buffer_store_dword v112, v2, s[20:23], s42 offen
    buffer_store_dword v113, v3, s[20:23], s42 offen
    v_sub_f32 v114, v67, v75
    v_add_f32 v115, v71, v79
    v_add_f32 v116, v67, v75
    v_sub_f32 v117, v71, v79
    v_cvt_pk_bf16_f32 v118, v114, v115
    v_cvt_pk_bf16_f32 v119, v116, v117
    buffer_store_dword v118, v2, s[20:23], s43 offen
    buffer_store_dword v119, v3, s[20:23], s43 offen
    v_sub_f32 v96, v80, v88
    v_add_f32 v97, v84, v92
    v_add_f32 v98, v80, v88
    v_sub_f32 v99, v84, v92
    v_cvt_pk_bf16_f32 v100, v96, v97
    v_cvt_pk_bf16_f32 v101, v98, v99
    s_mov_b64 exec, 0xffff
    buffer_store_dword v100, v2, s[20:23], s44 offen
    buffer_store_dword v101, v3, s[20:23], s44 offen
    s_mov_b64 exec, -1
    s_endpgm
ka1_kernel_sp13:
    s_mov_b32 s36, 0x00010001
    s_mov_b32 s37, s36
    v_mov_b32 v33, 0xbf803f80
pad1_23:
    s_cbranch_execz ka1_kernel_done
    v_cndmask_b32 v32, 0, v33, s[36:37]
    v_mov_b32 v33, v32
    v_mov_b32 v34, v32
    v_mov_b32 v35, v32
    s_waitcnt lgkmcnt(12)
    v_cndmask_b32 v24, 0, v16, s[36:37]
    v_xor_b32 v16, v9, v16
    v_cndmask_b32 v25, 0, v17, s[36:37]
    v_xor_b32 v17, v9, v17
    v_cndmask_b32 v26, 0, v18, s[36:37]
    v_xor_b32 v18, v9, v18
    v_cndmask_b32 v27, 0, v19, s[36:37]
    v_xor_b32 v19, v9, v19
    v_cndmask_b32 v28, 0, v20, s[36:37]
    v_xor_b32 v20, v9, v20
    v_cndmask_b32 v29, 0, v21, s[36:37]
    v_xor_b32 v21, v9, v21
    v_cndmask_b32 v30, 0, v22, s[36:37]
    v_xor_b32 v22, v9, v22
    v_cndmask_b32 v31, 0, v23, s[36:37]
    v_xor_b32 v23, v9, v23
    s_waitcnt lgkmcnt(11)
    v_mfma_f32_16x16x32_bf16 v[16:19], v[136:139], v[64:67], v[16:19]
    v_mfma_f32_16x16x32_bf16 v[24:27], v[136:139], v[32:35], v[24:27]
    ds_read_b128 v[136:139], v1 offset:4096
    s_waitcnt lgkmcnt(11)
    v_mfma_f32_16x16x32_bf16 v[24:27], v[140:143], v[100:103], v[24:27]
    ds_read_b128 v[140:143], v1 offset:22528
    s_waitcnt lgkmcnt(11)
    v_mfma_f32_16x16x32_bf16 v[20:23], v[144:147], v[64:67], v[20:23]
    v_mfma_f32_16x16x32_bf16 v[28:31], v[144:147], v[32:35], v[28:31]
    ds_read_b128 v[144:147], v1 offset:5120
    s_waitcnt lgkmcnt(11)
    v_mfma_f32_16x16x32_bf16 v[28:31], v[148:151], v[100:103], v[28:31]
    ds_read_b128 v[148:151], v1 offset:23552
    s_waitcnt lgkmcnt(11)
    v_mfma_f32_16x16x32_bf16 v[16:19], v[152:155], v[68:71], v[16:19]
    v_mfma_f32_16x16x32_bf16 v[24:27], v[152:155], v[32:35], v[24:27]
    ds_read_b128 v[152:155], v1 offset:6144
    s_waitcnt lgkmcnt(11)
    v_mfma_f32_16x16x32_bf16 v[24:27], v[156:159], v[104:107], v[24:27]
pad1_24:
    s_cbranch_execz ka1_kernel_done
    ds_read_b128 v[156:159], v1 offset:24576
    s_waitcnt lgkmcnt(11)
    v_mfma_f32_16x16x32_bf16 v[20:23], v[160:163], v[68:71], v[20:23]
    v_mfma_f32_16x16x32_bf16 v[28:31], v[160:163], v[32:35], v[28:31]
    ds_read_b128 v[160:163], v1 offset:7168
    s_waitcnt lgkmcnt(11)
    v_mfma_f32_16x16x32_bf16 v[28:31], v[164:167], v[104:107], v[28:31]
    ds_read_b128 v[164:167], v1 offset:25600
    s_waitcnt lgkmcnt(7)
    v_mfma_f32_16x16x32_bf16 v[16:19], v[136:139], v[72:75], v[16:19]
    v_mfma_f32_16x16x32_bf16 v[24:27], v[136:139], v[32:35], v[24:27]
    ds_read_b128 v[136:139], v1 offset:8192
    s_waitcnt lgkmcnt(7)
    v_mfma_f32_16x16x32_bf16 v[24:27], v[140:143], v[108:111], v[24:27]
    ds_read_b128 v[140:143], v1 offset:26624
    s_waitcnt lgkmcnt(7)
    v_mfma_f32_16x16x32_bf16 v[20:23], v[144:147], v[72:75], v[20:23]
    v_mfma_f32_16x16x32_bf16 v[28:31], v[144:147], v[32:35], v[28:31]
    ds_read_b128 v[144:147], v1 offset:9216
    s_waitcnt lgkmcnt(7)
    v_mfma_f32_16x16x32_bf16 v[28:31], v[148:151], v[108:111], v[28:31]
    ds_read_b128 v[148:151], v1 offset:27648
    s_waitcnt lgkmcnt(7)
    v_mfma_f32_16x16x32_bf16 v[16:19], v[152:155], v[76:79], v[16:19]
    v_mfma_f32_16x16x32_bf16 v[24:27], v[152:155], v[32:35], v[24:27]
    ds_read_b128 v[152:155], v1 offset:10240
    s_waitcnt lgkmcnt(7)
    v_mfma_f32_16x16x32_bf16 v[24:27], v[156:159], v[112:115], v[24:27]
    ds_read_b128 v[156:159], v1 offset:28672
    s_waitcnt lgkmcnt(7)
    v_mfma_f32_16x16x32_bf16 v[20:23], v[160:163], v[76:79], v[20:23]
    v_mfma_f32_16x16x32_bf16 v[28:31], v[160:163], v[32:35], v[28:31]
    ds_read_b128 v[160:163], v1 offset:11264
    s_waitcnt lgkmcnt(7)
    v_mfma_f32_16x16x32_bf16 v[28:31], v[164:167], v[112:115], v[28:31]
    ds_read_b128 v[164:167], v1 offset:29696
pad1_25:
    s_cbranch_execz ka1_kernel_done
    s_waitcnt lgkmcnt(7)
    v_mfma_f32_16x16x32_bf16 v[16:19], v[136:139], v[80:83], v[16:19]
    v_mfma_f32_16x16x32_bf16 v[24:27], v[136:139], v[32:35], v[24:27]
    ds_read_b128 v[136:139], v1 offset:12288
    s_waitcnt lgkmcnt(7)
    v_mfma_f32_16x16x32_bf16 v[24:27], v[140:143], v[116:119], v[24:27]
    ds_read_b128 v[140:143], v1 offset:30720
    s_waitcnt lgkmcnt(7)
    v_mfma_f32_16x16x32_bf16 v[20:23], v[144:147], v[80:83], v[20:23]
    v_mfma_f32_16x16x32_bf16 v[28:31], v[144:147], v[32:35], v[28:31]
    ds_read_b128 v[144:147], v1 offset:13312
    s_waitcnt lgkmcnt(7)
    v_mfma_f32_16x16x32_bf16 v[28:31], v[148:151], v[116:119], v[28:31]
    ds_read_b128 v[148:151], v1 offset:31744
    s_waitcnt lgkmcnt(7)
    v_mfma_f32_16x16x32_bf16 v[16:19], v[152:155], v[84:87], v[16:19]
    v_mfma_f32_16x16x32_bf16 v[24:27], v[152:155], v[32:35], v[24:27]
    ds_read_b128 v[152:155], v1 offset:14336
    s_waitcnt lgkmcnt(7)
    v_mfma_f32_16x16x32_bf16 v[24:27], v[156:159], v[120:123], v[24:27]
    ds_read_b128 v[156:159], v1 offset:32768
    s_waitcnt lgkmcnt(7)
    v_mfma_f32_16x16x32_bf16 v[20:23], v[160:163], v[84:87], v[20:23]
    v_mfma_f32_16x16x32_bf16 v[28:31], v[160:163], v[32:35], v[28:31]
    ds_read_b128 v[160:163], v1 offset:15360
    s_waitcnt lgkmcnt(7)
    v_mfma_f32_16x16x32_bf16 v[28:31], v[164:167], v[120:123], v[28:31]
    ds_read_b128 v[164:167], v1 offset:33792
    s_waitcnt lgkmcnt(7)
    v_mfma_f32_16x16x32_bf16 v[16:19], v[136:139], v[88:91], v[16:19]
    v_mfma_f32_16x16x32_bf16 v[24:27], v[136:139], v[32:35], v[24:27]
    ds_read_b128 v[136:139], v1 offset:16384
    s_waitcnt lgkmcnt(7)
    v_mfma_f32_16x16x32_bf16 v[24:27], v[140:143], v[124:127], v[24:27]
    ds_read_b128 v[140:143], v1 offset:34816
    s_waitcnt lgkmcnt(7)
    v_mfma_f32_16x16x32_bf16 v[20:23], v[144:147], v[88:91], v[20:23]
pad1_26:
    s_cbranch_execz ka1_kernel_done
    v_mfma_f32_16x16x32_bf16 v[28:31], v[144:147], v[32:35], v[28:31]
    ds_read_b128 v[144:147], v1 offset:17408
    s_waitcnt lgkmcnt(7)
    v_mfma_f32_16x16x32_bf16 v[28:31], v[148:151], v[124:127], v[28:31]
    ds_read_b128 v[148:151], v1 offset:35840
    s_waitcnt lgkmcnt(7)
    v_mfma_f32_16x16x32_bf16 v[16:19], v[152:155], v[92:95], v[16:19]
    v_mfma_f32_16x16x32_bf16 v[24:27], v[152:155], v[32:35], v[24:27]
    s_waitcnt lgkmcnt(6)
    v_mfma_f32_16x16x32_bf16 v[24:27], v[156:159], v[128:131], v[24:27]
    s_waitcnt lgkmcnt(5)
    v_mfma_f32_16x16x32_bf16 v[20:23], v[160:163], v[92:95], v[20:23]
    v_mfma_f32_16x16x32_bf16 v[28:31], v[160:163], v[32:35], v[28:31]
    s_waitcnt lgkmcnt(4)
    v_mfma_f32_16x16x32_bf16 v[28:31], v[164:167], v[128:131], v[28:31]
    s_waitcnt lgkmcnt(3)
    v_mfma_f32_16x16x32_bf16 v[16:19], v[136:139], v[96:99], v[16:19]
    v_mfma_f32_16x16x32_bf16 v[24:27], v[136:139], v[32:35], v[24:27]
    s_waitcnt lgkmcnt(2)
    v_mfma_f32_16x16x32_bf16 v[24:27], v[140:143], v[132:135], v[24:27]
    s_waitcnt lgkmcnt(1)
    v_mfma_f32_16x16x32_bf16 v[20:23], v[144:147], v[96:99], v[20:23]
    v_mfma_f32_16x16x32_bf16 v[28:31], v[144:147], v[32:35], v[28:31]
    s_waitcnt lgkmcnt(0)
    v_mfma_f32_16x16x32_bf16 v[28:31], v[148:151], v[132:135], v[28:31]
    v_cvt_pk_bf16_f32 v36, v16, v17
    v_cvt_pk_bf16_f32 v37, v18, v19
    s_nop 2
    v_cvt_pk_bf16_f32 v38, v20, v21
    v_cvt_pk_bf16_f32 v39, v22, v23
    v_cvt_pk_bf16_f32 v40, v24, v25
    v_cvt_pk_bf16_f32 v41, v26, v27
    v_cvt_pk_bf16_f32 v42, v28, v29
    v_cvt_pk_bf16_f32 v43, v30, v31
    v_mfma_f32_16x16x32_bf16 v[64:67], v[44:47], v[36:39], 0
    v_mfma_f32_16x16x32_bf16 v[68:71], v[52:55], v[36:39], 0
    v_mfma_f32_16x16x32_bf16 v[72:75], v[52:55], v[40:43], 0
pad1_27:
    s_cbranch_execz ka1_kernel_done
    v_mfma_f32_16x16x32_bf16 v[76:79], v[44:47], v[40:43], 0
    v_mfma_f32_16x16x32_bf16 v[80:83], v[48:51], v[36:39], 0
    v_mfma_f32_16x16x32_bf16 v[84:87], v[56:59], v[36:39], 0
    v_mfma_f32_16x16x32_bf16 v[88:91], v[56:59], v[40:43], 0
    v_mfma_f32_16x16x32_bf16 v[92:95], v[48:51], v[40:43], 0
    v_cmp_lt_u32 vcc, 15, v14
    v_mov_b32 v10, 0x80000000
    s_nop 0
    v_cndmask_b32 v11, 0, v10, vcc
    v_sub_f32 v96, v64, v72
    v_add_f32 v97, v68, v76
    v_add_f32 v98, v64, v72
    v_sub_f32 v99, v68, v76
    v_cndmask_b32 v96, v96, v64, s[36:37]
    v_cndmask_b32 v97, v97, v68, s[36:37]
    v_cndmask_b32 v98, v98, v76, s[36:37]
    v_cndmask_b32 v99, v99, v72, s[36:37]
    v_cvt_pk_bf16_f32 v100, v96, v97
    v_cvt_pk_bf16_f32 v101, v98, v99
    buffer_store_dword v100, v2, s[20:23], s40 offen
    buffer_store_dword v101, v3, s[20:23], s40 offen
    v_sub_f32 v102, v65, v73
    v_add_f32 v103, v69, v77
    v_add_f32 v104, v65, v73
    v_sub_f32 v105, v69, v77
    v_cndmask_b32 v102, v102, v65, s[36:37]
    v_cndmask_b32 v103, v103, v69, s[36:37]
    v_cndmask_b32 v104, v104, v77, s[36:37]
    v_cndmask_b32 v105, v105, v73, s[36:37]
    v_cvt_pk_bf16_f32 v106, v102, v103
    v_cvt_pk_bf16_f32 v107, v104, v105
    buffer_store_dword v106, v2, s[20:23], s41 offen
    buffer_store_dword v107, v3, s[20:23], s41 offen
    v_sub_f32 v108, v66, v74
    v_add_f32 v109, v70, v78
    v_add_f32 v110, v66, v74
    v_sub_f32 v111, v70, v78
    v_cndmask_b32 v108, v108, v66, s[36:37]
    v_cndmask_b32 v109, v109, v70, s[36:37]
pad1_28:
    s_cbranch_execz ka1_kernel_done
    v_cndmask_b32 v110, v110, v78, s[36:37]
    v_cndmask_b32 v111, v111, v74, s[36:37]
    v_cvt_pk_bf16_f32 v112, v108, v109
    v_cvt_pk_bf16_f32 v113, v110, v111
    buffer_store_dword v112, v2, s[20:23], s42 offen
    buffer_store_dword v113, v3, s[20:23], s42 offen
    v_sub_f32 v114, v67, v75
    v_add_f32 v115, v71, v79
    v_add_f32 v116, v67, v75
    v_sub_f32 v117, v71, v79
    v_cndmask_b32 v114, v114, v67, s[36:37]
    v_cndmask_b32 v115, v115, v71, s[36:37]
    v_cndmask_b32 v116, v116, v79, s[36:37]
    v_cndmask_b32 v117, v117, v75, s[36:37]
    v_cvt_pk_bf16_f32 v118, v114, v115
    v_cvt_pk_bf16_f32 v119, v116, v117
    buffer_store_dword v118, v2, s[20:23], s43 offen
    buffer_store_dword v119, v3, s[20:23], s43 offen
    v_sub_f32 v96, v80, v88
    v_add_f32 v97, v84, v92
    v_add_f32 v98, v80, v88
    v_sub_f32 v99, v84, v92
    v_cndmask_b32 v96, v96, v80, s[36:37]
    v_cndmask_b32 v97, v97, v84, s[36:37]
    v_cndmask_b32 v98, v98, v92, s[36:37]
    v_cndmask_b32 v99, v99, v88, s[36:37]
    v_cvt_pk_bf16_f32 v100, v96, v97
    v_cvt_pk_bf16_f32 v101, v98, v99
    v_xor_b32 v100, v11, v100
    v_xor_b32 v101, v11, v101
    buffer_store_dword v100, v2, s[20:23], s44 offen
    buffer_store_dword v101, v3, s[20:23], s44 offen
    v_sub_f32 v102, v81, v89
    v_add_f32 v103, v85, v93
    v_add_f32 v104, v81, v89
    v_sub_f32 v105, v85, v93
    v_cndmask_b32 v102, v102, v81, s[36:37]
    v_cndmask_b32 v103, v103, v85, s[36:37]
pad1_29:
    s_cbranch_execz ka1_kernel_done
    v_cndmask_b32 v104, v104, v93, s[36:37]
    v_cndmask_b32 v105, v105, v89, s[36:37]
    v_cvt_pk_bf16_f32 v106, v102, v103
    v_cvt_pk_bf16_f32 v107, v104, v105
    v_xor_b32 v106, v10, v106
    v_xor_b32 v107, v10, v107
    buffer_store_dword v106, v2, s[20:23], s45 offen
    buffer_store_dword v107, v3, s[20:23], s45 offen
    v_sub_f32 v108, v82, v90
    v_add_f32 v109, v86, v94
    v_add_f32 v110, v82, v90
    v_sub_f32 v111, v86, v94
    v_cndmask_b32 v108, v108, v82, s[36:37]
    v_cndmask_b32 v109, v109, v86, s[36:37]
    v_cndmask_b32 v110, v110, v94, s[36:37]
    v_cndmask_b32 v111, v111, v90, s[36:37]
    v_cvt_pk_bf16_f32 v112, v108, v109
    v_cvt_pk_bf16_f32 v113, v110, v111
    v_xor_b32 v112, v10, v112
    v_xor_b32 v113, v10, v113
    buffer_store_dword v112, v2, s[20:23], s46 offen
    buffer_store_dword v113, v3, s[20:23], s46 offen
    v_sub_f32 v114, v83, v91
    v_add_f32 v115, v87, v95
    v_add_f32 v116, v83, v91
    v_sub_f32 v117, v87, v95
    v_cndmask_b32 v114, v114, v83, s[36:37]
    v_cndmask_b32 v115, v115, v87, s[36:37]
    v_cndmask_b32 v116, v116, v95, s[36:37]
    v_cndmask_b32 v117, v117, v91, s[36:37]
    v_cvt_pk_bf16_f32 v118, v114, v115
    v_cvt_pk_bf16_f32 v119, v116, v117
    v_xor_b32 v118, v10, v118
    v_xor_b32 v119, v10, v119
    buffer_store_dword v118, v2, s[20:23], s47 offen
    buffer_store_dword v119, v3, s[20:23], s47 offen
ka1_kernel_fin:
ka1_kernel_done:
    s_endpgm
.section .rodata,"a"
.p2align 6
.amdhsa_kernel ka1_kernel
  .amdhsa_next_free_vgpr 168
  .amdhsa_next_free_sgpr 96
  .amdhsa_accum_offset 168
  .amdhsa_group_segment_fixed_size 0
  .amdhsa_kernarg_size 88
  .amdhsa_user_sgpr_count 2
  .amdhsa_user_sgpr_kernarg_segment_ptr 1
  .amdhsa_system_sgpr_workgroup_id_x 1
  .amdhsa_float_denorm_mode_32 3
  .amdhsa_float_denorm_mode_16_64 3
.end_amdhsa_kernel
.text
.globl kf_kernel
.p2align 8
.type kf_kernel,@function
kf_kernel:
pad0_0:
    s_cbranch_execz kf_kernel_done
    s_cmp_ge_u32 s2, 256
    s_cbranch_scc1 kf_kernel_done
    s_load_dwordx2 s[4:5], s[0:1], 80
    v_lshrrev_b32 v2, 6, v0
    v_and_b32 v14, 63, v0
    v_readfirstlane_b32 s6, v2
    v_lshlrev_b32 v1, 4, v14
    v_and_b32 v12, 15, v14
    v_lshrrev_b32 v13, 4, v14
    s_and_b32 s7, s2, 1
    s_lshl_b32 s7, s7, 2
    s_bfe_u32 s9, s2, 0x20003
    s_add_u32 s7, s7, s9
    s_bfe_u32 s8, s2, 0x20001
    s_lshl_b32 s8, s8, 2
    s_lshr_b32 s9, s2, 6
    s_add_u32 s9, s8, s9
    s_sub_u32 s10, 32, s9
    s_cmp_eq_u32 s9, 0
    s_cselect_b32 s10, 16, s10
    s_bitcmp1_b32 s2, 5
    s_cselect_b32 s8, s10, s9
    s_mul_i32 s10, s8, 147456
    s_mul_i32 s11, s9, 147456
    s_cmp_ge_u32 s8, 17
    s_cselect_b32 s11, s11, s10
    s_cselect_b32 s32, 73728, 0
    s_mov_b32 s33, 0xba000000
    s_cselect_b32 s33, 0x3a000000, s33
    s_lshl_b32 s34, s6, 15
    s_add_u32 s35, s34, 0
    s_add_u32 s36, s35, s32
    s_sub_u32 s37, s35, s32
    s_cmp_lt_u32 s35, 73728
    s_cselect_b32 s36, s36, s37
    s_add_u32 s44, s36, s11
    s_add_u32 s36, s35, s10
    s_cmp_eq_u32 s6, 0
    s_cselect_b32 s44, s36, s44
    s_add_u32 s35, s34, 4096
    s_add_u32 s36, s35, s32
    s_sub_u32 s37, s35, s32
    s_cmp_lt_u32 s35, 73728
    s_cselect_b32 s36, s36, s37
    s_add_u32 s45, s36, s11
    s_add_u32 s35, s34, 8192
    s_add_u32 s36, s35, s32
    s_sub_u32 s37, s35, s32
    s_cmp_lt_u32 s35, 73728
pad0_1:
    s_cbranch_execz kf_kernel_done
    s_cselect_b32 s36, s36, s37
    s_add_u32 s46, s36, s11
    s_add_u32 s36, s35, s10
    s_cmp_eq_u32 s6, 2
    s_cselect_b32 s46, s36, s46
    s_add_u32 s35, s34, 12288
    s_add_u32 s36, s35, s32
    s_sub_u32 s37, s35, s32
    s_cmp_lt_u32 s35, 73728
    s_cselect_b32 s36, s36, s37
    s_add_u32 s47, s36, s11
    s_add_u32 s35, s34, 16384
    s_add_u32 s36, s35, s32
    s_sub_u32 s37, s35, s32
    s_cmp_lt_u32 s35, 73728
    s_cselect_b32 s36, s36, s37
    s_add_u32 s48, s36, s11
    s_add_u32 s35, s34, 20480
    s_add_u32 s36, s35, s32
    s_sub_u32 s37, s35, s32
    s_cmp_lt_u32 s35, 73728
    s_cselect_b32 s36, s36, s37
    s_add_u32 s49, s36, s11
    s_add_u32 s35, s34, 24576
    s_add_u32 s36, s35, s32
    s_sub_u32 s37, s35, s32
    s_cmp_lt_u32 s35, 73728
    s_cselect_b32 s36, s36, s37
    s_add_u32 s50, s36, s11
    s_add_u32 s35, s34, 28672
    s_add_u32 s36, s35, s32
    s_sub_u32 s37, s35, s32
    s_cmp_lt_u32 s35, 73728
    s_cselect_b32 s36, s36, s37
    s_add_u32 s51, s36, s11
    s_lshl_b32 s35, s6, 12
    s_add_u32 s35, s35, 131072
    s_add_u32 s36, s35, s32
    s_sub_u32 s37, s35, s32
    s_cmp_lt_u32 s35, 73728
    s_cselect_b32 s36, s36, s37
    s_add_u32 s52, s36, s11
    s_mov_b32 s40, 0
    s_mov_b32 s41, 4096
    s_mov_b32 s42, 8192
    s_mov_b32 s43, 12288
    s_lshl_b32 s9, s7, 2
    s_add_u32 s9, s9, s6
pad0_2:
    s_cbranch_execz kf_kernel_done
    s_mul_i32 s9, s9, 331776
    s_mul_i32 s32, s8, 73728
    s_mul_i32 s35, s7, 2359296
    s_add_u32 s35, s35, s32
    s_lshl_b32 s34, s6, 14
    v_add_u32 v2, s34, v1
    s_and_b32 s34, s6, 1
    s_lshl_b32 s34, s34, 3
    s_lshr_b32 s36, s6, 1
    s_lshl_b32 s36, s36, 12
    s_add_u32 s34, s34, s36
    s_add_u32 s34, s34, 65536
    v_add_u32 v3, s34, v1
    s_waitcnt lgkmcnt(0)
    s_add_u32 s16, s4, 0xb00000
    s_addc_u32 s17, s5, 0
    s_and_b32 s17, s17, 0xffff
    s_mov_b32 s18, 0x480000
    s_mov_b32 s19, 0x20000
    s_add_u32 s24, s4, 0x1100000
    s_addc_u32 s25, s5, 0
    s_add_u32 s24, s24, s32
    s_addc_u32 s25, s25, 0
    s_and_b32 s25, s25, 0xffff
    s_mov_b32 s26, 0x12000
    s_mov_b32 s27, 0x20000
    buffer_load_dwordx4 a[0:3], v1, s[16:19], s52 offen offset:0
    buffer_load_dwordx4 a[4:7], v1, s[16:19], s52 offen offset:1024
    buffer_load_dwordx4 a[8:11], v1, s[16:19], s52 offen offset:2048
    buffer_load_dwordx4 a[12:15], v1, s[16:19], s52 offen offset:3072
    s_add_u32 s12, s4, 0x0
    s_addc_u32 s13, s5, 0
    s_add_u32 s12, s12, s9
    s_addc_u32 s13, s13, 0
    s_and_b32 s13, s13, 0xffff
    s_mov_b32 s14, 0x51000
    s_mov_b32 s15, 0x20000
    s_mov_b32 s36, 0
    s_add_u32 s28, s4, 0x1400000
    s_addc_u32 s29, s5, 0
    s_add_u32 s28, s28, s35
    s_addc_u32 s29, s29, 0
    s_and_b32 s29, s29, 0xffff
pad0_3:
    s_cbranch_execz kf_kernel_done
    s_mov_b32 s30, 0x12000
    s_mov_b32 s31, 0x20000
    v_lshl_add_u32 v128, v12, 6, s8
    v_add_u32 v129, 32, v128
    v_lshlrev_b32 v132, 2, v13
    v_cvt_f32_u32 v132, v132
    v_cvt_f32_u32 v128, v128
    v_mul_f32 v128, s33, v128
    v_mul_f32 v130, v128, v132
    v_cvt_f32_u32 v129, v129
    v_mul_f32 v129, s33, v129
    v_mul_f32 v131, v129, v132
    s_mov_b32 s34, 0x80008000
    v_mov_b32 v132, v130
    v_fmamk_f32 v133, v128, 0x3f800000, v130
    v_fmamk_f32 v134, v128, 0x40000000, v130
    v_fmamk_f32 v135, v128, 0x40400000, v130
    v_cos_f32 v136, v132
    v_sin_f32 v140, v132
    v_cos_f32 v137, v133
    v_sin_f32 v141, v133
    v_cos_f32 v138, v134
    v_sin_f32 v142, v134
    v_cos_f32 v139, v135
    v_sin_f32 v143, v135
    v_cvt_pk_bf16_f32 v136, v136, v140
    v_cvt_pk_bf16_f32 v137, v137, v141
    buffer_load_dwordx2 v[224:225], v3, s[24:27], 0 offen offset:0
    v_cvt_pk_bf16_f32 v138, v138, v142
    v_cvt_pk_bf16_f32 v139, v139, v143
    v_accvgpr_write_b32 a192, v136
    v_accvgpr_write_b32 a193, v137
    v_accvgpr_write_b32 a194, v138
    v_accvgpr_write_b32 a195, v139
    v_xor_b32 v137, s34, v137
    v_xor_b32 v139, s34, v139
    v_accvgpr_write_b32 a208, v136
    v_accvgpr_write_b32 a209, v137
    v_accvgpr_write_b32 a210, v138
    v_accvgpr_write_b32 a211, v139
    v_mov_b32 v132, v131
    v_fmamk_f32 v133, v129, 0x3f800000, v131
pad0_4:
    s_cbranch_execz kf_kernel_done
    buffer_load_dwordx2 v[226:227], v3, s[24:27], 0 offen offset:1024
    v_fmamk_f32 v134, v129, 0x40000000, v131
    v_fmamk_f32 v135, v129, 0x40400000, v131
    v_cos_f32 v136, v132
    v_sin_f32 v140, v132
    v_cos_f32 v137, v133
    v_sin_f32 v141, v133
    v_cos_f32 v138, v134
    v_sin_f32 v142, v134
    v_cos_f32 v139, v135
    v_sin_f32 v143, v135
    v_cvt_pk_bf16_f32 v136, v136, v140
    v_cvt_pk_bf16_f32 v137, v137, v141
    v_cvt_pk_bf16_f32 v138, v138, v142
    v_cvt_pk_bf16_f32 v139, v139, v143
    buffer_load_dwordx2 v[228:229], v3, s[24:27], 0 offen offset:2048
    v_accvgpr_write_b32 a224, v136
    v_accvgpr_write_b32 a225, v137
    v_accvgpr_write_b32 a226, v138
    v_accvgpr_write_b32 a227, v139
    v_xor_b32 v137, s34, v137
    v_xor_b32 v139, s34, v139
    v_accvgpr_write_b32 a240, v136
    v_accvgpr_write_b32 a241, v137
    v_accvgpr_write_b32 a242, v138
    v_accvgpr_write_b32 a243, v139
    v_fmamk_f32 v132, v128, 0x41800000, v130
    v_fmamk_f32 v133, v128, 0x41880000, v130
    v_fmamk_f32 v134, v128, 0x41900000, v130
    v_fmamk_f32 v135, v128, 0x41980000, v130
    buffer_load_dwordx2 v[230:231], v3, s[24:27], 0 offen offset:3072
    v_cos_f32 v136, v132
    v_sin_f32 v140, v132
    v_cos_f32 v137, v133
    v_sin_f32 v141, v133
    v_cos_f32 v138, v134
    v_sin_f32 v142, v134
    v_cos_f32 v139, v135
    v_sin_f32 v143, v135
    v_cvt_pk_bf16_f32 v136, v136, v140
pad0_5:
    s_cbranch_execz kf_kernel_done
    v_cvt_pk_bf16_f32 v137, v137, v141
    v_cvt_pk_bf16_f32 v138, v138, v142
    v_cvt_pk_bf16_f32 v139, v139, v143
    v_accvgpr_write_b32 a196, v136
    v_accvgpr_write_b32 a197, v137
    buffer_load_dwordx4 a[16:19], v1, s[16:19], s44 offen offset:0
    v_accvgpr_write_b32 a198, v138
    v_accvgpr_write_b32 a199, v139
    v_xor_b32 v137, s34, v137
    v_xor_b32 v139, s34, v139
    v_accvgpr_write_b32 a212, v136
    v_accvgpr_write_b32 a213, v137
    v_accvgpr_write_b32 a214, v138
    v_accvgpr_write_b32 a215, v139
    v_fmamk_f32 v132, v129, 0x41800000, v131
    v_fmamk_f32 v133, v129, 0x41880000, v131
    v_fmamk_f32 v134, v129, 0x41900000, v131
    v_fmamk_f32 v135, v129, 0x41980000, v131
    v_cos_f32 v136, v132
    v_sin_f32 v140, v132
    buffer_load_dwordx4 a[20:23], v1, s[16:19], s44 offen offset:1024
    v_cos_f32 v137, v133
    v_sin_f32 v141, v133
    v_cos_f32 v138, v134
    v_sin_f32 v142, v134
    v_cos_f32 v139, v135
    v_sin_f32 v143, v135
    v_cvt_pk_bf16_f32 v136, v136, v140
    v_cvt_pk_bf16_f32 v137, v137, v141
    v_cvt_pk_bf16_f32 v138, v138, v142
    v_cvt_pk_bf16_f32 v139, v139, v143
    v_accvgpr_write_b32 a228, v136
    v_accvgpr_write_b32 a229, v137
    v_accvgpr_write_b32 a230, v138
    v_accvgpr_write_b32 a231, v139
    buffer_load_dwordx4 a[24:27], v1, s[16:19], s44 offen offset:2048
    v_xor_b32 v137, s34, v137
pad0_6:
    s_cbranch_execz kf_kernel_done
    v_xor_b32 v139, s34, v139
    v_accvgpr_write_b32 a244, v136
    v_accvgpr_write_b32 a245, v137
    v_accvgpr_write_b32 a246, v138
    v_accvgpr_write_b32 a247, v139
    v_fmamk_f32 v132, v128, 0x42000000, v130
    v_fmamk_f32 v133, v128, 0x42040000, v130
    v_fmamk_f32 v134, v128, 0x42080000, v130
    v_fmamk_f32 v135, v128, 0x420c0000, v130
    v_cos_f32 v136, v132
    v_sin_f32 v140, v132
    v_cos_f32 v137, v133
    v_sin_f32 v141, v133
    buffer_load_dwordx4 a[28:31], v1, s[16:19], s44 offen offset:3072
    v_cos_f32 v138, v134
    v_sin_f32 v142, v134
    v_cos_f32 v139, v135
    v_sin_f32 v143, v135
    v_cvt_pk_bf16_f32 v136, v136, v140
    v_cvt_pk_bf16_f32 v137, v137, v141
    v_cvt_pk_bf16_f32 v138, v138, v142
    v_cvt_pk_bf16_f32 v139, v139, v143
    v_accvgpr_write_b32 a200, v136
    v_accvgpr_write_b32 a201, v137
    v_accvgpr_write_b32 a202, v138
    v_accvgpr_write_b32 a203, v139
    v_xor_b32 v137, s34, v137
    v_xor_b32 v139, s34, v139
    buffer_load_dwordx4 v[160:163], v2, s[24:27], s40 offen offset:0
    v_accvgpr_write_b32 a216, v136
    v_accvgpr_write_b32 a217, v137
    v_accvgpr_write_b32 a218, v138
    v_accvgpr_write_b32 a219, v139
    v_fmamk_f32 v132, v129, 0x42000000, v131
    v_fmamk_f32 v133, v129, 0x42040000, v131
    v_fmamk_f32 v134, v129, 0x42080000, v131
    v_fmamk_f32 v135, v129, 0x420c0000, v131
pad0_7:
    s_cbranch_execz kf_kernel_done
    v_cos_f32 v136, v132
    v_sin_f32 v140, v132
    v_cos_f32 v137, v133
    v_sin_f32 v141, v133
    v_cos_f32 v138, v134
    v_sin_f32 v142, v134
    buffer_load_dwordx4 v[164:167], v2, s[24:27], s40 offen offset:1024
    v_cos_f32 v139, v135
    v_sin_f32 v143, v135
    v_cvt_pk_bf16_f32 v136, v136, v140
    v_cvt_pk_bf16_f32 v137, v137, v141
    v_cvt_pk_bf16_f32 v138, v138, v142
    v_cvt_pk_bf16_f32 v139, v139, v143
    v_accvgpr_write_b32 a232, v136
    v_accvgpr_write_b32 a233, v137
    v_accvgpr_write_b32 a234, v138
    v_accvgpr_write_b32 a235, v139
    v_xor_b32 v137, s34, v137
    v_xor_b32 v139, s34, v139
    v_accvgpr_write_b32 a248, v136
    v_accvgpr_write_b32 a249, v137
    buffer_load_dwordx4 v[168:171], v2, s[24:27], s40 offen offset:2048
    v_accvgpr_write_b32 a250, v138
    v_accvgpr_write_b32 a251, v139
    v_fmamk_f32 v132, v128, 0x42400000, v130
    v_fmamk_f32 v133, v128, 0x42440000, v130
    v_fmamk_f32 v134, v128, 0x42480000, v130
    v_fmamk_f32 v135, v128, 0x424c0000, v130
    v_cos_f32 v136, v132
    v_sin_f32 v140, v132
    v_cos_f32 v137, v133
    v_sin_f32 v141, v133
    v_cos_f32 v138, v134
    v_sin_f32 v142, v134
    v_cos_f32 v139, v135
    v_sin_f32 v143, v135
    buffer_load_dwordx4 v[172:175], v2, s[24:27], s40 offen offset:3072
    v_cvt_pk_bf16_f32 v136, v136, v140
    v_cvt_pk_bf16_f32 v137, v137, v141
    v_cvt_pk_bf16_f32 v138, v138, v142
    v_cvt_pk_bf16_f32 v139, v139, v143
pad0_8:
    s_cbranch_execz kf_kernel_done
    v_accvgpr_write_b32 a204, v136
    v_accvgpr_write_b32 a205, v137
    v_accvgpr_write_b32 a206, v138
    v_accvgpr_write_b32 a207, v139
    v_xor_b32 v137, s34, v137
    v_xor_b32 v139, s34, v139
    v_accvgpr_write_b32 a220, v136
    v_accvgpr_write_b32 a221, v137
    v_accvgpr_write_b32 a222, v138
    v_accvgpr_write_b32 a223, v139
    buffer_load_dwordx4 a[32:35], v1, s[16:19], s45 offen offset:0
    v_fmamk_f32 v132, v129, 0x42400000, v131
    v_fmamk_f32 v133, v129, 0x42440000, v131
    v_fmamk_f32 v134, v129, 0x42480000, v131
    v_fmamk_f32 v135, v129, 0x424c0000, v131
    v_cos_f32 v136, v132
    v_sin_f32 v140, v132
    v_cos_f32 v137, v133
    v_sin_f32 v141, v133
    v_cos_f32 v138, v134
    v_sin_f32 v142, v134
    v_cos_f32 v139, v135
    v_sin_f32 v143, v135
    v_cvt_pk_bf16_f32 v136, v136, v140
    v_cvt_pk_bf16_f32 v137, v137, v141
    buffer_load_dwordx4 a[36:39], v1, s[16:19], s45 offen offset:1024
    v_cvt_pk_bf16_f32 v138, v138, v142
    v_cvt_pk_bf16_f32 v139, v139, v143
    v_accvgpr_write_b32 a236, v136
    v_accvgpr_write_b32 a237, v137
    v_accvgpr_write_b32 a238, v138
    v_accvgpr_write_b32 a239, v139
    v_xor_b32 v137, s34, v137
    v_xor_b32 v139, s34, v139
    v_accvgpr_write_b32 a252, v136
    v_accvgpr_write_b32 a253, v137
    v_accvgpr_write_b32 a254, v138
pad0_9:
    s_cbranch_execz kf_kernel_done
    v_accvgpr_write_b32 a255, v139
    v_and_b32 v128, 1, v12
    v_lshlrev_b32 v128, 4, v128
    v_mov_b32 v129, 0x3f80
    v_lshlrev_b32 v128, v128, v129
    v_lshrrev_b32 v129, 1, v12
    v_lshlrev_b32 v11, 1, v13
    v_cmp_eq_u32 vcc, v129, v11
    s_nop 1
    v_cndmask_b32 v10, 0, v128, vcc
    v_add_u32 v11, 1, v11
    v_cmp_eq_u32 vcc, v129, v11
    s_nop 1
    v_cndmask_b32 v11, 0, v128, vcc
    v_lshrrev_b32 v129, 2, v12
    v_cmp_eq_u32 vcc, v129, v13
    s_lshl_b32 s34, s6, 3
    s_add_u32 s34, s34, 147456
    v_lshl_add_u32 v128, v12, 5, s34
    v_lshlrev_b32 v15, 3, v14
    v_add_u32 v15, 149504, v15
    v_cndmask_b32 v15, v15, v128, vcc
    v_mov_b32 v4, 0x3f803f80
    v_mov_b32 v5, 0x3f803f80
    v_mov_b32 v6, 0x3f803f80
    v_mov_b32 v7, 0x3f803f80
    s_mov_b32 s56, 0x22222222
    s_mov_b32 s57, 0x22222222
    s_mov_b32 s58, 0x44444444
    s_mov_b32 s59, 0x44444444
    s_mov_b32 s60, 0x88888888
    s_mov_b32 s61, 0x88888888
    s_lshr_b32 s63, s2, 3
    s_or_b32 s63, s63, s6
    s_cmp_eq_u32 s7, 0
    s_cselect_b32 s38, 0x10000, 0
    s_cselect_b32 s39, 0xffff0000, 0
    s_waitcnt vmcnt(17)
    v_mfma_f32_16x16x32_bf16 v[144:147], a[0:3], a[192:195], 0
    v_mfma_f32_16x16x32_bf16 v[148:151], a[0:3], a[208:211], 0
    buffer_load_dwordx4 a[40:43], v1, s[16:19], s45 offen offset:2048
    v_mfma_f32_16x16x32_bf16 v[152:155], a[0:3], a[224:227], 0
pad0_10:
    s_cbranch_execz kf_kernel_done
    v_mfma_f32_16x16x32_bf16 v[156:159], a[0:3], a[240:243], 0
    buffer_load_dwordx4 a[44:47], v1, s[16:19], s45 offen offset:3072
    s_waitcnt vmcnt(18)
    v_mfma_f32_16x16x32_bf16 v[144:147], a[4:7], a[196:199], v[144:147]
    v_mfma_f32_16x16x32_bf16 v[148:151], a[4:7], a[212:215], v[148:151]
    buffer_load_dwordx4 a[48:51], v1, s[16:19], s46 offen offset:0
    v_mfma_f32_16x16x32_bf16 v[152:155], a[4:7], a[228:231], v[152:155]
    v_mfma_f32_16x16x32_bf16 v[156:159], a[4:7], a[244:247], v[156:159]
    buffer_load_dwordx4 a[52:55], v1, s[16:19], s46 offen offset:1024
    s_waitcnt vmcnt(19)
    v_mfma_f32_16x16x32_bf16 v[144:147], a[8:11], a[200:203], v[144:147]
    v_mfma_f32_16x16x32_bf16 v[148:151], a[8:11], a[216:219], v[148:151]
    buffer_load_dwordx4 a[56:59], v1, s[16:19], s46 offen offset:2048
    v_mfma_f32_16x16x32_bf16 v[152:155], a[8:11], a[232:235], v[152:155]
    v_mfma_f32_16x16x32_bf16 v[156:159], a[8:11], a[248:251], v[156:159]
    buffer_load_dwordx4 a[60:63], v1, s[16:19], s46 offen offset:3072
    s_waitcnt vmcnt(20)
    v_mfma_f32_16x16x32_bf16 v[144:147], a[12:15], a[204:207], v[144:147]
    v_mfma_f32_16x16x32_bf16 v[148:151], a[12:15], a[220:223], v[148:151]
    buffer_load_dwordx4 v[176:179], v2, s[24:27], s41 offen offset:0
    v_mfma_f32_16x16x32_bf16 v[152:155], a[12:15], a[236:239], v[152:155]
    v_mfma_f32_16x16x32_bf16 v[156:159], a[12:15], a[252:255], v[156:159]
    buffer_load_dwordx4 v[180:183], v2, s[24:27], s41 offen offset:1024
    s_waitcnt vmcnt(18)
    v_mfma_f32_16x16x16_bf16 v[144:147], v[10:11], v[224:225], v[144:147]
    v_mfma_f32_16x16x16_bf16 v[148:151], v[10:11], v[226:227], v[148:151]
    v_mfma_f32_16x16x16_bf16 v[152:155], v[10:11], v[228:229], v[152:155]
    v_mfma_f32_16x16x16_bf16 v[156:159], v[10:11], v[230:231], v[156:159]
    s_waitcnt vmcnt(17)
    v_mfma_f32_16x16x32_bf16 v[16:19], a[16:19], a[192:195], 0
    v_mfma_f32_16x16x32_bf16 v[20:23], a[16:19], a[208:211], 0
    buffer_load_dwordx4 v[184:187], v2, s[24:27], s41 offen offset:2048
    v_mfma_f32_16x16x32_bf16 v[24:27], a[16:19], a[224:227], 0
    v_mfma_f32_16x16x32_bf16 v[28:31], a[16:19], a[240:243], 0
pad0_11:
    s_cbranch_execz kf_kernel_done
    buffer_load_dwordx4 v[188:191], v2, s[24:27], s41 offen offset:3072
    s_waitcnt vmcnt(18)
    v_mfma_f32_16x16x32_bf16 v[16:19], a[20:23], a[196:199], v[16:19]
    v_cvt_pk_bf16_f32 v224, v144, v145
    v_mfma_f32_16x16x32_bf16 v[20:23], a[20:23], a[212:215], v[20:23]
    v_cvt_pk_bf16_f32 v225, v146, v147
    buffer_load_dwordx4 a[64:67], v1, s[16:19], s47 offen offset:0
    v_mfma_f32_16x16x32_bf16 v[24:27], a[20:23], a[228:231], v[24:27]
    v_cvt_pk_bf16_f32 v226, v148, v149
    v_mfma_f32_16x16x32_bf16 v[28:31], a[20:23], a[244:247], v[28:31]
    v_cvt_pk_bf16_f32 v227, v150, v151
    buffer_load_dwordx4 a[68:71], v1, s[16:19], s47 offen offset:1024
    s_waitcnt vmcnt(19)
    v_mfma_f32_16x16x32_bf16 v[16:19], a[24:27], a[200:203], v[16:19]
    v_cvt_pk_bf16_f32 v228, v152, v153
    v_mfma_f32_16x16x32_bf16 v[20:23], a[24:27], a[216:219], v[20:23]
    v_cvt_pk_bf16_f32 v229, v154, v155
    buffer_load_dwordx4 a[72:75], v1, s[16:19], s47 offen offset:2048
    v_mfma_f32_16x16x32_bf16 v[24:27], a[24:27], a[232:235], v[24:27]
    v_cvt_pk_bf16_f32 v230, v156, v157
    v_mfma_f32_16x16x32_bf16 v[28:31], a[24:27], a[248:251], v[28:31]
    v_cvt_pk_bf16_f32 v231, v158, v159
    buffer_load_dwordx4 a[76:79], v1, s[16:19], s47 offen offset:3072
    s_waitcnt vmcnt(20)
    v_mfma_f32_16x16x32_bf16 v[16:19], a[28:31], a[204:207], v[16:19]
    v_mfma_f32_16x16x32_bf16 v[20:23], a[28:31], a[220:223], v[20:23]
    buffer_load_dwordx4 a[80:83], v1, s[16:19], s48 offen offset:0
    v_mfma_f32_16x16x32_bf16 v[24:27], a[28:31], a[236:239], v[24:27]
    v_mfma_f32_16x16x32_bf16 v[28:31], a[28:31], a[252:255], v[28:31]
    buffer_load_dwordx4 a[84:87], v1, s[16:19], s48 offen offset:1024
    v_mfma_f32_16x16x16_bf16 a[160:163], v[4:5], v[224:225], 0
    v_mfma_f32_16x16x16_bf16 a[176:179], v[224:225], v[224:225], 0
    v_mfma_f32_16x16x16_bf16 a[164:167], v[4:5], v[226:227], 0
pad0_12:
    s_cbranch_execz kf_kernel_done
    v_mfma_f32_16x16x16_bf16 a[180:183], v[226:227], v[226:227], 0
    v_mfma_f32_16x16x16_bf16 a[168:171], v[4:5], v[228:229], 0
    v_mfma_f32_16x16x16_bf16 a[184:187], v[228:229], v[228:229], 0
    v_mfma_f32_16x16x16_bf16 a[172:175], v[4:5], v[230:231], 0
    v_mfma_f32_16x16x16_bf16 a[188:191], v[230:231], v[230:231], 0
    s_waitcnt vmcnt(18)
    v_mfma_f32_16x16x16_bf16 v[16:19], v[10:11], v[160:161], v[16:19]
    v_mfma_f32_16x16x16_bf16 v[20:23], v[10:11], v[164:165], v[20:23]
    v_mfma_f32_16x16x16_bf16 v[24:27], v[10:11], v[168:169], v[24:27]
    v_mfma_f32_16x16x16_bf16 v[28:31], v[10:11], v[172:173], v[28:31]
    s_waitcnt vmcnt(17)
    v_mfma_f32_16x16x32_bf16 v[32:35], a[32:35], a[192:195], 0
    v_mfma_f32_16x16x32_bf16 v[36:39], a[32:35], a[208:211], 0
    buffer_load_dwordx4 a[88:91], v1, s[16:19], s48 offen offset:2048
    v_mfma_f32_16x16x32_bf16 v[40:43], a[32:35], a[224:227], 0
    v_mfma_f32_16x16x32_bf16 v[44:47], a[32:35], a[240:243], 0
    buffer_load_dwordx4 a[92:95], v1, s[16:19], s48 offen offset:3072
    s_waitcnt vmcnt(18)
    v_mfma_f32_16x16x32_bf16 v[32:35], a[36:39], a[196:199], v[32:35]
    v_cvt_pk_bf16_f32 v160, v16, v17
    v_mfma_f32_16x16x32_bf16 v[36:39], a[36:39], a[212:215], v[36:39]
    v_cvt_pk_bf16_f32 v161, v18, v19
    buffer_load_dwordx4 v[192:195], v2, s[24:27], s42 offen offset:0
    v_mfma_f32_16x16x32_bf16 v[40:43], a[36:39], a[228:231], v[40:43]
    v_cvt_pk_bf16_f32 v164, v20, v21
    v_mfma_f32_16x16x32_bf16 v[44:47], a[36:39], a[244:247], v[44:47]
    v_cvt_pk_bf16_f32 v165, v22, v23
    buffer_load_dwordx4 v[196:199], v2, s[24:27], s42 offen offset:1024
    s_waitcnt vmcnt(19)
    v_mfma_f32_16x16x32_bf16 v[32:35], a[40:43], a[200:203], v[32:35]
    v_cvt_pk_bf16_f32 v168, v24, v25
    v_mfma_f32_16x16x32_bf16 v[36:39], a[40:43], a[216:219], v[36:39]
    v_cvt_pk_bf16_f32 v169, v26, v27
    buffer_load_dwordx4 v[200:203], v2, s[24:27], s42 offen offset:2048
pad0_13:
    s_cbranch_execz kf_kernel_done
    v_mfma_f32_16x16x32_bf16 v[40:43], a[40:43], a[232:235], v[40:43]
    v_cvt_pk_bf16_f32 v172, v28, v29
    v_mfma_f32_16x16x32_bf16 v[44:47], a[40:43], a[248:251], v[44:47]
    v_cvt_pk_bf16_f32 v173, v30, v31
    buffer_load_dwordx4 v[204:207], v2, s[24:27], s42 offen offset:3072
    s_waitcnt vmcnt(20)
    v_mfma_f32_16x16x32_bf16 v[32:35], a[44:47], a[204:207], v[32:35]
    v_mfma_f32_16x16x32_bf16 v[36:39], a[44:47], a[220:223], v[36:39]
    buffer_load_dwordx4 a[96:99], v1, s[16:19], s49 offen offset:0
    v_mfma_f32_16x16x32_bf16 v[40:43], a[44:47], a[236:239], v[40:43]
    v_mfma_f32_16x16x32_bf16 v[44:47], a[44:47], a[252:255], v[44:47]
    buffer_load_dwordx4 a[100:103], v1, s[16:19], s49 offen offset:1024
    v_mfma_f32_16x16x16_bf16 v[32:35], v[10:11], v[162:163], v[32:35]
    v_mfma_f32_16x16x16_bf16 v[36:39], v[10:11], v[166:167], v[36:39]
    v_mfma_f32_16x16x16_bf16 v[40:43], v[10:11], v[170:171], v[40:43]
    v_mfma_f32_16x16x16_bf16 v[44:47], v[10:11], v[174:175], v[44:47]
    s_waitcnt vmcnt(21)
    v_mfma_f32_16x16x32_bf16 v[48:51], a[48:51], a[192:195], 0
    v_mfma_f32_16x16x32_bf16 v[52:55], a[48:51], a[208:211], 0
    buffer_load_dwordx4 a[104:107], v1, s[16:19], s49 offen offset:2048
    v_mfma_f32_16x16x32_bf16 v[56:59], a[48:51], a[224:227], 0
    v_mfma_f32_16x16x32_bf16 v[60:63], a[48:51], a[240:243], 0
    buffer_load_dwordx4 a[108:111], v1, s[16:19], s49 offen offset:3072
    s_waitcnt vmcnt(22)
    v_mfma_f32_16x16x32_bf16 v[48:51], a[52:55], a[196:199], v[48:51]
    v_cvt_pk_bf16_f32 v162, v32, v33
    v_mfma_f32_16x16x32_bf16 v[52:55], a[52:55], a[212:215], v[52:55]
    v_cvt_pk_bf16_f32 v163, v34, v35
    buffer_load_dwordx4 a[112:115], v1, s[16:19], s50 offen offset:0
    v_mfma_f32_16x16x32_bf16 v[56:59], a[52:55], a[228:231], v[56:59]
    v_cvt_pk_bf16_f32 v166, v36, v37
    v_mfma_f32_16x16x32_bf16 v[60:63], a[52:55], a[244:247], v[60:63]
    v_cvt_pk_bf16_f32 v167, v38, v39
pad0_14:
    s_cbranch_execz kf_kernel_done
    buffer_load_dwordx4 a[116:119], v1, s[16:19], s50 offen offset:1024
    s_waitcnt vmcnt(23)
    v_mfma_f32_16x16x32_bf16 v[48:51], a[56:59], a[200:203], v[48:51]
    v_cvt_pk_bf16_f32 v170, v40, v41
    v_mfma_f32_16x16x32_bf16 v[52:55], a[56:59], a[216:219], v[52:55]
    v_cvt_pk_bf16_f32 v171, v42, v43
    buffer_load_dwordx4 a[120:123], v1, s[16:19], s50 offen offset:2048
    v_mfma_f32_16x16x32_bf16 v[56:59], a[56:59], a[232:235], v[56:59]
    v_cvt_pk_bf16_f32 v174, v44, v45
    v_mfma_f32_16x16x32_bf16 v[60:63], a[56:59], a[248:251], v[60:63]
    v_cvt_pk_bf16_f32 v175, v46, v47
    buffer_load_dwordx4 a[124:127], v1, s[16:19], s50 offen offset:3072
    s_waitcnt vmcnt(24)
    v_mfma_f32_16x16x32_bf16 v[48:51], a[60:63], a[204:207], v[48:51]
    v_mfma_f32_16x16x32_bf16 v[52:55], a[60:63], a[220:223], v[52:55]
    buffer_load_dwordx4 v[208:211], v2, s[24:27], s43 offen offset:0
    v_mfma_f32_16x16x32_bf16 v[56:59], a[60:63], a[236:239], v[56:59]
    v_mfma_f32_16x16x32_bf16 v[60:63], a[60:63], a[252:255], v[60:63]
    buffer_load_dwordx4 v[212:215], v2, s[24:27], s43 offen offset:1024
    v_mfma_f32_16x16x32_bf16 a[160:163], v[4:7], v[160:163], a[160:163]
    v_mfma_f32_16x16x32_bf16 a[176:179], v[160:163], v[160:163], a[176:179]
    v_mfma_f32_16x16x32_bf16 a[164:167], v[4:7], v[164:167], a[164:167]
    v_mfma_f32_16x16x32_bf16 a[180:183], v[164:167], v[164:167], a[180:183]
    v_mfma_f32_16x16x32_bf16 a[168:171], v[4:7], v[168:171], a[168:171]
    v_mfma_f32_16x16x32_bf16 a[184:187], v[168:171], v[168:171], a[184:187]
    v_mfma_f32_16x16x32_bf16 a[172:175], v[4:7], v[172:175], a[172:175]
    v_mfma_f32_16x16x32_bf16 a[188:191], v[172:175], v[172:175], a[188:191]
    s_waitcnt vmcnt(22)
    v_mfma_f32_16x16x16_bf16 v[48:51], v[10:11], v[176:177], v[48:51]
    v_mfma_f32_16x16x16_bf16 v[52:55], v[10:11], v[180:181], v[52:55]
    v_mfma_f32_16x16x16_bf16 v[56:59], v[10:11], v[184:185], v[56:59]
    v_mfma_f32_16x16x16_bf16 v[60:63], v[10:11], v[188:189], v[60:63]
    s_waitcnt vmcnt(21)
pad0_15:
    s_cbranch_execz kf_kernel_done
    v_mfma_f32_16x16x32_bf16 v[64:67], a[64:67], a[192:195], 0
    v_mfma_f32_16x16x32_bf16 v[68:71], a[64:67], a[208:211], 0
    buffer_load_dwordx4 v[216:219], v2, s[24:27], s43 offen offset:2048
    v_mfma_f32_16x16x32_bf16 v[72:75], a[64:67], a[224:227], 0
    v_mfma_f32_16x16x32_bf16 v[76:79], a[64:67], a[240:243], 0
    buffer_load_dwordx4 v[220:223], v2, s[24:27], s43 offen offset:3072
    s_waitcnt vmcnt(22)
    v_mfma_f32_16x16x32_bf16 v[64:67], a[68:71], a[196:199], v[64:67]
    v_cvt_pk_bf16_f32 v176, v48, v49
    v_mfma_f32_16x16x32_bf16 v[68:71], a[68:71], a[212:215], v[68:71]
    v_cvt_pk_bf16_f32 v177, v50, v51
    buffer_load_dwordx4 a[128:131], v1, s[16:19], s51 offen offset:0
    v_mfma_f32_16x16x32_bf16 v[72:75], a[68:71], a[228:231], v[72:75]
    v_cvt_pk_bf16_f32 v180, v52, v53
    v_mfma_f32_16x16x32_bf16 v[76:79], a[68:71], a[244:247], v[76:79]
    v_cvt_pk_bf16_f32 v181, v54, v55
    buffer_load_dwordx4 a[132:135], v1, s[16:19], s51 offen offset:1024
    s_waitcnt vmcnt(23)
    v_mfma_f32_16x16x32_bf16 v[64:67], a[72:75], a[200:203], v[64:67]
    v_cvt_pk_bf16_f32 v184, v56, v57
    v_mfma_f32_16x16x32_bf16 v[68:71], a[72:75], a[216:219], v[68:71]
    v_cvt_pk_bf16_f32 v185, v58, v59
    buffer_load_dwordx4 a[136:139], v1, s[16:19], s51 offen offset:2048
    v_mfma_f32_16x16x32_bf16 v[72:75], a[72:75], a[232:235], v[72:75]
    v_cvt_pk_bf16_f32 v188, v60, v61
    v_mfma_f32_16x16x32_bf16 v[76:79], a[72:75], a[248:251], v[76:79]
    v_cvt_pk_bf16_f32 v189, v62, v63
    buffer_load_dwordx4 a[140:143], v1, s[16:19], s51 offen offset:3072
    s_waitcnt vmcnt(24)
    v_mfma_f32_16x16x32_bf16 v[64:67], a[76:79], a[204:207], v[64:67]
    v_mfma_f32_16x16x32_bf16 v[68:71], a[76:79], a[220:223], v[68:71]
    buffer_load_dwordx4 a[144:147], v1, s[12:15], s36 offen offset:0
    v_mfma_f32_16x16x32_bf16 v[72:75], a[76:79], a[236:239], v[72:75]
pad0_16:
    s_cbranch_execz kf_kernel_done
    v_mfma_f32_16x16x32_bf16 v[76:79], a[76:79], a[252:255], v[76:79]
    buffer_load_dwordx4 a[148:151], v1, s[12:15], s36 offen offset:1024
    v_mfma_f32_16x16x16_bf16 v[64:67], v[10:11], v[178:179], v[64:67]
    v_mfma_f32_16x16x16_bf16 v[68:71], v[10:11], v[182:183], v[68:71]
    v_mfma_f32_16x16x16_bf16 v[72:75], v[10:11], v[186:187], v[72:75]
    v_mfma_f32_16x16x16_bf16 v[76:79], v[10:11], v[190:191], v[76:79]
    s_waitcnt vmcnt(25)
    v_mfma_f32_16x16x32_bf16 v[80:83], a[80:83], a[192:195], 0
    v_mfma_f32_16x16x32_bf16 v[84:87], a[80:83], a[208:211], 0
    buffer_load_dwordx4 a[152:155], v1, s[12:15], s36 offen offset:2048
    v_mfma_f32_16x16x32_bf16 v[88:91], a[80:83], a[224:227], 0
    v_mfma_f32_16x16x32_bf16 v[92:95], a[80:83], a[240:243], 0
    buffer_load_dwordx4 a[156:159], v1, s[12:15], s36 offen offset:3072
    s_waitcnt vmcnt(26)
    v_mfma_f32_16x16x32_bf16 v[80:83], a[84:87], a[196:199], v[80:83]
    v_cvt_pk_bf16_f32 v178, v64, v65
    v_mfma_f32_16x16x32_bf16 v[84:87], a[84:87], a[212:215], v[84:87]
    v_cvt_pk_bf16_f32 v179, v66, v67
    s_add_u32 s36, s36, 4096
    buffer_load_dwordx4 a[0:3], v1, s[12:15], s36 offen offset:0
    v_mfma_f32_16x16x32_bf16 v[88:91], a[84:87], a[228:231], v[88:91]
    v_cvt_pk_bf16_f32 v182, v68, v69
    v_mfma_f32_16x16x32_bf16 v[92:95], a[84:87], a[244:247], v[92:95]
    v_cvt_pk_bf16_f32 v183, v70, v71
    buffer_load_dwordx4 a[4:7], v1, s[12:15], s36 offen offset:1024
    s_waitcnt vmcnt(27)
    v_mfma_f32_16x16x32_bf16 v[80:83], a[88:91], a[200:203], v[80:83]
    v_cvt_pk_bf16_f32 v186, v72, v73
    v_mfma_f32_16x16x32_bf16 v[84:87], a[88:91], a[216:219], v[84:87]
    v_cvt_pk_bf16_f32 v187, v74, v75
    buffer_load_dwordx4 a[8:11], v1, s[12:15], s36 offen offset:2048
    v_mfma_f32_16x16x32_bf16 v[88:91], a[88:91], a[232:235], v[88:91]
    v_cvt_pk_bf16_f32 v190, v76, v77
pad0_17:
    s_cbranch_execz kf_kernel_done
    v_mfma_f32_16x16x32_bf16 v[92:95], a[88:91], a[248:251], v[92:95]
    v_cvt_pk_bf16_f32 v191, v78, v79
    buffer_load_dwordx4 a[12:15], v1, s[12:15], s36 offen offset:3072
    s_waitcnt vmcnt(28)
    v_mfma_f32_16x16x32_bf16 v[80:83], a[92:95], a[204:207], v[80:83]
    v_mfma_f32_16x16x32_bf16 v[84:87], a[92:95], a[220:223], v[84:87]
    s_add_u32 s36, s36, 4096
    buffer_load_dwordx4 a[16:19], v1, s[12:15], s36 offen offset:0
    v_mfma_f32_16x16x32_bf16 v[88:91], a[92:95], a[236:239], v[88:91]
    v_mfma_f32_16x16x32_bf16 v[92:95], a[92:95], a[252:255], v[92:95]
    buffer_load_dwordx4 a[20:23], v1, s[12:15], s36 offen offset:1024
    v_mfma_f32_16x16x32_bf16 a[160:163], v[4:7], v[176:179], a[160:163]
    v_mfma_f32_16x16x32_bf16 a[176:179], v[176:179], v[176:179], a[176:179]
    v_mfma_f32_16x16x32_bf16 a[164:167], v[4:7], v[180:183], a[164:167]
    v_mfma_f32_16x16x32_bf16 a[180:183], v[180:183], v[180:183], a[180:183]
    v_mfma_f32_16x16x32_bf16 a[168:171], v[4:7], v[184:187], a[168:171]
    v_mfma_f32_16x16x32_bf16 a[184:187], v[184:187], v[184:187], a[184:187]
    v_mfma_f32_16x16x32_bf16 a[172:175], v[4:7], v[188:191], a[172:175]
    v_mfma_f32_16x16x32_bf16 a[188:191], v[188:191], v[188:191], a[188:191]
    s_waitcnt vmcnt(26)
    v_mfma_f32_16x16x16_bf16 v[80:83], v[10:11], v[192:193], v[80:83]
    v_mfma_f32_16x16x16_bf16 v[84:87], v[10:11], v[196:197], v[84:87]
    v_mfma_f32_16x16x16_bf16 v[88:91], v[10:11], v[200:201], v[88:91]
    v_mfma_f32_16x16x16_bf16 v[92:95], v[10:11], v[204:205], v[92:95]
    s_waitcnt vmcnt(25)
    v_mfma_f32_16x16x32_bf16 v[96:99], a[96:99], a[192:195], 0
    v_mfma_f32_16x16x32_bf16 v[100:103], a[96:99], a[208:211], 0
    buffer_load_dwordx4 a[24:27], v1, s[12:15], s36 offen offset:2048
    v_mfma_f32_16x16x32_bf16 v[104:107], a[96:99], a[224:227], 0
    v_mfma_f32_16x16x32_bf16 v[108:111], a[96:99], a[240:243], 0
    buffer_load_dwordx4 a[28:31], v1, s[12:15], s36 offen offset:3072
    s_waitcnt vmcnt(26)
    v_mfma_f32_16x16x32_bf16 v[96:99], a[100:103], a[196:199], v[96:99]
    v_cvt_pk_bf16_f32 v192, v80, v81
pad0_18:
    s_cbranch_execz kf_kernel_done
    v_mfma_f32_16x16x32_bf16 v[100:103], a[100:103], a[212:215], v[100:103]
    v_cvt_pk_bf16_f32 v193, v82, v83
    s_add_u32 s36, s36, 4096
    buffer_load_dwordx4 a[32:35], v1, s[12:15], s36 offen offset:0
    v_mfma_f32_16x16x32_bf16 v[104:107], a[100:103], a[228:231], v[104:107]
    v_cvt_pk_bf16_f32 v196, v84, v85
    v_mfma_f32_16x16x32_bf16 v[108:111], a[100:103], a[244:247], v[108:111]
    v_cvt_pk_bf16_f32 v197, v86, v87
    buffer_load_dwordx4 a[36:39], v1, s[12:15], s36 offen offset:1024
    s_waitcnt vmcnt(27)
    v_mfma_f32_16x16x32_bf16 v[96:99], a[104:107], a[200:203], v[96:99]
    v_cvt_pk_bf16_f32 v200, v88, v89
    v_mfma_f32_16x16x32_bf16 v[100:103], a[104:107], a[216:219], v[100:103]
    v_cvt_pk_bf16_f32 v201, v90, v91
    buffer_load_dwordx4 a[40:43], v1, s[12:15], s36 offen offset:2048
    v_mfma_f32_16x16x32_bf16 v[104:107], a[104:107], a[232:235], v[104:107]
    v_cvt_pk_bf16_f32 v204, v92, v93
    v_mfma_f32_16x16x32_bf16 v[108:111], a[104:107], a[248:251], v[108:111]
    v_cvt_pk_bf16_f32 v205, v94, v95
    buffer_load_dwordx4 a[44:47], v1, s[12:15], s36 offen offset:3072
    s_waitcnt vmcnt(28)
    v_mfma_f32_16x16x32_bf16 v[96:99], a[108:111], a[204:207], v[96:99]
    v_mfma_f32_16x16x32_bf16 v[100:103], a[108:111], a[220:223], v[100:103]
    s_add_u32 s36, s36, 4096
    buffer_load_dwordx4 a[48:51], v1, s[12:15], s36 offen offset:0
    v_mfma_f32_16x16x32_bf16 v[104:107], a[108:111], a[236:239], v[104:107]
    v_mfma_f32_16x16x32_bf16 v[108:111], a[108:111], a[252:255], v[108:111]
    buffer_load_dwordx4 a[52:55], v1, s[12:15], s36 offen offset:1024
    v_mfma_f32_16x16x16_bf16 v[96:99], v[10:11], v[194:195], v[96:99]
    v_mfma_f32_16x16x16_bf16 v[100:103], v[10:11], v[198:199], v[100:103]
    v_mfma_f32_16x16x16_bf16 v[104:107], v[10:11], v[202:203], v[104:107]
    v_mfma_f32_16x16x16_bf16 v[108:111], v[10:11], v[206:207], v[108:111]
pad0_19:
    s_cbranch_execz kf_kernel_done
    s_waitcnt vmcnt(29)
    v_mfma_f32_16x16x32_bf16 v[112:115], a[112:115], a[192:195], 0
    v_mfma_f32_16x16x32_bf16 v[116:119], a[112:115], a[208:211], 0
    buffer_load_dwordx4 a[56:59], v1, s[12:15], s36 offen offset:2048
    v_mfma_f32_16x16x32_bf16 v[120:123], a[112:115], a[224:227], 0
    v_mfma_f32_16x16x32_bf16 v[124:127], a[112:115], a[240:243], 0
    buffer_load_dwordx4 a[60:63], v1, s[12:15], s36 offen offset:3072
    s_waitcnt vmcnt(30)
    v_mfma_f32_16x16x32_bf16 v[112:115], a[116:119], a[196:199], v[112:115]
    v_cvt_pk_bf16_f32 v194, v96, v97
    v_mfma_f32_16x16x32_bf16 v[116:119], a[116:119], a[212:215], v[116:119]
    v_cvt_pk_bf16_f32 v195, v98, v99
    s_add_u32 s36, s36, 4096
    buffer_load_dwordx4 a[64:67], v1, s[12:15], s36 offen offset:0
    v_mfma_f32_16x16x32_bf16 v[120:123], a[116:119], a[228:231], v[120:123]
    v_cvt_pk_bf16_f32 v198, v100, v101
    v_mfma_f32_16x16x32_bf16 v[124:127], a[116:119], a[244:247], v[124:127]
    v_cvt_pk_bf16_f32 v199, v102, v103
    buffer_load_dwordx4 a[68:71], v1, s[12:15], s36 offen offset:1024
    s_waitcnt vmcnt(31)
    v_mfma_f32_16x16x32_bf16 v[112:115], a[120:123], a[200:203], v[112:115]
    v_cvt_pk_bf16_f32 v202, v104, v105
    v_mfma_f32_16x16x32_bf16 v[116:119], a[120:123], a[216:219], v[116:119]
    v_cvt_pk_bf16_f32 v203, v106, v107
    buffer_load_dwordx4 a[72:75], v1, s[12:15], s36 offen offset:2048
    v_mfma_f32_16x16x32_bf16 v[120:123], a[120:123], a[232:235], v[120:123]
    v_cvt_pk_bf16_f32 v206, v108, v109
    v_mfma_f32_16x16x32_bf16 v[124:127], a[120:123], a[248:251], v[124:127]
    v_cvt_pk_bf16_f32 v207, v110, v111
    buffer_load_dwordx4 a[76:79], v1, s[12:15], s36 offen offset:3072
    s_waitcnt vmcnt(32)
    v_mfma_f32_16x16x32_bf16 v[112:115], a[124:127], a[204:207], v[112:115]
    v_mfma_f32_16x16x32_bf16 v[116:119], a[124:127], a[220:223], v[116:119]
    s_add_u32 s36, s36, 4096
pad0_20:
    s_cbranch_execz kf_kernel_done
    buffer_load_dwordx4 a[80:83], v1, s[12:15], s36 offen offset:0
    v_mfma_f32_16x16x32_bf16 v[120:123], a[124:127], a[236:239], v[120:123]
    v_mfma_f32_16x16x32_bf16 v[124:127], a[124:127], a[252:255], v[124:127]
    buffer_load_dwordx4 a[84:87], v1, s[12:15], s36 offen offset:1024
    v_mfma_f32_16x16x32_bf16 a[160:163], v[4:7], v[192:195], a[160:163]
    v_mfma_f32_16x16x32_bf16 a[176:179], v[192:195], v[192:195], a[176:179]
    v_mfma_f32_16x16x32_bf16 a[164:167], v[4:7], v[196:199], a[164:167]
    v_mfma_f32_16x16x32_bf16 a[180:183], v[196:199], v[196:199], a[180:183]
    v_mfma_f32_16x16x32_bf16 a[168:171], v[4:7], v[200:203], a[168:171]
    v_mfma_f32_16x16x32_bf16 a[184:187], v[200:203], v[200:203], a[184:187]
    v_mfma_f32_16x16x32_bf16 a[172:175], v[4:7], v[204:207], a[172:175]
    v_mfma_f32_16x16x32_bf16 a[188:191], v[204:207], v[204:207], a[188:191]
    s_waitcnt vmcnt(30)
    v_mfma_f32_16x16x16_bf16 v[112:115], v[10:11], v[208:209], v[112:115]
    v_mfma_f32_16x16x16_bf16 v[116:119], v[10:11], v[212:213], v[116:119]
    v_mfma_f32_16x16x16_bf16 v[120:123], v[10:11], v[216:217], v[120:123]
    v_mfma_f32_16x16x16_bf16 v[124:127], v[10:11], v[220:221], v[124:127]
    s_waitcnt vmcnt(29)
    v_mfma_f32_16x16x32_bf16 v[128:131], a[128:131], a[192:195], 0
    v_mfma_f32_16x16x32_bf16 v[132:135], a[128:131], a[208:211], 0
    buffer_load_dwordx4 a[88:91], v1, s[12:15], s36 offen offset:2048
    v_mfma_f32_16x16x32_bf16 v[136:139], a[128:131], a[224:227], 0
    v_mfma_f32_16x16x32_bf16 v[140:143], a[128:131], a[240:243], 0
    buffer_load_dwordx4 a[92:95], v1, s[12:15], s36 offen offset:3072
    s_waitcnt vmcnt(30)
    v_mfma_f32_16x16x32_bf16 v[128:131], a[132:135], a[196:199], v[128:131]
    v_cvt_pk_bf16_f32 v208, v112, v113
    v_mfma_f32_16x16x32_bf16 v[132:135], a[132:135], a[212:215], v[132:135]
    v_cvt_pk_bf16_f32 v209, v114, v115
    s_add_u32 s36, s36, 4096
    buffer_load_dwordx4 a[96:99], v1, s[12:15], s36 offen offset:0
    v_mfma_f32_16x16x32_bf16 v[136:139], a[132:135], a[228:231], v[136:139]
    v_cvt_pk_bf16_f32 v212, v116, v117
pad0_21:
    s_cbranch_execz kf_kernel_done
    v_mfma_f32_16x16x32_bf16 v[140:143], a[132:135], a[244:247], v[140:143]
    v_cvt_pk_bf16_f32 v213, v118, v119
    buffer_load_dwordx4 a[100:103], v1, s[12:15], s36 offen offset:1024
    s_waitcnt vmcnt(31)
    v_mfma_f32_16x16x32_bf16 v[128:131], a[136:139], a[200:203], v[128:131]
    v_cvt_pk_bf16_f32 v216, v120, v121
    v_mfma_f32_16x16x32_bf16 v[132:135], a[136:139], a[216:219], v[132:135]
    v_cvt_pk_bf16_f32 v217, v122, v123
    buffer_load_dwordx4 a[104:107], v1, s[12:15], s36 offen offset:2048
    v_mfma_f32_16x16x32_bf16 v[136:139], a[136:139], a[232:235], v[136:139]
    v_cvt_pk_bf16_f32 v220, v124, v125
    v_mfma_f32_16x16x32_bf16 v[140:143], a[136:139], a[248:251], v[140:143]
    v_cvt_pk_bf16_f32 v221, v126, v127
    buffer_load_dwordx4 a[108:111], v1, s[12:15], s36 offen offset:3072
    s_waitcnt vmcnt(32)
    v_mfma_f32_16x16x32_bf16 v[128:131], a[140:143], a[204:207], v[128:131]
    v_mfma_f32_16x16x32_bf16 v[132:135], a[140:143], a[220:223], v[132:135]
    s_add_u32 s36, s36, 4096
    buffer_load_dwordx4 a[112:115], v1, s[12:15], s36 offen offset:0
    v_mfma_f32_16x16x32_bf16 v[136:139], a[140:143], a[236:239], v[136:139]
    v_mfma_f32_16x16x32_bf16 v[140:143], a[140:143], a[252:255], v[140:143]
    buffer_load_dwordx4 a[116:119], v1, s[12:15], s36 offen offset:1024
    v_mfma_f32_16x16x16_bf16 v[128:131], v[10:11], v[210:211], v[128:131]
    v_mfma_f32_16x16x16_bf16 v[132:135], v[10:11], v[214:215], v[132:135]
    v_mfma_f32_16x16x16_bf16 v[136:139], v[10:11], v[218:219], v[136:139]
    v_mfma_f32_16x16x16_bf16 v[140:143], v[10:11], v[222:223], v[140:143]
    s_nop 4
    v_cvt_pk_bf16_f32 v210, v128, v129
    v_cvt_pk_bf16_f32 v211, v130, v131
    v_cvt_pk_bf16_f32 v214, v132, v133
    v_cvt_pk_bf16_f32 v215, v134, v135
    v_cvt_pk_bf16_f32 v218, v136, v137
    v_cvt_pk_bf16_f32 v219, v138, v139
pad0_22:
    s_cbranch_execz kf_kernel_done
    v_cvt_pk_bf16_f32 v222, v140, v141
    v_cvt_pk_bf16_f32 v223, v142, v143
    v_mfma_f32_16x16x32_bf16 a[160:163], v[4:7], v[208:211], a[160:163]
    v_mfma_f32_16x16x32_bf16 a[176:179], v[208:211], v[208:211], a[176:179]
    v_mfma_f32_16x16x32_bf16 a[164:167], v[4:7], v[212:215], a[164:167]
    v_mfma_f32_16x16x32_bf16 a[180:183], v[212:215], v[212:215], a[180:183]
    v_mfma_f32_16x16x32_bf16 a[168:171], v[4:7], v[216:219], a[168:171]
    v_mfma_f32_16x16x32_bf16 a[184:187], v[216:219], v[216:219], a[184:187]
    v_mfma_f32_16x16x32_bf16 a[172:175], v[4:7], v[220:223], a[172:175]
    v_mfma_f32_16x16x32_bf16 a[188:191], v[220:223], v[220:223], a[188:191]
    v_add_u32 v4, 73728, v2
    v_add_u32 v5, 73728, v3
    v_add_u32 v6, 65536, v1
    v_add_u32 v7, 131072, v1
    v_lshlrev_b32 v11, 5, v14
    v_add_u32 v11, 147456, v11
    s_lshl_b32 s34, s6, 9
    s_add_u32 s34, s34, 149504
    v_lshl_add_u32 v13, v12, 3, s34
    v_lshl_add_u32 v12, v14, 3, s34
    v_accvgpr_read_b32 v232, a160
    v_accvgpr_read_b32 v233, a176
    v_accvgpr_read_b32 v234, a177
    v_accvgpr_read_b32 v235, a178
    v_accvgpr_read_b32 v236, a179
    v_cndmask_b32 v233, v233, v234, s[56:57]
    v_cndmask_b32 v233, v233, v235, s[58:59]
    v_cndmask_b32 v233, v233, v236, s[60:61]
    ds_write_b64 v15, v[232:233] offset:0
    v_accvgpr_read_b32 v238, a164
    v_accvgpr_read_b32 v239, a180
    v_accvgpr_read_b32 v240, a181
pad0_23:
    s_cbranch_execz kf_kernel_done
    v_accvgpr_read_b32 v241, a182
    v_accvgpr_read_b32 v242, a183
    v_cndmask_b32 v239, v239, v240, s[56:57]
    v_cndmask_b32 v239, v239, v241, s[58:59]
    v_cndmask_b32 v239, v239, v242, s[60:61]
    ds_write_b64 v15, v[238:239] offset:512
    v_accvgpr_read_b32 v244, a168
    v_accvgpr_read_b32 v245, a184
    v_accvgpr_read_b32 v246, a185
    v_accvgpr_read_b32 v247, a186
    v_accvgpr_read_b32 v248, a187
    v_cndmask_b32 v245, v245, v246, s[56:57]
    v_cndmask_b32 v245, v245, v247, s[58:59]
    v_cndmask_b32 v245, v245, v248, s[60:61]
    ds_write_b64 v15, v[244:245] offset:1024
    v_accvgpr_read_b32 v250, a172
    v_accvgpr_read_b32 v251, a188
    v_accvgpr_read_b32 v252, a189
    v_accvgpr_read_b32 v253, a190
    v_accvgpr_read_b32 v254, a191
    v_cndmask_b32 v251, v251, v252, s[56:57]
    v_cndmask_b32 v251, v251, v253, s[58:59]
    v_cndmask_b32 v251, v251, v254, s[60:61]
    ds_write_b64 v15, v[250:251] offset:1536
    buffer_load_dwordx4 a[120:123], v1, s[12:15], s36 offen offset:2048
    buffer_load_dwordx4 a[124:127], v1, s[12:15], s36 offen offset:3072
    s_add_u32 s36, s36, 4096
    buffer_load_dwordx4 a[128:131], v1, s[12:15], s36 offen offset:0
    buffer_load_dwordx4 a[132:135], v1, s[12:15], s36 offen offset:1024
    buffer_load_dwordx4 a[136:139], v1, s[12:15], s36 offen offset:2048
    buffer_load_dwordx4 a[140:143], v1, s[12:15], s36 offen offset:3072
    s_add_u32 s36, s36, 4096
pad0_24:
    s_cbranch_execz kf_kernel_done
    buffer_load_dwordx4 a[160:163], v1, s[12:15], s36 offen offset:0
    buffer_load_dwordx4 a[164:167], v1, s[12:15], s36 offen offset:1024
    buffer_load_dwordx4 a[168:171], v1, s[12:15], s36 offen offset:2048
    buffer_load_dwordx4 a[172:175], v1, s[12:15], s36 offen offset:3072
    s_add_u32 s36, s36, 4096
    buffer_load_dwordx4 a[176:179], v1, s[12:15], s36 offen offset:0
    buffer_load_dwordx4 a[180:183], v1, s[12:15], s36 offen offset:1024
    buffer_load_dwordx4 a[184:187], v1, s[12:15], s36 offen offset:2048
    buffer_load_dwordx4 a[188:191], v1, s[12:15], s36 offen offset:3072
    s_waitcnt lgkmcnt(0)
    s_barrier
    ds_read_b128 v[232:235], v11
    ds_read_b128 v[236:239], v11 offset:16
    s_waitcnt lgkmcnt(0)
    v_pk_add_f32 v[232:233], v[232:233], v[234:235]
    v_pk_add_f32 v[236:237], v[236:237], v[238:239]
    v_pk_add_f32 v[232:233], v[232:233], v[236:237]
    v_mul_f32 v232, 0x3ae38e39, v232
    v_mul_f32 v233, 0x3ae38e39, v233
    v_fma_f32 v233, -v232, v232, v233
    v_max_f32 v233, 0, v233
    v_cvt_pk_bf16_f32 v234, v232, v233
    v_lshlrev_b32 v232, 16, v234
    v_and_b32 v233, 0xffff0000, v234
    v_add_f32 v233, 0x3727c5ac, v233
    v_cvt_pk_bf16_f32 v234, v233, v233
    v_and_b32 v233, 0xffff0000, v234
    v_sqrt_f32 v233, v233
    s_nop 0
    v_cvt_pk_bf16_f32 v234, v233, v233
    v_and_b32 v233, 0xffff0000, v234
    v_rcp_f32 v236, v233
    s_nop 0
    v_mul_f32 v237, -v232, v236
    ds_write_b64 v12, v[236:237]
    ds_read_b64 v[248:249], v13 offset:0
pad0_25:
    s_cbranch_execz kf_kernel_done
    ds_read_b64 v[250:251], v13 offset:128
    ds_read_b64 v[252:253], v13 offset:256
    ds_read_b64 v[254:255], v13 offset:384
    s_waitcnt lgkmcnt(3)
    v_pk_fma_f32 v[16:17], v[16:17], v[248:249], v[248:249] op_sel:[0,0,1] op_sel_hi:[1,0,1]
    v_pk_fma_f32 v[18:19], v[18:19], v[248:249], v[248:249] op_sel:[0,0,1] op_sel_hi:[1,0,1]
    v_pk_fma_f32 v[32:33], v[32:33], v[248:249], v[248:249] op_sel:[0,0,1] op_sel_hi:[1,0,1]
    v_pk_fma_f32 v[34:35], v[34:35], v[248:249], v[248:249] op_sel:[0,0,1] op_sel_hi:[1,0,1]
    v_cvt_pk_bf16_f32 v232, v16, v17
    v_cvt_pk_bf16_f32 v233, v18, v19
    v_cvt_pk_bf16_f32 v234, v32, v33
    v_cvt_pk_bf16_f32 v235, v34, v35
    ds_write_b128 v2, v[232:235] offset:0
    v_pk_fma_f32 v[48:49], v[48:49], v[248:249], v[248:249] op_sel:[0,0,1] op_sel_hi:[1,0,1]
    v_pk_fma_f32 v[50:51], v[50:51], v[248:249], v[248:249] op_sel:[0,0,1] op_sel_hi:[1,0,1]
    v_pk_fma_f32 v[64:65], v[64:65], v[248:249], v[248:249] op_sel:[0,0,1] op_sel_hi:[1,0,1]
    v_pk_fma_f32 v[66:67], v[66:67], v[248:249], v[248:249] op_sel:[0,0,1] op_sel_hi:[1,0,1]
    v_cvt_pk_bf16_f32 v236, v48, v49
    v_cvt_pk_bf16_f32 v237, v50, v51
    v_cvt_pk_bf16_f32 v238, v64, v65
    v_cvt_pk_bf16_f32 v239, v66, v67
    ds_write_b128 v2, v[236:239] offset:4096
    v_pk_fma_f32 v[80:81], v[80:81], v[248:249], v[248:249] op_sel:[0,0,1] op_sel_hi:[1,0,1]
    v_pk_fma_f32 v[82:83], v[82:83], v[248:249], v[248:249] op_sel:[0,0,1] op_sel_hi:[1,0,1]
    v_pk_fma_f32 v[96:97], v[96:97], v[248:249], v[248:249] op_sel:[0,0,1] op_sel_hi:[1,0,1]
    v_pk_fma_f32 v[98:99], v[98:99], v[248:249], v[248:249] op_sel:[0,0,1] op_sel_hi:[1,0,1]
    v_cvt_pk_bf16_f32 v240, v80, v81
    v_cvt_pk_bf16_f32 v241, v82, v83
    v_cvt_pk_bf16_f32 v242, v96, v97
    v_cvt_pk_bf16_f32 v243, v98, v99
    ds_write_b128 v2, v[240:243] offset:8192
    v_pk_fma_f32 v[112:113], v[112:113], v[248:249], v[248:249] op_sel:[0,0,1] op_sel_hi:[1,0,1]
pad0_26:
    s_cbranch_execz kf_kernel_done
    v_pk_fma_f32 v[114:115], v[114:115], v[248:249], v[248:249] op_sel:[0,0,1] op_sel_hi:[1,0,1]
    v_pk_fma_f32 v[128:129], v[128:129], v[248:249], v[248:249] op_sel:[0,0,1] op_sel_hi:[1,0,1]
    v_pk_fma_f32 v[130:131], v[130:131], v[248:249], v[248:249] op_sel:[0,0,1] op_sel_hi:[1,0,1]
    v_cvt_pk_bf16_f32 v244, v112, v113
    v_cvt_pk_bf16_f32 v245, v114, v115
    v_cvt_pk_bf16_f32 v246, v128, v129
    v_cvt_pk_bf16_f32 v247, v130, v131
    ds_write_b128 v2, v[244:247] offset:12288
    v_pk_fma_f32 v[144:145], v[144:145], v[248:249], v[248:249] op_sel:[0,0,1] op_sel_hi:[1,0,1]
    v_pk_fma_f32 v[146:147], v[146:147], v[248:249], v[248:249] op_sel:[0,0,1] op_sel_hi:[1,0,1]
    v_cvt_pk_bf16_f32 v232, v144, v145
    v_cvt_pk_bf16_f32 v233, v146, v147
    ds_write_b64 v3, v[232:233] offset:0
    s_waitcnt lgkmcnt(7)
    v_pk_fma_f32 v[20:21], v[20:21], v[250:251], v[250:251] op_sel:[0,0,1] op_sel_hi:[1,0,1]
    v_pk_fma_f32 v[22:23], v[22:23], v[250:251], v[250:251] op_sel:[0,0,1] op_sel_hi:[1,0,1]
    v_pk_fma_f32 v[36:37], v[36:37], v[250:251], v[250:251] op_sel:[0,0,1] op_sel_hi:[1,0,1]
    v_pk_fma_f32 v[38:39], v[38:39], v[250:251], v[250:251] op_sel:[0,0,1] op_sel_hi:[1,0,1]
    v_cvt_pk_bf16_f32 v236, v20, v21
    v_cvt_pk_bf16_f32 v237, v22, v23
    v_cvt_pk_bf16_f32 v238, v36, v37
    v_cvt_pk_bf16_f32 v239, v38, v39
    ds_write_b128 v2, v[236:239] offset:1024
    v_pk_fma_f32 v[52:53], v[52:53], v[250:251], v[250:251] op_sel:[0,0,1] op_sel_hi:[1,0,1]
    v_pk_fma_f32 v[54:55], v[54:55], v[250:251], v[250:251] op_sel:[0,0,1] op_sel_hi:[1,0,1]
    v_pk_fma_f32 v[68:69], v[68:69], v[250:251], v[250:251] op_sel:[0,0,1] op_sel_hi:[1,0,1]
    v_pk_fma_f32 v[70:71], v[70:71], v[250:251], v[250:251] op_sel:[0,0,1] op_sel_hi:[1,0,1]
    v_cvt_pk_bf16_f32 v240, v52, v53
    v_cvt_pk_bf16_f32 v241, v54, v55
    v_cvt_pk_bf16_f32 v242, v68, v69
    v_cvt_pk_bf16_f32 v243, v70, v71
    ds_write_b128 v2, v[240:243] offset:5120
pad0_27:
    s_cbranch_execz kf_kernel_done
    v_pk_fma_f32 v[84:85], v[84:85], v[250:251], v[250:251] op_sel:[0,0,1] op_sel_hi:[1,0,1]
    v_pk_fma_f32 v[86:87], v[86:87], v[250:251], v[250:251] op_sel:[0,0,1] op_sel_hi:[1,0,1]
    v_pk_fma_f32 v[100:101], v[100:101], v[250:251], v[250:251] op_sel:[0,0,1] op_sel_hi:[1,0,1]
    v_pk_fma_f32 v[102:103], v[102:103], v[250:251], v[250:251] op_sel:[0,0,1] op_sel_hi:[1,0,1]
    v_cvt_pk_bf16_f32 v244, v84, v85
    v_cvt_pk_bf16_f32 v245, v86, v87
    v_cvt_pk_bf16_f32 v246, v100, v101
    v_cvt_pk_bf16_f32 v247, v102, v103
    ds_write_b128 v2, v[244:247] offset:9216
    v_pk_fma_f32 v[116:117], v[116:117], v[250:251], v[250:251] op_sel:[0,0,1] op_sel_hi:[1,0,1]
    v_pk_fma_f32 v[118:119], v[118:119], v[250:251], v[250:251] op_sel:[0,0,1] op_sel_hi:[1,0,1]
    v_pk_fma_f32 v[132:133], v[132:133], v[250:251], v[250:251] op_sel:[0,0,1] op_sel_hi:[1,0,1]
    v_pk_fma_f32 v[134:135], v[134:135], v[250:251], v[250:251] op_sel:[0,0,1] op_sel_hi:[1,0,1]
    v_cvt_pk_bf16_f32 v232, v116, v117
    v_cvt_pk_bf16_f32 v233, v118, v119
    v_cvt_pk_bf16_f32 v234, v132, v133
    v_cvt_pk_bf16_f32 v235, v134, v135
    ds_write_b128 v2, v[232:235] offset:13312
    v_pk_fma_f32 v[148:149], v[148:149], v[250:251], v[250:251] op_sel:[0,0,1] op_sel_hi:[1,0,1]
    v_pk_fma_f32 v[150:151], v[150:151], v[250:251], v[250:251] op_sel:[0,0,1] op_sel_hi:[1,0,1]
    v_cvt_pk_bf16_f32 v236, v148, v149
    v_cvt_pk_bf16_f32 v237, v150, v151
    ds_write_b64 v3, v[236:237] offset:1024
    s_waitcnt lgkmcnt(11)
    v_pk_fma_f32 v[24:25], v[24:25], v[252:253], v[252:253] op_sel:[0,0,1] op_sel_hi:[1,0,1]
    v_pk_fma_f32 v[26:27], v[26:27], v[252:253], v[252:253] op_sel:[0,0,1] op_sel_hi:[1,0,1]
    v_pk_fma_f32 v[40:41], v[40:41], v[252:253], v[252:253] op_sel:[0,0,1] op_sel_hi:[1,0,1]
    v_pk_fma_f32 v[42:43], v[42:43], v[252:253], v[252:253] op_sel:[0,0,1] op_sel_hi:[1,0,1]
    v_cvt_pk_bf16_f32 v240, v24, v25
    v_cvt_pk_bf16_f32 v241, v26, v27
    v_cvt_pk_bf16_f32 v242, v40, v41
    v_cvt_pk_bf16_f32 v243, v42, v43
pad0_28:
    s_cbranch_execz kf_kernel_done
    ds_write_b128 v2, v[240:243] offset:2048
    v_pk_fma_f32 v[56:57], v[56:57], v[252:253], v[252:253] op_sel:[0,0,1] op_sel_hi:[1,0,1]
    v_pk_fma_f32 v[58:59], v[58:59], v[252:253], v[252:253] op_sel:[0,0,1] op_sel_hi:[1,0,1]
    v_pk_fma_f32 v[72:73], v[72:73], v[252:253], v[252:253] op_sel:[0,0,1] op_sel_hi:[1,0,1]
    v_pk_fma_f32 v[74:75], v[74:75], v[252:253], v[252:253] op_sel:[0,0,1] op_sel_hi:[1,0,1]
    v_cvt_pk_bf16_f32 v244, v56, v57
    v_cvt_pk_bf16_f32 v245, v58, v59
    v_cvt_pk_bf16_f32 v246, v72, v73
    v_cvt_pk_bf16_f32 v247, v74, v75
    s_waitcnt lgkmcnt(0)
    ds_write_b128 v2, v[244:247] offset:6144
    v_pk_fma_f32 v[88:89], v[88:89], v[252:253], v[252:253] op_sel:[0,0,1] op_sel_hi:[1,0,1]
    v_pk_fma_f32 v[90:91], v[90:91], v[252:253], v[252:253] op_sel:[0,0,1] op_sel_hi:[1,0,1]
    v_pk_fma_f32 v[104:105], v[104:105], v[252:253], v[252:253] op_sel:[0,0,1] op_sel_hi:[1,0,1]
    v_pk_fma_f32 v[106:107], v[106:107], v[252:253], v[252:253] op_sel:[0,0,1] op_sel_hi:[1,0,1]
    v_cvt_pk_bf16_f32 v232, v88, v89
    v_cvt_pk_bf16_f32 v233, v90, v91
    v_cvt_pk_bf16_f32 v234, v104, v105
    v_cvt_pk_bf16_f32 v235, v106, v107
    ds_write_b128 v2, v[232:235] offset:10240
    v_pk_fma_f32 v[120:121], v[120:121], v[252:253], v[252:253] op_sel:[0,0,1] op_sel_hi:[1,0,1]
    v_pk_fma_f32 v[122:123], v[122:123], v[252:253], v[252:253] op_sel:[0,0,1] op_sel_hi:[1,0,1]
    v_pk_fma_f32 v[136:137], v[136:137], v[252:253], v[252:253] op_sel:[0,0,1] op_sel_hi:[1,0,1]
    v_pk_fma_f32 v[138:139], v[138:139], v[252:253], v[252:253] op_sel:[0,0,1] op_sel_hi:[1,0,1]
    v_cvt_pk_bf16_f32 v236, v120, v121
    v_cvt_pk_bf16_f32 v237, v122, v123
    v_cvt_pk_bf16_f32 v238, v136, v137
    v_cvt_pk_bf16_f32 v239, v138, v139
    ds_write_b128 v2, v[236:239] offset:14336
    v_pk_fma_f32 v[152:153], v[152:153], v[252:253], v[252:253] op_sel:[0,0,1] op_sel_hi:[1,0,1]
    v_pk_fma_f32 v[154:155], v[154:155], v[252:253], v[252:253] op_sel:[0,0,1] op_sel_hi:[1,0,1]
    v_cvt_pk_bf16_f32 v240, v152, v153
pad0_29:
    s_cbranch_execz kf_kernel_done
    v_cvt_pk_bf16_f32 v241, v154, v155
    ds_write_b64 v3, v[240:241] offset:2048
    v_pk_fma_f32 v[28:29], v[28:29], v[254:255], v[254:255] op_sel:[0,0,1] op_sel_hi:[1,0,1]
    v_pk_fma_f32 v[30:31], v[30:31], v[254:255], v[254:255] op_sel:[0,0,1] op_sel_hi:[1,0,1]
    v_pk_fma_f32 v[44:45], v[44:45], v[254:255], v[254:255] op_sel:[0,0,1] op_sel_hi:[1,0,1]
    v_pk_fma_f32 v[46:47], v[46:47], v[254:255], v[254:255] op_sel:[0,0,1] op_sel_hi:[1,0,1]
    v_cvt_pk_bf16_f32 v244, v28, v29
    v_cvt_pk_bf16_f32 v245, v30, v31
    v_cvt_pk_bf16_f32 v246, v44, v45
    v_cvt_pk_bf16_f32 v247, v46, v47
    ds_write_b128 v2, v[244:247] offset:3072
    v_pk_fma_f32 v[60:61], v[60:61], v[254:255], v[254:255] op_sel:[0,0,1] op_sel_hi:[1,0,1]
    v_pk_fma_f32 v[62:63], v[62:63], v[254:255], v[254:255] op_sel:[0,0,1] op_sel_hi:[1,0,1]
    v_pk_fma_f32 v[76:77], v[76:77], v[254:255], v[254:255] op_sel:[0,0,1] op_sel_hi:[1,0,1]
    v_pk_fma_f32 v[78:79], v[78:79], v[254:255], v[254:255] op_sel:[0,0,1] op_sel_hi:[1,0,1]
    v_cvt_pk_bf16_f32 v232, v60, v61
    v_cvt_pk_bf16_f32 v233, v62, v63
    v_cvt_pk_bf16_f32 v234, v76, v77
    v_cvt_pk_bf16_f32 v235, v78, v79
    ds_write_b128 v2, v[232:235] offset:7168
    v_pk_fma_f32 v[92:93], v[92:93], v[254:255], v[254:255] op_sel:[0,0,1] op_sel_hi:[1,0,1]
    v_pk_fma_f32 v[94:95], v[94:95], v[254:255], v[254:255] op_sel:[0,0,1] op_sel_hi:[1,0,1]
    v_pk_fma_f32 v[108:109], v[108:109], v[254:255], v[254:255] op_sel:[0,0,1] op_sel_hi:[1,0,1]
    v_pk_fma_f32 v[110:111], v[110:111], v[254:255], v[254:255] op_sel:[0,0,1] op_sel_hi:[1,0,1]
    v_cvt_pk_bf16_f32 v236, v92, v93
    v_cvt_pk_bf16_f32 v237, v94, v95
    v_cvt_pk_bf16_f32 v238, v108, v109
    v_cvt_pk_bf16_f32 v239, v110, v111
    ds_write_b128 v2, v[236:239] offset:11264
    v_pk_fma_f32 v[124:125], v[124:125], v[254:255], v[254:255] op_sel:[0,0,1] op_sel_hi:[1,0,1]
    v_pk_fma_f32 v[126:127], v[126:127], v[254:255], v[254:255] op_sel:[0,0,1] op_sel_hi:[1,0,1]
pad0_30:
    s_cbranch_execz kf_kernel_done
    v_pk_fma_f32 v[140:141], v[140:141], v[254:255], v[254:255] op_sel:[0,0,1] op_sel_hi:[1,0,1]
    v_pk_fma_f32 v[142:143], v[142:143], v[254:255], v[254:255] op_sel:[0,0,1] op_sel_hi:[1,0,1]
    v_cvt_pk_bf16_f32 v240, v124, v125
    v_cvt_pk_bf16_f32 v241, v126, v127
    v_cvt_pk_bf16_f32 v242, v140, v141
    v_cvt_pk_bf16_f32 v243, v142, v143
    ds_write_b128 v2, v[240:243] offset:15360
    v_pk_fma_f32 v[156:157], v[156:157], v[254:255], v[254:255] op_sel:[0,0,1] op_sel_hi:[1,0,1]
    v_pk_fma_f32 v[158:159], v[158:159], v[254:255], v[254:255] op_sel:[0,0,1] op_sel_hi:[1,0,1]
    v_cvt_pk_bf16_f32 v244, v156, v157
    v_cvt_pk_bf16_f32 v245, v158, v159
    ds_write_b64 v3, v[244:245] offset:3072
    s_waitcnt lgkmcnt(0)
    s_barrier
    ds_read_b128 a[192:195], v1 offset:0
    ds_read_b128 a[196:199], v1 offset:1024
    ds_read_b128 a[200:203], v1 offset:2048
    ds_read_b128 a[204:207], v1 offset:3072
    ds_read_b128 a[208:211], v1 offset:4096
    ds_read_b128 a[212:215], v1 offset:5120
    ds_read_b128 a[216:219], v1 offset:6144
    ds_read_b128 a[220:223], v1 offset:7168
    s_waitcnt vmcnt(44) lgkmcnt(4)
    v_mfma_f32_16x16x32_bf16 v[16:19], a[144:147], a[192:195], 0
    ds_read_b128 a[224:227], v1 offset:8192
    v_mfma_f32_16x16x32_bf16 v[20:23], a[144:147], a[196:199], 0
    v_mfma_f32_16x16x32_bf16 v[24:27], a[144:147], a[200:203], 0
    v_mfma_f32_16x16x32_bf16 v[28:31], a[144:147], a[204:207], 0
    s_add_u32 s36, s36, 4096
    buffer_load_dwordx4 a[144:147], v1, s[12:15], s36 offen offset:0
    v_mfma_f32_16x16x32_bf16 v[32:35], a[148:151], a[192:195], 0
    ds_read_b128 a[228:231], v1 offset:9216
    v_mfma_f32_16x16x32_bf16 v[36:39], a[148:151], a[196:199], 0
pad0_31:
    s_cbranch_execz kf_kernel_done
    v_mfma_f32_16x16x32_bf16 v[40:43], a[148:151], a[200:203], 0
    v_mfma_f32_16x16x32_bf16 v[44:47], a[148:151], a[204:207], 0
    buffer_load_dwordx4 a[148:151], v1, s[12:15], s36 offen offset:1024
    v_mfma_f32_16x16x32_bf16 v[48:51], a[152:155], a[192:195], 0
    ds_read_b128 a[232:235], v1 offset:10240
    v_mfma_f32_16x16x32_bf16 v[52:55], a[152:155], a[196:199], 0
    v_mfma_f32_16x16x32_bf16 v[56:59], a[152:155], a[200:203], 0
    v_mfma_f32_16x16x32_bf16 v[60:63], a[152:155], a[204:207], 0
    buffer_load_dwordx4 a[152:155], v1, s[12:15], s36 offen offset:2048
    v_mfma_f32_16x16x32_bf16 v[64:67], a[156:159], a[192:195], 0
    ds_read_b128 a[236:239], v1 offset:11264
    v_mfma_f32_16x16x32_bf16 v[68:71], a[156:159], a[196:199], 0
    v_mfma_f32_16x16x32_bf16 v[72:75], a[156:159], a[200:203], 0
    v_mfma_f32_16x16x32_bf16 v[76:79], a[156:159], a[204:207], 0
    buffer_load_dwordx4 a[156:159], v1, s[12:15], s36 offen offset:3072
    s_waitcnt vmcnt(44) lgkmcnt(4)
    v_mfma_f32_16x16x32_bf16 v[16:19], a[0:3], a[208:211], v[16:19]
    ds_read_b128 a[240:243], v1 offset:12288
    v_mfma_f32_16x16x32_bf16 v[20:23], a[0:3], a[212:215], v[20:23]
    v_mfma_f32_16x16x32_bf16 v[24:27], a[0:3], a[216:219], v[24:27]
    v_mfma_f32_16x16x32_bf16 v[28:31], a[0:3], a[220:223], v[28:31]
    s_add_u32 s36, s36, 4096
    buffer_load_dwordx4 a[0:3], v1, s[12:15], s36 offen offset:0
    v_mfma_f32_16x16x32_bf16 v[32:35], a[4:7], a[208:211], v[32:35]
    ds_read_b128 a[244:247], v1 offset:13312
    v_mfma_f32_16x16x32_bf16 v[36:39], a[4:7], a[212:215], v[36:39]
    v_mfma_f32_16x16x32_bf16 v[40:43], a[4:7], a[216:219], v[40:43]
    v_mfma_f32_16x16x32_bf16 v[44:47], a[4:7], a[220:223], v[44:47]
    buffer_load_dwordx4 a[4:7], v1, s[12:15], s36 offen offset:1024
    v_mfma_f32_16x16x32_bf16 v[48:51], a[8:11], a[208:211], v[48:51]
    ds_read_b128 a[248:251], v1 offset:14336
    v_mfma_f32_16x16x32_bf16 v[52:55], a[8:11], a[212:215], v[52:55]
pad0_32:
    s_cbranch_execz kf_kernel_done
    v_mfma_f32_16x16x32_bf16 v[56:59], a[8:11], a[216:219], v[56:59]
    v_mfma_f32_16x16x32_bf16 v[60:63], a[8:11], a[220:223], v[60:63]
    buffer_load_dwordx4 a[8:11], v1, s[12:15], s36 offen offset:2048
    v_mfma_f32_16x16x32_bf16 v[64:67], a[12:15], a[208:211], v[64:67]
    ds_read_b128 a[252:255], v1 offset:15360
    v_mfma_f32_16x16x32_bf16 v[68:71], a[12:15], a[212:215], v[68:71]
    v_mfma_f32_16x16x32_bf16 v[72:75], a[12:15], a[216:219], v[72:75]
    v_mfma_f32_16x16x32_bf16 v[76:79], a[12:15], a[220:223], v[76:79]
    buffer_load_dwordx4 a[12:15], v1, s[12:15], s36 offen offset:3072
    s_waitcnt vmcnt(44) lgkmcnt(4)
    v_mfma_f32_16x16x32_bf16 v[16:19], a[16:19], a[224:227], v[16:19]
    ds_read_b128 a[192:195], v1 offset:16384
    v_mfma_f32_16x16x32_bf16 v[20:23], a[16:19], a[228:231], v[20:23]
    v_mfma_f32_16x16x32_bf16 v[24:27], a[16:19], a[232:235], v[24:27]
    v_mfma_f32_16x16x32_bf16 v[28:31], a[16:19], a[236:239], v[28:31]
    s_add_u32 s36, s36, 4096
    buffer_load_dwordx4 a[16:19], v1, s[12:15], s36 offen offset:0
    v_mfma_f32_16x16x32_bf16 v[32:35], a[20:23], a[224:227], v[32:35]
    ds_read_b128 a[196:199], v1 offset:17408
    v_mfma_f32_16x16x32_bf16 v[36:39], a[20:23], a[228:231], v[36:39]
    v_mfma_f32_16x16x32_bf16 v[40:43], a[20:23], a[232:235], v[40:43]
    v_mfma_f32_16x16x32_bf16 v[44:47], a[20:23], a[236:239], v[44:47]
    buffer_load_dwordx4 a[20:23], v1, s[12:15], s36 offen offset:1024
    v_mfma_f32_16x16x32_bf16 v[48:51], a[24:27], a[224:227], v[48:51]
    ds_read_b128 a[200:203], v1 offset:18432
    v_mfma_f32_16x16x32_bf16 v[52:55], a[24:27], a[228:231], v[52:55]
    v_mfma_f32_16x16x32_bf16 v[56:59], a[24:27], a[232:235], v[56:59]
    v_mfma_f32_16x16x32_bf16 v[60:63], a[24:27], a[236:239], v[60:63]
    buffer_load_dwordx4 a[24:27], v1, s[12:15], s36 offen offset:2048
    v_mfma_f32_16x16x32_bf16 v[64:67], a[28:31], a[224:227], v[64:67]
    ds_read_b128 a[204:207], v1 offset:19456
    v_mfma_f32_16x16x32_bf16 v[68:71], a[28:31], a[228:231], v[68:71]
pad0_33:
    s_cbranch_execz kf_kernel_done
    v_mfma_f32_16x16x32_bf16 v[72:75], a[28:31], a[232:235], v[72:75]
    v_mfma_f32_16x16x32_bf16 v[76:79], a[28:31], a[236:239], v[76:79]
    buffer_load_dwordx4 a[28:31], v1, s[12:15], s36 offen offset:3072
    s_waitcnt vmcnt(44) lgkmcnt(4)
    v_mfma_f32_16x16x32_bf16 v[16:19], a[32:35], a[240:243], v[16:19]
    ds_read_b128 a[208:211], v1 offset:20480
    v_mfma_f32_16x16x32_bf16 v[20:23], a[32:35], a[244:247], v[20:23]
    v_mfma_f32_16x16x32_bf16 v[24:27], a[32:35], a[248:251], v[24:27]
    v_mfma_f32_16x16x32_bf16 v[28:31], a[32:35], a[252:255], v[28:31]
    s_add_u32 s36, s36, 4096
    buffer_load_dwordx4 a[32:35], v1, s[12:15], s36 offen offset:0
    v_mfma_f32_16x16x32_bf16 v[32:35], a[36:39], a[240:243], v[32:35]
    ds_read_b128 a[212:215], v1 offset:21504
    v_mfma_f32_16x16x32_bf16 v[36:39], a[36:39], a[244:247], v[36:39]
    v_mfma_f32_16x16x32_bf16 v[40:43], a[36:39], a[248:251], v[40:43]
    v_mfma_f32_16x16x32_bf16 v[44:47], a[36:39], a[252:255], v[44:47]
    buffer_load_dwordx4 a[36:39], v1, s[12:15], s36 offen offset:1024
    v_mfma_f32_16x16x32_bf16 v[48:51], a[40:43], a[240:243], v[48:51]
    ds_read_b128 a[216:219], v1 offset:22528
    v_mfma_f32_16x16x32_bf16 v[52:55], a[40:43], a[244:247], v[52:55]
    v_mfma_f32_16x16x32_bf16 v[56:59], a[40:43], a[248:251], v[56:59]
    v_mfma_f32_16x16x32_bf16 v[60:63], a[40:43], a[252:255], v[60:63]
    buffer_load_dwordx4 a[40:43], v1, s[12:15], s36 offen offset:2048
    v_mfma_f32_16x16x32_bf16 v[64:67], a[44:47], a[240:243], v[64:67]
    ds_read_b128 a[220:223], v1 offset:23552
    v_mfma_f32_16x16x32_bf16 v[68:71], a[44:47], a[244:247], v[68:71]
    v_mfma_f32_16x16x32_bf16 v[72:75], a[44:47], a[248:251], v[72:75]
    v_mfma_f32_16x16x32_bf16 v[76:79], a[44:47], a[252:255], v[76:79]
    buffer_load_dwordx4 a[44:47], v1, s[12:15], s36 offen offset:3072
    s_waitcnt vmcnt(44) lgkmcnt(4)
    v_mfma_f32_16x16x32_bf16 v[16:19], a[48:51], a[192:195], v[16:19]
    ds_read_b128 a[224:227], v1 offset:24576
    v_mfma_f32_16x16x32_bf16 v[20:23], a[48:51], a[196:199], v[20:23]
pad0_34:
    s_cbranch_execz kf_kernel_done
    v_mfma_f32_16x16x32_bf16 v[24:27], a[48:51], a[200:203], v[24:27]
    v_mfma_f32_16x16x32_bf16 v[28:31], a[48:51], a[204:207], v[28:31]
    s_add_u32 s36, s36, 4096
    buffer_load_dwordx4 a[48:51], v1, s[12:15], s36 offen offset:0
    v_mfma_f32_16x16x32_bf16 v[32:35], a[52:55], a[192:195], v[32:35]
    ds_read_b128 a[228:231], v1 offset:25600
    v_mfma_f32_16x16x32_bf16 v[36:39], a[52:55], a[196:199], v[36:39]
    v_mfma_f32_16x16x32_bf16 v[40:43], a[52:55], a[200:203], v[40:43]
    v_mfma_f32_16x16x32_bf16 v[44:47], a[52:55], a[204:207], v[44:47]
    buffer_load_dwordx4 a[52:55], v1, s[12:15], s36 offen offset:1024
    v_mfma_f32_16x16x32_bf16 v[48:51], a[56:59], a[192:195], v[48:51]
    ds_read_b128 a[232:235], v1 offset:26624
    v_mfma_f32_16x16x32_bf16 v[52:55], a[56:59], a[196:199], v[52:55]
    v_mfma_f32_16x16x32_bf16 v[56:59], a[56:59], a[200:203], v[56:59]
    v_mfma_f32_16x16x32_bf16 v[60:63], a[56:59], a[204:207], v[60:63]
    buffer_load_dwordx4 a[56:59], v1, s[12:15], s36 offen offset:2048
    v_mfma_f32_16x16x32_bf16 v[64:67], a[60:63], a[192:195], v[64:67]
    ds_read_b128 a[236:239], v1 offset:27648
    v_mfma_f32_16x16x32_bf16 v[68:71], a[60:63], a[196:199], v[68:71]
    v_mfma_f32_16x16x32_bf16 v[72:75], a[60:63], a[200:203], v[72:75]
    v_mfma_f32_16x16x32_bf16 v[76:79], a[60:63], a[204:207], v[76:79]
    buffer_load_dwordx4 a[60:63], v1, s[12:15], s36 offen offset:3072
    s_waitcnt vmcnt(44) lgkmcnt(4)
    v_mfma_f32_16x16x32_bf16 v[16:19], a[64:67], a[208:211], v[16:19]
    ds_read_b128 a[240:243], v1 offset:28672
    v_mfma_f32_16x16x32_bf16 v[20:23], a[64:67], a[212:215], v[20:23]
    v_mfma_f32_16x16x32_bf16 v[24:27], a[64:67], a[216:219], v[24:27]
    v_mfma_f32_16x16x32_bf16 v[28:31], a[64:67], a[220:223], v[28:31]
    s_add_u32 s36, s36, 4096
    buffer_load_dwordx4 a[64:67], v1, s[12:15], s36 offen offset:0
    v_mfma_f32_16x16x32_bf16 v[32:35], a[68:71], a[208:211], v[32:35]
    ds_read_b128 a[244:247], v1 offset:29696
pad0_35:
    s_cbranch_execz kf_kernel_done
    v_mfma_f32_16x16x32_bf16 v[36:39], a[68:71], a[212:215], v[36:39]
    v_mfma_f32_16x16x32_bf16 v[40:43], a[68:71], a[216:219], v[40:43]
    v_mfma_f32_16x16x32_bf16 v[44:47], a[68:71], a[220:223], v[44:47]
    buffer_load_dwordx4 a[68:71], v1, s[12:15], s36 offen offset:1024
    v_mfma_f32_16x16x32_bf16 v[48:51], a[72:75], a[208:211], v[48:51]
    ds_read_b128 a[248:251], v1 offset:30720
    v_mfma_f32_16x16x32_bf16 v[52:55], a[72:75], a[212:215], v[52:55]
    v_mfma_f32_16x16x32_bf16 v[56:59], a[72:75], a[216:219], v[56:59]
    v_mfma_f32_16x16x32_bf16 v[60:63], a[72:75], a[220:223], v[60:63]
    buffer_load_dwordx4 a[72:75], v1, s[12:15], s36 offen offset:2048
    v_mfma_f32_16x16x32_bf16 v[64:67], a[76:79], a[208:211], v[64:67]
    ds_read_b128 a[252:255], v1 offset:31744
    v_mfma_f32_16x16x32_bf16 v[68:71], a[76:79], a[212:215], v[68:71]
    v_mfma_f32_16x16x32_bf16 v[72:75], a[76:79], a[216:219], v[72:75]
    v_mfma_f32_16x16x32_bf16 v[76:79], a[76:79], a[220:223], v[76:79]
    buffer_load_dwordx4 a[76:79], v1, s[12:15], s36 offen offset:3072
    s_waitcnt vmcnt(44) lgkmcnt(4)
    v_mfma_f32_16x16x32_bf16 v[16:19], a[80:83], a[224:227], v[16:19]
    ds_read_b128 a[192:195], v1 offset:32768
    v_mfma_f32_16x16x32_bf16 v[20:23], a[80:83], a[228:231], v[20:23]
    v_mfma_f32_16x16x32_bf16 v[24:27], a[80:83], a[232:235], v[24:27]
    v_mfma_f32_16x16x32_bf16 v[28:31], a[80:83], a[236:239], v[28:31]
    s_add_u32 s36, s36, 4096
    buffer_load_dwordx4 a[80:83], v1, s[12:15], s36 offen offset:0
    v_mfma_f32_16x16x32_bf16 v[32:35], a[84:87], a[224:227], v[32:35]
    ds_read_b128 a[196:199], v1 offset:33792
    v_mfma_f32_16x16x32_bf16 v[36:39], a[84:87], a[228:231], v[36:39]
    v_mfma_f32_16x16x32_bf16 v[40:43], a[84:87], a[232:235], v[40:43]
    v_mfma_f32_16x16x32_bf16 v[44:47], a[84:87], a[236:239], v[44:47]
    buffer_load_dwordx4 a[84:87], v1, s[12:15], s36 offen offset:1024
    v_mfma_f32_16x16x32_bf16 v[48:51], a[88:91], a[224:227], v[48:51]
    ds_read_b128 a[200:203], v1 offset:34816
pad0_36:
    s_cbranch_execz kf_kernel_done
    v_mfma_f32_16x16x32_bf16 v[52:55], a[88:91], a[228:231], v[52:55]
    v_mfma_f32_16x16x32_bf16 v[56:59], a[88:91], a[232:235], v[56:59]
    v_mfma_f32_16x16x32_bf16 v[60:63], a[88:91], a[236:239], v[60:63]
    buffer_load_dwordx4 a[88:91], v1, s[12:15], s36 offen offset:2048
    v_mfma_f32_16x16x32_bf16 v[64:67], a[92:95], a[224:227], v[64:67]
    ds_read_b128 a[204:207], v1 offset:35840
    v_mfma_f32_16x16x32_bf16 v[68:71], a[92:95], a[228:231], v[68:71]
    v_mfma_f32_16x16x32_bf16 v[72:75], a[92:95], a[232:235], v[72:75]
    v_mfma_f32_16x16x32_bf16 v[76:79], a[92:95], a[236:239], v[76:79]
    buffer_load_dwordx4 a[92:95], v1, s[12:15], s36 offen offset:3072
    s_waitcnt vmcnt(44) lgkmcnt(4)
    v_mfma_f32_16x16x32_bf16 v[16:19], a[96:99], a[240:243], v[16:19]
    ds_read_b128 a[208:211], v1 offset:36864
    v_mfma_f32_16x16x32_bf16 v[20:23], a[96:99], a[244:247], v[20:23]
    v_mfma_f32_16x16x32_bf16 v[24:27], a[96:99], a[248:251], v[24:27]
    v_mfma_f32_16x16x32_bf16 v[28:31], a[96:99], a[252:255], v[28:31]
    s_add_u32 s36, s36, 4096
    buffer_load_dwordx4 a[96:99], v1, s[12:15], s36 offen offset:0
    v_mfma_f32_16x16x32_bf16 v[32:35], a[100:103], a[240:243], v[32:35]
    ds_read_b128 a[212:215], v1 offset:37888
    v_mfma_f32_16x16x32_bf16 v[36:39], a[100:103], a[244:247], v[36:39]
    v_mfma_f32_16x16x32_bf16 v[40:43], a[100:103], a[248:251], v[40:43]
    v_mfma_f32_16x16x32_bf16 v[44:47], a[100:103], a[252:255], v[44:47]
    buffer_load_dwordx4 a[100:103], v1, s[12:15], s36 offen offset:1024
    v_mfma_f32_16x16x32_bf16 v[48:51], a[104:107], a[240:243], v[48:51]
    ds_read_b128 a[216:219], v1 offset:38912
    v_mfma_f32_16x16x32_bf16 v[52:55], a[104:107], a[244:247], v[52:55]
    v_mfma_f32_16x16x32_bf16 v[56:59], a[104:107], a[248:251], v[56:59]
    v_mfma_f32_16x16x32_bf16 v[60:63], a[104:107], a[252:255], v[60:63]
    buffer_load_dwordx4 a[104:107], v1, s[12:15], s36 offen offset:2048
    v_mfma_f32_16x16x32_bf16 v[64:67], a[108:111], a[240:243], v[64:67]
    ds_read_b128 a[220:223], v1 offset:39936
pad0_37:
    s_cbranch_execz kf_kernel_done
    v_mfma_f32_16x16x32_bf16 v[68:71], a[108:111], a[244:247], v[68:71]
    v_mfma_f32_16x16x32_bf16 v[72:75], a[108:111], a[248:251], v[72:75]
    v_mfma_f32_16x16x32_bf16 v[76:79], a[108:111], a[252:255], v[76:79]
    buffer_load_dwordx4 a[108:111], v1, s[12:15], s36 offen offset:3072
    s_waitcnt vmcnt(44) lgkmcnt(4)
    v_mfma_f32_16x16x32_bf16 v[16:19], a[112:115], a[192:195], v[16:19]
    ds_read_b128 a[224:227], v1 offset:40960
    v_mfma_f32_16x16x32_bf16 v[20:23], a[112:115], a[196:199], v[20:23]
    v_mfma_f32_16x16x32_bf16 v[24:27], a[112:115], a[200:203], v[24:27]
    v_mfma_f32_16x16x32_bf16 v[28:31], a[112:115], a[204:207], v[28:31]
    s_add_u32 s36, s36, 4096
    buffer_load_dwordx4 a[112:115], v1, s[12:15], s36 offen offset:0
    v_mfma_f32_16x16x32_bf16 v[32:35], a[116:119], a[192:195], v[32:35]
    ds_read_b128 a[228:231], v1 offset:41984
    v_mfma_f32_16x16x32_bf16 v[36:39], a[116:119], a[196:199], v[36:39]
    v_mfma_f32_16x16x32_bf16 v[40:43], a[116:119], a[200:203], v[40:43]
    v_mfma_f32_16x16x32_bf16 v[44:47], a[116:119], a[204:207], v[44:47]
    buffer_load_dwordx4 a[116:119], v1, s[12:15], s36 offen offset:1024
    v_mfma_f32_16x16x32_bf16 v[48:51], a[120:123], a[192:195], v[48:51]
    ds_read_b128 a[232:235], v1 offset:43008
    v_mfma_f32_16x16x32_bf16 v[52:55], a[120:123], a[196:199], v[52:55]
    v_mfma_f32_16x16x32_bf16 v[56:59], a[120:123], a[200:203], v[56:59]
    v_mfma_f32_16x16x32_bf16 v[60:63], a[120:123], a[204:207], v[60:63]
    buffer_load_dwordx4 a[120:123], v1, s[12:15], s36 offen offset:2048
    v_mfma_f32_16x16x32_bf16 v[64:67], a[124:127], a[192:195], v[64:67]
    ds_read_b128 a[236:239], v1 offset:44032
    v_mfma_f32_16x16x32_bf16 v[68:71], a[124:127], a[196:199], v[68:71]
    v_mfma_f32_16x16x32_bf16 v[72:75], a[124:127], a[200:203], v[72:75]
    v_mfma_f32_16x16x32_bf16 v[76:79], a[124:127], a[204:207], v[76:79]
    buffer_load_dwordx4 a[124:127], v1, s[12:15], s36 offen offset:3072
    s_waitcnt vmcnt(44) lgkmcnt(4)
    v_mfma_f32_16x16x32_bf16 v[16:19], a[128:131], a[208:211], v[16:19]
pad0_38:
    s_cbranch_execz kf_kernel_done
    ds_read_b128 a[240:243], v1 offset:45056
    v_mfma_f32_16x16x32_bf16 v[20:23], a[128:131], a[212:215], v[20:23]
    v_mfma_f32_16x16x32_bf16 v[24:27], a[128:131], a[216:219], v[24:27]
    v_mfma_f32_16x16x32_bf16 v[28:31], a[128:131], a[220:223], v[28:31]
    s_add_u32 s36, s36, 4096
    buffer_load_dwordx4 a[128:131], v1, s[12:15], s36 offen offset:0
    v_mfma_f32_16x16x32_bf16 v[32:35], a[132:135], a[208:211], v[32:35]
    ds_read_b128 a[244:247], v1 offset:46080
    v_mfma_f32_16x16x32_bf16 v[36:39], a[132:135], a[212:215], v[36:39]
    v_mfma_f32_16x16x32_bf16 v[40:43], a[132:135], a[216:219], v[40:43]
    v_mfma_f32_16x16x32_bf16 v[44:47], a[132:135], a[220:223], v[44:47]
    buffer_load_dwordx4 a[132:135], v1, s[12:15], s36 offen offset:1024
    v_mfma_f32_16x16x32_bf16 v[48:51], a[136:139], a[208:211], v[48:51]
    ds_read_b128 a[248:251], v1 offset:47104
    v_mfma_f32_16x16x32_bf16 v[52:55], a[136:139], a[212:215], v[52:55]
    v_mfma_f32_16x16x32_bf16 v[56:59], a[136:139], a[216:219], v[56:59]
    v_mfma_f32_16x16x32_bf16 v[60:63], a[136:139], a[220:223], v[60:63]
    buffer_load_dwordx4 a[136:139], v1, s[12:15], s36 offen offset:2048
    v_mfma_f32_16x16x32_bf16 v[64:67], a[140:143], a[208:211], v[64:67]
    ds_read_b128 a[252:255], v1 offset:48128
    v_mfma_f32_16x16x32_bf16 v[68:71], a[140:143], a[212:215], v[68:71]
    v_mfma_f32_16x16x32_bf16 v[72:75], a[140:143], a[216:219], v[72:75]
    v_mfma_f32_16x16x32_bf16 v[76:79], a[140:143], a[220:223], v[76:79]
    buffer_load_dwordx4 a[140:143], v1, s[12:15], s36 offen offset:3072
    s_waitcnt vmcnt(44) lgkmcnt(4)
    v_mfma_f32_16x16x32_bf16 v[16:19], a[160:163], a[224:227], v[16:19]
    ds_read_b128 a[192:195], v1 offset:49152
    v_mfma_f32_16x16x32_bf16 v[20:23], a[160:163], a[228:231], v[20:23]
    v_mfma_f32_16x16x32_bf16 v[24:27], a[160:163], a[232:235], v[24:27]
    v_mfma_f32_16x16x32_bf16 v[28:31], a[160:163], a[236:239], v[28:31]
    s_add_u32 s36, s36, 4096
    buffer_load_dwordx4 a[160:163], v1, s[12:15], s36 offen offset:0
pad0_39:
    s_cbranch_execz kf_kernel_done
    v_mfma_f32_16x16x32_bf16 v[32:35], a[164:167], a[224:227], v[32:35]
    ds_read_b128 a[196:199], v1 offset:50176
    v_mfma_f32_16x16x32_bf16 v[36:39], a[164:167], a[228:231], v[36:39]
    v_mfma_f32_16x16x32_bf16 v[40:43], a[164:167], a[232:235], v[40:43]
    v_mfma_f32_16x16x32_bf16 v[44:47], a[164:167], a[236:239], v[44:47]
    buffer_load_dwordx4 a[164:167], v1, s[12:15], s36 offen offset:1024
    v_mfma_f32_16x16x32_bf16 v[48:51], a[168:171], a[224:227], v[48:51]
    ds_read_b128 a[200:203], v1 offset:51200
    v_mfma_f32_16x16x32_bf16 v[52:55], a[168:171], a[228:231], v[52:55]
    v_mfma_f32_16x16x32_bf16 v[56:59], a[168:171], a[232:235], v[56:59]
    v_mfma_f32_16x16x32_bf16 v[60:63], a[168:171], a[236:239], v[60:63]
    buffer_load_dwordx4 a[168:171], v1, s[12:15], s36 offen offset:2048
    v_mfma_f32_16x16x32_bf16 v[64:67], a[172:175], a[224:227], v[64:67]
    ds_read_b128 a[204:207], v1 offset:52224
    v_mfma_f32_16x16x32_bf16 v[68:71], a[172:175], a[228:231], v[68:71]
    v_mfma_f32_16x16x32_bf16 v[72:75], a[172:175], a[232:235], v[72:75]
    v_mfma_f32_16x16x32_bf16 v[76:79], a[172:175], a[236:239], v[76:79]
    buffer_load_dwordx4 a[172:175], v1, s[12:15], s36 offen offset:3072
    s_waitcnt vmcnt(44) lgkmcnt(4)
    v_mfma_f32_16x16x32_bf16 v[16:19], a[176:179], a[240:243], v[16:19]
    ds_read_b128 a[208:211], v1 offset:53248
    v_mfma_f32_16x16x32_bf16 v[20:23], a[176:179], a[244:247], v[20:23]
    v_mfma_f32_16x16x32_bf16 v[24:27], a[176:179], a[248:251], v[24:27]
    v_mfma_f32_16x16x32_bf16 v[28:31], a[176:179], a[252:255], v[28:31]
    s_add_u32 s36, s36, 4096
    buffer_load_dwordx4 a[176:179], v1, s[12:15], s36 offen offset:0
    v_mfma_f32_16x16x32_bf16 v[32:35], a[180:183], a[240:243], v[32:35]
    ds_read_b128 a[212:215], v1 offset:54272
    v_mfma_f32_16x16x32_bf16 v[36:39], a[180:183], a[244:247], v[36:39]
    v_mfma_f32_16x16x32_bf16 v[40:43], a[180:183], a[248:251], v[40:43]
    v_mfma_f32_16x16x32_bf16 v[44:47], a[180:183], a[252:255], v[44:47]
    buffer_load_dwordx4 a[180:183], v1, s[12:15], s36 offen offset:1024
pad0_40:
    s_cbranch_execz kf_kernel_done
    v_mfma_f32_16x16x32_bf16 v[48:51], a[184:187], a[240:243], v[48:51]
    ds_read_b128 a[216:219], v1 offset:55296
    v_mfma_f32_16x16x32_bf16 v[52:55], a[184:187], a[244:247], v[52:55]
    v_mfma_f32_16x16x32_bf16 v[56:59], a[184:187], a[248:251], v[56:59]
    v_mfma_f32_16x16x32_bf16 v[60:63], a[184:187], a[252:255], v[60:63]
    buffer_load_dwordx4 a[184:187], v1, s[12:15], s36 offen offset:2048
    v_mfma_f32_16x16x32_bf16 v[64:67], a[188:191], a[240:243], v[64:67]
    ds_read_b128 a[220:223], v1 offset:56320
    v_mfma_f32_16x16x32_bf16 v[68:71], a[188:191], a[244:247], v[68:71]
    v_mfma_f32_16x16x32_bf16 v[72:75], a[188:191], a[248:251], v[72:75]
    v_mfma_f32_16x16x32_bf16 v[76:79], a[188:191], a[252:255], v[76:79]
    buffer_load_dwordx4 a[188:191], v1, s[12:15], s36 offen offset:3072
    s_waitcnt vmcnt(44) lgkmcnt(4)
    v_mfma_f32_16x16x32_bf16 v[16:19], a[144:147], a[192:195], v[16:19]
    ds_read_b128 a[224:227], v1 offset:57344
    v_mfma_f32_16x16x32_bf16 v[20:23], a[144:147], a[196:199], v[20:23]
    v_mfma_f32_16x16x32_bf16 v[24:27], a[144:147], a[200:203], v[24:27]
    v_mfma_f32_16x16x32_bf16 v[28:31], a[144:147], a[204:207], v[28:31]
    s_add_u32 s36, s36, 4096
    buffer_load_dwordx4 a[144:147], v1, s[12:15], s36 offen offset:0
    v_mfma_f32_16x16x32_bf16 v[32:35], a[148:151], a[192:195], v[32:35]
    ds_read_b128 a[228:231], v1 offset:58368
    v_mfma_f32_16x16x32_bf16 v[36:39], a[148:151], a[196:199], v[36:39]
    v_mfma_f32_16x16x32_bf16 v[40:43], a[148:151], a[200:203], v[40:43]
    v_mfma_f32_16x16x32_bf16 v[44:47], a[148:151], a[204:207], v[44:47]
    buffer_load_dwordx4 a[148:151], v1, s[12:15], s36 offen offset:1024
    v_mfma_f32_16x16x32_bf16 v[48:51], a[152:155], a[192:195], v[48:51]
    ds_read_b128 a[232:235], v1 offset:59392
    v_mfma_f32_16x16x32_bf16 v[52:55], a[152:155], a[196:199], v[52:55]
    v_mfma_f32_16x16x32_bf16 v[56:59], a[152:155], a[200:203], v[56:59]
    v_mfma_f32_16x16x32_bf16 v[60:63], a[152:155], a[204:207], v[60:63]
    buffer_load_dwordx4 a[152:155], v1, s[12:15], s36 offen offset:2048
pad0_41:
    s_cbranch_execz kf_kernel_done
    v_mfma_f32_16x16x32_bf16 v[64:67], a[156:159], a[192:195], v[64:67]
    ds_read_b128 a[236:239], v1 offset:60416
    v_mfma_f32_16x16x32_bf16 v[68:71], a[156:159], a[196:199], v[68:71]
    v_mfma_f32_16x16x32_bf16 v[72:75], a[156:159], a[200:203], v[72:75]
    v_mfma_f32_16x16x32_bf16 v[76:79], a[156:159], a[204:207], v[76:79]
    buffer_load_dwordx4 a[156:159], v1, s[12:15], s36 offen offset:3072
    s_waitcnt vmcnt(44) lgkmcnt(4)
    v_mfma_f32_16x16x32_bf16 v[16:19], a[0:3], a[208:211], v[16:19]
    ds_read_b128 a[240:243], v1 offset:61440
    v_mfma_f32_16x16x32_bf16 v[20:23], a[0:3], a[212:215], v[20:23]
    v_mfma_f32_16x16x32_bf16 v[24:27], a[0:3], a[216:219], v[24:27]
    v_mfma_f32_16x16x32_bf16 v[28:31], a[0:3], a[220:223], v[28:31]
    s_add_u32 s36, s36, 4096
    buffer_load_dwordx4 a[0:3], v1, s[12:15], s36 offen offset:0
    v_mfma_f32_16x16x32_bf16 v[32:35], a[4:7], a[208:211], v[32:35]
    ds_read_b128 a[244:247], v1 offset:62464
    v_mfma_f32_16x16x32_bf16 v[36:39], a[4:7], a[212:215], v[36:39]
    v_mfma_f32_16x16x32_bf16 v[40:43], a[4:7], a[216:219], v[40:43]
    v_mfma_f32_16x16x32_bf16 v[44:47], a[4:7], a[220:223], v[44:47]
    buffer_load_dwordx4 a[4:7], v1, s[12:15], s36 offen offset:1024
    v_mfma_f32_16x16x32_bf16 v[48:51], a[8:11], a[208:211], v[48:51]
    ds_read_b128 a[248:251], v1 offset:63488
    v_mfma_f32_16x16x32_bf16 v[52:55], a[8:11], a[212:215], v[52:55]
    v_mfma_f32_16x16x32_bf16 v[56:59], a[8:11], a[216:219], v[56:59]
    v_mfma_f32_16x16x32_bf16 v[60:63], a[8:11], a[220:223], v[60:63]
    buffer_load_dwordx4 a[8:11], v1, s[12:15], s36 offen offset:2048
    v_mfma_f32_16x16x32_bf16 v[64:67], a[12:15], a[208:211], v[64:67]
    ds_read_b128 a[252:255], v1 offset:64512
    v_mfma_f32_16x16x32_bf16 v[68:71], a[12:15], a[212:215], v[68:71]
    v_mfma_f32_16x16x32_bf16 v[72:75], a[12:15], a[216:219], v[72:75]
    v_mfma_f32_16x16x32_bf16 v[76:79], a[12:15], a[220:223], v[76:79]
    buffer_load_dwordx4 a[12:15], v1, s[12:15], s36 offen offset:3072
pad0_42:
    s_cbranch_execz kf_kernel_done
    s_waitcnt vmcnt(44) lgkmcnt(4)
    v_mfma_f32_16x16x32_bf16 v[16:19], a[16:19], a[224:227], v[16:19]
    ds_read_b128 a[192:195], v6 offset:0
    v_mfma_f32_16x16x32_bf16 v[20:23], a[16:19], a[228:231], v[20:23]
    v_mfma_f32_16x16x32_bf16 v[24:27], a[16:19], a[232:235], v[24:27]
    v_mfma_f32_16x16x32_bf16 v[28:31], a[16:19], a[236:239], v[28:31]
    s_add_u32 s36, s36, 4096
    buffer_load_dwordx4 a[16:19], v1, s[12:15], s36 offen offset:0
    v_mfma_f32_16x16x32_bf16 v[32:35], a[20:23], a[224:227], v[32:35]
    ds_read_b128 a[196:199], v6 offset:1024
    v_mfma_f32_16x16x32_bf16 v[36:39], a[20:23], a[228:231], v[36:39]
    v_mfma_f32_16x16x32_bf16 v[40:43], a[20:23], a[232:235], v[40:43]
    v_mfma_f32_16x16x32_bf16 v[44:47], a[20:23], a[236:239], v[44:47]
    buffer_load_dwordx4 a[20:23], v1, s[12:15], s36 offen offset:1024
    v_mfma_f32_16x16x32_bf16 v[48:51], a[24:27], a[224:227], v[48:51]
    ds_read_b128 a[200:203], v6 offset:2048
    v_mfma_f32_16x16x32_bf16 v[52:55], a[24:27], a[228:231], v[52:55]
    v_mfma_f32_16x16x32_bf16 v[56:59], a[24:27], a[232:235], v[56:59]
    v_mfma_f32_16x16x32_bf16 v[60:63], a[24:27], a[236:239], v[60:63]
    buffer_load_dwordx4 a[24:27], v1, s[12:15], s36 offen offset:2048
    v_mfma_f32_16x16x32_bf16 v[64:67], a[28:31], a[224:227], v[64:67]
    ds_read_b128 a[204:207], v6 offset:3072
    v_mfma_f32_16x16x32_bf16 v[68:71], a[28:31], a[228:231], v[68:71]
    v_mfma_f32_16x16x32_bf16 v[72:75], a[28:31], a[232:235], v[72:75]
    v_mfma_f32_16x16x32_bf16 v[76:79], a[28:31], a[236:239], v[76:79]
    buffer_load_dwordx4 a[28:31], v1, s[12:15], s36 offen offset:3072
    s_waitcnt vmcnt(44) lgkmcnt(4)
    v_mfma_f32_16x16x32_bf16 v[16:19], a[32:35], a[240:243], v[16:19]
    ds_read_b128 a[208:211], v6 offset:4096
    v_mfma_f32_16x16x32_bf16 v[20:23], a[32:35], a[244:247], v[20:23]
    v_mfma_f32_16x16x32_bf16 v[24:27], a[32:35], a[248:251], v[24:27]
    v_mfma_f32_16x16x32_bf16 v[28:31], a[32:35], a[252:255], v[28:31]
    s_add_u32 s36, s36, 4096
pad0_43:
    s_cbranch_execz kf_kernel_done
    buffer_load_dwordx4 a[32:35], v1, s[12:15], s36 offen offset:0
    v_mfma_f32_16x16x32_bf16 v[32:35], a[36:39], a[240:243], v[32:35]
    ds_read_b128 a[212:215], v6 offset:5120
    v_mfma_f32_16x16x32_bf16 v[36:39], a[36:39], a[244:247], v[36:39]
    v_mfma_f32_16x16x32_bf16 v[40:43], a[36:39], a[248:251], v[40:43]
    v_mfma_f32_16x16x32_bf16 v[44:47], a[36:39], a[252:255], v[44:47]
    buffer_load_dwordx4 a[36:39], v1, s[12:15], s36 offen offset:1024
    v_mfma_f32_16x16x32_bf16 v[48:51], a[40:43], a[240:243], v[48:51]
    ds_read_b128 a[216:219], v6 offset:6144
    v_mfma_f32_16x16x32_bf16 v[52:55], a[40:43], a[244:247], v[52:55]
    v_mfma_f32_16x16x32_bf16 v[56:59], a[40:43], a[248:251], v[56:59]
    v_mfma_f32_16x16x32_bf16 v[60:63], a[40:43], a[252:255], v[60:63]
    buffer_load_dwordx4 a[40:43], v1, s[12:15], s36 offen offset:2048
    v_mfma_f32_16x16x32_bf16 v[64:67], a[44:47], a[240:243], v[64:67]
    ds_read_b128 a[220:223], v6 offset:7168
    v_mfma_f32_16x16x32_bf16 v[68:71], a[44:47], a[244:247], v[68:71]
    v_mfma_f32_16x16x32_bf16 v[72:75], a[44:47], a[248:251], v[72:75]
    v_mfma_f32_16x16x32_bf16 v[76:79], a[44:47], a[252:255], v[76:79]
    buffer_load_dwordx4 a[44:47], v1, s[12:15], s36 offen offset:3072
    s_waitcnt vmcnt(44) lgkmcnt(4)
    v_mfma_f32_16x16x32_bf16 v[16:19], a[48:51], a[192:195], v[16:19]
    ds_read_b128 a[224:227], v1 offset:0
    v_mfma_f32_16x16x32_bf16 v[20:23], a[48:51], a[196:199], v[20:23]
    v_mfma_f32_16x16x32_bf16 v[24:27], a[48:51], a[200:203], v[24:27]
    v_mfma_f32_16x16x32_bf16 v[28:31], a[48:51], a[204:207], v[28:31]
    s_add_u32 s36, s36, 4096
    buffer_load_dwordx4 a[48:51], v1, s[12:15], s36 offen offset:0
    v_mfma_f32_16x16x32_bf16 v[32:35], a[52:55], a[192:195], v[32:35]
    ds_read_b128 a[228:231], v1 offset:1024
    v_mfma_f32_16x16x32_bf16 v[36:39], a[52:55], a[196:199], v[36:39]
    v_mfma_f32_16x16x32_bf16 v[40:43], a[52:55], a[200:203], v[40:43]
    v_mfma_f32_16x16x32_bf16 v[44:47], a[52:55], a[204:207], v[44:47]
pad0_44:
    s_cbranch_execz kf_kernel_done
    buffer_load_dwordx4 a[52:55], v1, s[12:15], s36 offen offset:1024
    v_mfma_f32_16x16x32_bf16 v[48:51], a[56:59], a[192:195], v[48:51]
    ds_read_b128 a[232:235], v1 offset:2048
    v_mfma_f32_16x16x32_bf16 v[52:55], a[56:59], a[196:199], v[52:55]
    v_mfma_f32_16x16x32_bf16 v[56:59], a[56:59], a[200:203], v[56:59]
    v_mfma_f32_16x16x32_bf16 v[60:63], a[56:59], a[204:207], v[60:63]
    buffer_load_dwordx4 a[56:59], v1, s[12:15], s36 offen offset:2048
    v_mfma_f32_16x16x32_bf16 v[64:67], a[60:63], a[192:195], v[64:67]
    ds_read_b128 a[236:239], v1 offset:3072
    v_mfma_f32_16x16x32_bf16 v[68:71], a[60:63], a[196:199], v[68:71]
    v_mfma_f32_16x16x32_bf16 v[72:75], a[60:63], a[200:203], v[72:75]
    v_mfma_f32_16x16x32_bf16 v[76:79], a[60:63], a[204:207], v[76:79]
    buffer_load_dwordx4 a[60:63], v1, s[12:15], s36 offen offset:3072
    s_waitcnt vmcnt(44) lgkmcnt(4)
    v_mfma_f32_16x16x32_bf16 v[16:19], a[64:67], a[208:211], v[16:19]
    ds_read_b128 a[240:243], v1 offset:4096
    v_mfma_f32_16x16x32_bf16 v[20:23], a[64:67], a[212:215], v[20:23]
    v_mfma_f32_16x16x32_bf16 v[24:27], a[64:67], a[216:219], v[24:27]
    v_mfma_f32_16x16x32_bf16 v[28:31], a[64:67], a[220:223], v[28:31]
    s_add_u32 s36, s36, 4096
    buffer_load_dwordx4 a[64:67], v1, s[12:15], s36 offen offset:0
    v_mfma_f32_16x16x32_bf16 v[32:35], a[68:71], a[208:211], v[32:35]
    ds_read_b128 a[244:247], v1 offset:5120
    v_mfma_f32_16x16x32_bf16 v[36:39], a[68:71], a[212:215], v[36:39]
    v_mfma_f32_16x16x32_bf16 v[40:43], a[68:71], a[216:219], v[40:43]
    v_mfma_f32_16x16x32_bf16 v[44:47], a[68:71], a[220:223], v[44:47]
    buffer_load_dwordx4 a[68:71], v1, s[12:15], s36 offen offset:1024
    v_mfma_f32_16x16x32_bf16 v[48:51], a[72:75], a[208:211], v[48:51]
    ds_read_b128 a[248:251], v1 offset:6144
    v_mfma_f32_16x16x32_bf16 v[52:55], a[72:75], a[212:215], v[52:55]
    v_mfma_f32_16x16x32_bf16 v[56:59], a[72:75], a[216:219], v[56:59]
    v_mfma_f32_16x16x32_bf16 v[60:63], a[72:75], a[220:223], v[60:63]
pad0_45:
    s_cbranch_execz kf_kernel_done
    buffer_load_dwordx4 a[72:75], v1, s[12:15], s36 offen offset:2048
    v_mfma_f32_16x16x32_bf16 v[64:67], a[76:79], a[208:211], v[64:67]
    ds_read_b128 a[252:255], v1 offset:7168
    v_mfma_f32_16x16x32_bf16 v[68:71], a[76:79], a[212:215], v[68:71]
    v_mfma_f32_16x16x32_bf16 v[72:75], a[76:79], a[216:219], v[72:75]
    v_mfma_f32_16x16x32_bf16 v[76:79], a[76:79], a[220:223], v[76:79]
    buffer_load_dwordx4 a[76:79], v1, s[12:15], s36 offen offset:3072
    s_waitcnt vmcnt(45) lgkmcnt(4)
    v_mfma_f32_16x16x32_bf16 v[80:83], a[80:83], a[224:227], 0
    ds_read_b128 a[192:195], v1 offset:8192
    v_mfma_f32_16x16x32_bf16 v[84:87], a[80:83], a[228:231], 0
    v_mfma_f32_16x16x32_bf16 v[88:91], a[80:83], a[232:235], 0
    v_mfma_f32_16x16x32_bf16 v[92:95], a[80:83], a[236:239], 0
    s_add_u32 s36, s36, 4096
    buffer_load_dwordx4 a[80:83], v1, s[12:15], s36 offen offset:0
    v_mfma_f32_16x16x32_bf16 v[96:99], a[84:87], a[224:227], 0
    ds_read_b128 a[196:199], v1 offset:9216
    v_mfma_f32_16x16x32_bf16 v[100:103], a[84:87], a[228:231], 0
    v_mfma_f32_16x16x32_bf16 v[104:107], a[84:87], a[232:235], 0
    ds_read_b128 a[200:203], v1 offset:10240
    v_mfma_f32_16x16x32_bf16 v[108:111], a[84:87], a[236:239], 0
    buffer_load_dwordx4 a[84:87], v1, s[12:15], s36 offen offset:1024
    v_mfma_f32_16x16x32_bf16 v[144:147], a[88:91], a[224:227], 0
    v_mfma_f32_16x16x32_bf16 v[148:151], a[88:91], a[228:231], 0
    ds_read_b128 a[204:207], v1 offset:11264
    v_mfma_f32_16x16x32_bf16 v[152:155], a[88:91], a[232:235], 0
    v_mfma_f32_16x16x32_bf16 v[156:159], a[88:91], a[236:239], 0
    buffer_load_dwordx4 a[88:91], v1, s[12:15], s36 offen offset:2048
    s_waitcnt vmcnt(45) lgkmcnt(4)
    v_mfma_f32_16x16x32_bf16 v[80:83], a[92:95], a[240:243], v[80:83]
    ds_read_b128 a[208:211], v1 offset:12288
    v_mfma_f32_16x16x32_bf16 v[84:87], a[92:95], a[244:247], v[84:87]
pad0_46:
    s_cbranch_execz kf_kernel_done
    ds_read_b128 a[212:215], v1 offset:13312
    v_mfma_f32_16x16x32_bf16 v[88:91], a[92:95], a[248:251], v[88:91]
    ds_read_b128 a[216:219], v1 offset:14336
    v_mfma_f32_16x16x32_bf16 v[92:95], a[92:95], a[252:255], v[92:95]
    buffer_load_dwordx4 a[92:95], v1, s[12:15], s36 offen offset:3072
    v_mfma_f32_16x16x32_bf16 v[96:99], a[96:99], a[240:243], v[96:99]
    ds_read_b128 a[220:223], v1 offset:15360
    v_cvt_pk_bf16_f32 v236, v16, v17
    v_mfma_f32_16x16x32_bf16 v[100:103], a[96:99], a[244:247], v[100:103]
    v_cvt_pk_bf16_f32 v237, v18, v19
    v_mfma_f32_16x16x32_bf16 v[104:107], a[96:99], a[248:251], v[104:107]
    v_cvt_pk_bf16_f32 v238, v32, v33
    v_mfma_f32_16x16x32_bf16 v[108:111], a[96:99], a[252:255], v[108:111]
    s_add_u32 s36, s36, 4096
    buffer_load_dwordx4 a[96:99], v1, s[12:15], s36 offen offset:0
    v_mfma_f32_16x16x32_bf16 v[144:147], a[100:103], a[240:243], v[144:147]
    v_cvt_pk_bf16_f32 v239, v34, v35
    v_pk_max_i16 v236, v236, 0
    v_mfma_f32_16x16x32_bf16 v[148:151], a[100:103], a[244:247], v[148:151]
    v_pk_max_i16 v237, v237, 0
    v_mfma_f32_16x16x32_bf16 v[152:155], a[100:103], a[248:251], v[152:155]
    v_pk_max_i16 v238, v238, 0
    v_pk_max_i16 v239, v239, 0
    v_mfma_f32_16x16x32_bf16 v[156:159], a[100:103], a[252:255], v[156:159]
    buffer_load_dwordx4 a[100:103], v1, s[12:15], s36 offen offset:1024
    s_waitcnt vmcnt(45) lgkmcnt(4)
    v_mfma_f32_16x16x32_bf16 v[80:83], a[104:107], a[192:195], v[80:83]
    ds_read_b128 a[224:227], v1 offset:16384
    v_mfma_f32_16x16x32_bf16 v[84:87], a[104:107], a[196:199], v[84:87]
    ds_read_b128 a[228:231], v1 offset:17408
    v_mfma_f32_16x16x32_bf16 v[88:91], a[104:107], a[200:203], v[88:91]
    ds_read_b128 a[232:235], v1 offset:18432
pad0_47:
    s_cbranch_execz kf_kernel_done
    v_mfma_f32_16x16x32_bf16 v[92:95], a[104:107], a[204:207], v[92:95]
    buffer_load_dwordx4 a[104:107], v1, s[12:15], s36 offen offset:2048
    v_mfma_f32_16x16x32_bf16 v[96:99], a[108:111], a[192:195], v[96:99]
    ds_read_b128 a[236:239], v1 offset:19456
    ds_write_b128 v4, v[236:239] offset:0
    v_mfma_f32_16x16x32_bf16 v[100:103], a[108:111], a[196:199], v[100:103]
    v_cvt_pk_bf16_f32 v240, v20, v21
    v_mfma_f32_16x16x32_bf16 v[104:107], a[108:111], a[200:203], v[104:107]
    v_cvt_pk_bf16_f32 v241, v22, v23
    v_mfma_f32_16x16x32_bf16 v[108:111], a[108:111], a[204:207], v[108:111]
    buffer_load_dwordx4 a[108:111], v1, s[12:15], s36 offen offset:3072
    v_mfma_f32_16x16x32_bf16 v[144:147], a[112:115], a[192:195], v[144:147]
    v_cvt_pk_bf16_f32 v242, v36, v37
    v_cvt_pk_bf16_f32 v243, v38, v39
    v_mfma_f32_16x16x32_bf16 v[148:151], a[112:115], a[196:199], v[148:151]
    v_pk_max_i16 v240, v240, 0
    v_mfma_f32_16x16x32_bf16 v[152:155], a[112:115], a[200:203], v[152:155]
    v_pk_max_i16 v241, v241, 0
    v_pk_max_i16 v242, v242, 0
    v_mfma_f32_16x16x32_bf16 v[156:159], a[112:115], a[204:207], v[156:159]
    s_add_u32 s36, s36, 4096
    buffer_load_dwordx4 a[112:115], v1, s[12:15], s36 offen offset:0
    s_waitcnt vmcnt(45) lgkmcnt(5)
    v_mfma_f32_16x16x32_bf16 v[80:83], a[116:119], a[208:211], v[80:83]
    ds_read_b128 a[240:243], v1 offset:20480
    v_mfma_f32_16x16x32_bf16 v[84:87], a[116:119], a[212:215], v[84:87]
    ds_read_b128 a[244:247], v1 offset:21504
    v_mfma_f32_16x16x32_bf16 v[88:91], a[116:119], a[216:219], v[88:91]
    ds_read_b128 a[248:251], v1 offset:22528
    v_mfma_f32_16x16x32_bf16 v[92:95], a[116:119], a[220:223], v[92:95]
    buffer_load_dwordx4 a[116:119], v1, s[12:15], s36 offen offset:1024
    v_mfma_f32_16x16x32_bf16 v[96:99], a[120:123], a[208:211], v[96:99]
pad0_48:
    s_cbranch_execz kf_kernel_done
    ds_read_b128 a[252:255], v1 offset:23552
    v_pk_max_i16 v243, v243, 0
    v_mfma_f32_16x16x32_bf16 v[100:103], a[120:123], a[212:215], v[100:103]
    ds_write_b128 v4, v[240:243] offset:1024
    v_mfma_f32_16x16x32_bf16 v[104:107], a[120:123], a[216:219], v[104:107]
    v_cvt_pk_bf16_f32 v244, v24, v25
    v_mfma_f32_16x16x32_bf16 v[108:111], a[120:123], a[220:223], v[108:111]
    buffer_load_dwordx4 a[120:123], v1, s[12:15], s36 offen offset:2048
    v_mfma_f32_16x16x32_bf16 v[144:147], a[124:127], a[208:211], v[144:147]
    v_cvt_pk_bf16_f32 v245, v26, v27
    v_cvt_pk_bf16_f32 v246, v40, v41
    v_mfma_f32_16x16x32_bf16 v[148:151], a[124:127], a[212:215], v[148:151]
    v_cvt_pk_bf16_f32 v247, v42, v43
    v_mfma_f32_16x16x32_bf16 v[152:155], a[124:127], a[216:219], v[152:155]
    v_pk_max_i16 v244, v244, 0
    v_pk_max_i16 v245, v245, 0
    v_mfma_f32_16x16x32_bf16 v[156:159], a[124:127], a[220:223], v[156:159]
    buffer_load_dwordx4 a[124:127], v1, s[12:15], s36 offen offset:3072
    s_waitcnt vmcnt(45) lgkmcnt(6)
    v_mfma_f32_16x16x32_bf16 v[80:83], a[128:131], a[224:227], v[80:83]
    ds_read_b128 a[192:195], v1 offset:24576
    v_mfma_f32_16x16x32_bf16 v[84:87], a[128:131], a[228:231], v[84:87]
    ds_read_b128 a[196:199], v1 offset:25600
    v_mfma_f32_16x16x32_bf16 v[88:91], a[128:131], a[232:235], v[88:91]
    ds_read_b128 a[200:203], v1 offset:26624
    v_mfma_f32_16x16x32_bf16 v[92:95], a[128:131], a[236:239], v[92:95]
    s_add_u32 s36, s36, 4096
    buffer_load_dwordx4 a[128:131], v1, s[12:15], s36 offen offset:0
    v_mfma_f32_16x16x32_bf16 v[96:99], a[132:135], a[224:227], v[96:99]
    ds_read_b128 a[204:207], v1 offset:27648
    v_pk_max_i16 v246, v246, 0
    v_mfma_f32_16x16x32_bf16 v[100:103], a[132:135], a[228:231], v[100:103]
pad0_49:
    s_cbranch_execz kf_kernel_done
    v_pk_max_i16 v247, v247, 0
    v_mfma_f32_16x16x32_bf16 v[104:107], a[132:135], a[232:235], v[104:107]
    ds_write_b128 v4, v[244:247] offset:2048
    v_mfma_f32_16x16x32_bf16 v[108:111], a[132:135], a[236:239], v[108:111]
    buffer_load_dwordx4 a[132:135], v1, s[12:15], s36 offen offset:1024
    v_mfma_f32_16x16x32_bf16 v[144:147], a[136:139], a[224:227], v[144:147]
    v_cvt_pk_bf16_f32 v248, v28, v29
    v_cvt_pk_bf16_f32 v249, v30, v31
    v_mfma_f32_16x16x32_bf16 v[148:151], a[136:139], a[228:231], v[148:151]
    v_cvt_pk_bf16_f32 v250, v44, v45
    v_mfma_f32_16x16x32_bf16 v[152:155], a[136:139], a[232:235], v[152:155]
    v_cvt_pk_bf16_f32 v251, v46, v47
    v_pk_max_i16 v248, v248, 0
    v_mfma_f32_16x16x32_bf16 v[156:159], a[136:139], a[236:239], v[156:159]
    buffer_load_dwordx4 a[136:139], v1, s[12:15], s36 offen offset:2048
    s_waitcnt vmcnt(45) lgkmcnt(6)
    v_mfma_f32_16x16x32_bf16 v[80:83], a[140:143], a[240:243], v[80:83]
    ds_read_b128 a[208:211], v1 offset:28672
    v_mfma_f32_16x16x32_bf16 v[84:87], a[140:143], a[244:247], v[84:87]
    ds_read_b128 a[212:215], v1 offset:29696
    v_mfma_f32_16x16x32_bf16 v[88:91], a[140:143], a[248:251], v[88:91]
    ds_read_b128 a[216:219], v1 offset:30720
    v_mfma_f32_16x16x32_bf16 v[92:95], a[140:143], a[252:255], v[92:95]
    buffer_load_dwordx4 a[140:143], v1, s[12:15], s36 offen offset:3072
    v_mfma_f32_16x16x32_bf16 v[96:99], a[160:163], a[240:243], v[96:99]
    ds_read_b128 a[220:223], v1 offset:31744
    v_pk_max_i16 v249, v249, 0
    v_mfma_f32_16x16x32_bf16 v[100:103], a[160:163], a[244:247], v[100:103]
    v_pk_max_i16 v250, v250, 0
    v_mfma_f32_16x16x32_bf16 v[104:107], a[160:163], a[248:251], v[104:107]
    v_pk_max_i16 v251, v251, 0
    v_mfma_f32_16x16x32_bf16 v[108:111], a[160:163], a[252:255], v[108:111]
pad0_50:
    s_cbranch_execz kf_kernel_done
    s_add_u32 s36, s36, 4096
    buffer_load_dwordx4 a[160:163], v1, s[12:15], s36 offen offset:0
    v_mfma_f32_16x16x32_bf16 v[144:147], a[164:167], a[240:243], v[144:147]
    ds_write_b128 v4, v[248:251] offset:3072
    v_cvt_pk_bf16_f32 v252, v48, v49
    v_mfma_f32_16x16x32_bf16 v[148:151], a[164:167], a[244:247], v[148:151]
    v_cvt_pk_bf16_f32 v253, v50, v51
    v_mfma_f32_16x16x32_bf16 v[152:155], a[164:167], a[248:251], v[152:155]
    v_cvt_pk_bf16_f32 v254, v64, v65
    v_cvt_pk_bf16_f32 v255, v66, v67
    v_mfma_f32_16x16x32_bf16 v[156:159], a[164:167], a[252:255], v[156:159]
    buffer_load_dwordx4 a[164:167], v1, s[12:15], s36 offen offset:1024
    s_waitcnt vmcnt(45) lgkmcnt(6)
    v_mfma_f32_16x16x32_bf16 v[80:83], a[168:171], a[192:195], v[80:83]
    ds_read_b128 a[224:227], v1 offset:32768
    v_mfma_f32_16x16x32_bf16 v[84:87], a[168:171], a[196:199], v[84:87]
    ds_read_b128 a[228:231], v1 offset:33792
    v_mfma_f32_16x16x32_bf16 v[88:91], a[168:171], a[200:203], v[88:91]
    ds_read_b128 a[232:235], v1 offset:34816
    v_mfma_f32_16x16x32_bf16 v[92:95], a[168:171], a[204:207], v[92:95]
    buffer_load_dwordx4 a[168:171], v1, s[12:15], s36 offen offset:2048
    v_mfma_f32_16x16x32_bf16 v[96:99], a[172:175], a[192:195], v[96:99]
    ds_read_b128 a[236:239], v1 offset:35840
    v_pk_max_i16 v252, v252, 0
    v_mfma_f32_16x16x32_bf16 v[100:103], a[172:175], a[196:199], v[100:103]
    v_pk_max_i16 v253, v253, 0
    v_mfma_f32_16x16x32_bf16 v[104:107], a[172:175], a[200:203], v[104:107]
    v_pk_max_i16 v254, v254, 0
    v_mfma_f32_16x16x32_bf16 v[108:111], a[172:175], a[204:207], v[108:111]
    buffer_load_dwordx4 a[172:175], v1, s[12:15], s36 offen offset:3072
    v_mfma_f32_16x16x32_bf16 v[144:147], a[176:179], a[192:195], v[144:147]
    v_pk_max_i16 v255, v255, 0
pad0_51:
    s_cbranch_execz kf_kernel_done
    ds_write_b128 v4, v[252:255] offset:4096
    v_mfma_f32_16x16x32_bf16 v[148:151], a[176:179], a[196:199], v[148:151]
    v_cvt_pk_bf16_f32 v232, v52, v53
    v_mfma_f32_16x16x32_bf16 v[152:155], a[176:179], a[200:203], v[152:155]
    v_cvt_pk_bf16_f32 v233, v54, v55
    v_cvt_pk_bf16_f32 v234, v68, v69
    v_mfma_f32_16x16x32_bf16 v[156:159], a[176:179], a[204:207], v[156:159]
    s_add_u32 s36, s36, 4096
    buffer_load_dwordx4 a[176:179], v1, s[12:15], s36 offen offset:0
    s_waitcnt vmcnt(45) lgkmcnt(6)
    v_mfma_f32_16x16x32_bf16 v[80:83], a[180:183], a[208:211], v[80:83]
    ds_read_b128 a[240:243], v1 offset:36864
    v_mfma_f32_16x16x32_bf16 v[84:87], a[180:183], a[212:215], v[84:87]
    ds_read_b128 a[244:247], v1 offset:37888
    v_mfma_f32_16x16x32_bf16 v[88:91], a[180:183], a[216:219], v[88:91]
    ds_read_b128 a[248:251], v1 offset:38912
    v_mfma_f32_16x16x32_bf16 v[92:95], a[180:183], a[220:223], v[92:95]
    buffer_load_dwordx4 a[180:183], v1, s[12:15], s36 offen offset:1024
    v_mfma_f32_16x16x32_bf16 v[96:99], a[184:187], a[208:211], v[96:99]
    ds_read_b128 a[252:255], v1 offset:39936
    v_cvt_pk_bf16_f32 v235, v70, v71
    v_mfma_f32_16x16x32_bf16 v[100:103], a[184:187], a[212:215], v[100:103]
    v_pk_max_i16 v232, v232, 0
    v_mfma_f32_16x16x32_bf16 v[104:107], a[184:187], a[216:219], v[104:107]
    v_pk_max_i16 v233, v233, 0
    v_mfma_f32_16x16x32_bf16 v[108:111], a[184:187], a[220:223], v[108:111]
    buffer_load_dwordx4 a[184:187], v1, s[12:15], s36 offen offset:2048
    v_mfma_f32_16x16x32_bf16 v[144:147], a[188:191], a[208:211], v[144:147]
    v_pk_max_i16 v234, v234, 0
    v_pk_max_i16 v235, v235, 0
    v_mfma_f32_16x16x32_bf16 v[148:151], a[188:191], a[212:215], v[148:151]
    ds_write_b128 v4, v[232:235] offset:5120
pad0_52:
    s_cbranch_execz kf_kernel_done
    v_mfma_f32_16x16x32_bf16 v[152:155], a[188:191], a[216:219], v[152:155]
    v_cvt_pk_bf16_f32 v236, v56, v57
    v_cvt_pk_bf16_f32 v237, v58, v59
    v_mfma_f32_16x16x32_bf16 v[156:159], a[188:191], a[220:223], v[156:159]
    buffer_load_dwordx4 a[188:191], v1, s[12:15], s36 offen offset:3072
    s_waitcnt vmcnt(45) lgkmcnt(6)
    v_mfma_f32_16x16x32_bf16 v[80:83], a[144:147], a[224:227], v[80:83]
    ds_read_b128 a[192:195], v1 offset:40960
    v_mfma_f32_16x16x32_bf16 v[84:87], a[144:147], a[228:231], v[84:87]
    ds_read_b128 a[196:199], v1 offset:41984
    v_mfma_f32_16x16x32_bf16 v[88:91], a[144:147], a[232:235], v[88:91]
    ds_read_b128 a[200:203], v1 offset:43008
    v_mfma_f32_16x16x32_bf16 v[92:95], a[144:147], a[236:239], v[92:95]
    s_add_u32 s36, s36, 4096
    buffer_load_dwordx4 a[144:147], v1, s[12:15], s36 offen offset:0
    v_mfma_f32_16x16x32_bf16 v[96:99], a[148:151], a[224:227], v[96:99]
    ds_read_b128 a[204:207], v1 offset:44032
    v_cvt_pk_bf16_f32 v238, v72, v73
    v_mfma_f32_16x16x32_bf16 v[100:103], a[148:151], a[228:231], v[100:103]
    v_cvt_pk_bf16_f32 v239, v74, v75
    v_mfma_f32_16x16x32_bf16 v[104:107], a[148:151], a[232:235], v[104:107]
    v_pk_max_i16 v236, v236, 0
    v_mfma_f32_16x16x32_bf16 v[108:111], a[148:151], a[236:239], v[108:111]
    buffer_load_dwordx4 a[148:151], v1, s[12:15], s36 offen offset:1024
    v_mfma_f32_16x16x32_bf16 v[144:147], a[152:155], a[224:227], v[144:147]
    v_pk_max_i16 v237, v237, 0
    v_pk_max_i16 v238, v238, 0
    v_mfma_f32_16x16x32_bf16 v[148:151], a[152:155], a[228:231], v[148:151]
    v_pk_max_i16 v239, v239, 0
    v_mfma_f32_16x16x32_bf16 v[152:155], a[152:155], a[232:235], v[152:155]
    ds_write_b128 v4, v[236:239] offset:6144
    v_cvt_pk_bf16_f32 v240, v60, v61
pad0_53:
    s_cbranch_execz kf_kernel_done
    v_mfma_f32_16x16x32_bf16 v[156:159], a[152:155], a[236:239], v[156:159]
    buffer_load_dwordx4 a[152:155], v1, s[12:15], s36 offen offset:2048
    s_waitcnt vmcnt(45) lgkmcnt(6)
    v_mfma_f32_16x16x32_bf16 v[80:83], a[156:159], a[240:243], v[80:83]
    ds_read_b128 a[208:211], v1 offset:45056
    v_mfma_f32_16x16x32_bf16 v[84:87], a[156:159], a[244:247], v[84:87]
    ds_read_b128 a[212:215], v1 offset:46080
    v_mfma_f32_16x16x32_bf16 v[88:91], a[156:159], a[248:251], v[88:91]
    ds_read_b128 a[216:219], v1 offset:47104
    v_mfma_f32_16x16x32_bf16 v[92:95], a[156:159], a[252:255], v[92:95]
    buffer_load_dwordx4 a[156:159], v1, s[12:15], s36 offen offset:3072
    v_mfma_f32_16x16x32_bf16 v[96:99], a[0:3], a[240:243], v[96:99]
    ds_read_b128 a[220:223], v1 offset:48128
    v_cvt_pk_bf16_f32 v241, v62, v63
    v_mfma_f32_16x16x32_bf16 v[100:103], a[0:3], a[244:247], v[100:103]
    v_cvt_pk_bf16_f32 v242, v76, v77
    v_mfma_f32_16x16x32_bf16 v[104:107], a[0:3], a[248:251], v[104:107]
    v_cvt_pk_bf16_f32 v243, v78, v79
    v_mfma_f32_16x16x32_bf16 v[108:111], a[0:3], a[252:255], v[108:111]
    s_add_u32 s36, s36, 4096
    buffer_load_dwordx4 a[0:3], v1, s[12:15], s36 offen offset:0
    v_mfma_f32_16x16x32_bf16 v[144:147], a[4:7], a[240:243], v[144:147]
    v_pk_max_i16 v240, v240, 0
    v_pk_max_i16 v241, v241, 0
    v_mfma_f32_16x16x32_bf16 v[148:151], a[4:7], a[244:247], v[148:151]
    v_pk_max_i16 v242, v242, 0
    v_mfma_f32_16x16x32_bf16 v[152:155], a[4:7], a[248:251], v[152:155]
    v_pk_max_i16 v243, v243, 0
    ds_write_b128 v4, v[240:243] offset:7168
    v_mfma_f32_16x16x32_bf16 v[156:159], a[4:7], a[252:255], v[156:159]
    buffer_load_dwordx4 a[4:7], v1, s[12:15], s36 offen offset:1024
    s_waitcnt vmcnt(45) lgkmcnt(6)
    v_mfma_f32_16x16x32_bf16 v[80:83], a[8:11], a[192:195], v[80:83]
pad0_54:
    s_cbranch_execz kf_kernel_done
    ds_read_b128 a[224:227], v1 offset:49152
    v_mfma_f32_16x16x32_bf16 v[84:87], a[8:11], a[196:199], v[84:87]
    ds_read_b128 a[228:231], v1 offset:50176
    v_mfma_f32_16x16x32_bf16 v[88:91], a[8:11], a[200:203], v[88:91]
    ds_read_b128 a[232:235], v1 offset:51200
    v_mfma_f32_16x16x32_bf16 v[92:95], a[8:11], a[204:207], v[92:95]
    buffer_load_dwordx4 a[8:11], v1, s[12:15], s36 offen offset:2048
    v_mfma_f32_16x16x32_bf16 v[96:99], a[12:15], a[192:195], v[96:99]
    ds_read_b128 a[236:239], v1 offset:52224
    v_mul_u32_u24 v16, s38, v160
    v_mfma_f32_16x16x32_bf16 v[100:103], a[12:15], a[196:199], v[100:103]
    v_and_b32 v17, s39, v160
    v_mfma_f32_16x16x32_bf16 v[104:107], a[12:15], a[200:203], v[104:107]
    v_mul_u32_u24 v18, s38, v161
    v_mfma_f32_16x16x32_bf16 v[108:111], a[12:15], a[204:207], v[108:111]
    buffer_load_dwordx4 a[12:15], v1, s[12:15], s36 offen offset:3072
    v_mfma_f32_16x16x32_bf16 v[144:147], a[16:19], a[192:195], v[144:147]
    v_and_b32 v19, s39, v161
    v_mul_u32_u24 v20, s38, v164
    v_mfma_f32_16x16x32_bf16 v[148:151], a[16:19], a[196:199], v[148:151]
    v_and_b32 v21, s39, v164
    v_mfma_f32_16x16x32_bf16 v[152:155], a[16:19], a[200:203], v[152:155]
    v_mul_u32_u24 v22, s38, v165
    v_and_b32 v23, s39, v165
    v_mfma_f32_16x16x32_bf16 v[156:159], a[16:19], a[204:207], v[156:159]
    s_add_u32 s36, s36, 4096
    buffer_load_dwordx4 a[16:19], v1, s[12:15], s36 offen offset:0
    s_waitcnt vmcnt(45) lgkmcnt(5)
    v_mfma_f32_16x16x32_bf16 v[80:83], a[20:23], a[208:211], v[80:83]
    ds_read_b128 a[240:243], v1 offset:53248
    v_mfma_f32_16x16x32_bf16 v[84:87], a[20:23], a[212:215], v[84:87]
    ds_read_b128 a[244:247], v1 offset:54272
    v_mfma_f32_16x16x32_bf16 v[88:91], a[20:23], a[216:219], v[88:91]
    ds_read_b128 a[248:251], v1 offset:55296
    v_mfma_f32_16x16x32_bf16 v[92:95], a[20:23], a[220:223], v[92:95]
    buffer_load_dwordx4 a[20:23], v1, s[12:15], s36 offen offset:1024
pad0_55:
    s_cbranch_execz kf_kernel_done
    v_mfma_f32_16x16x32_bf16 v[96:99], a[24:27], a[208:211], v[96:99]
    ds_read_b128 a[252:255], v1 offset:56320
    v_mul_u32_u24 v24, s38, v168
    v_mfma_f32_16x16x32_bf16 v[100:103], a[24:27], a[212:215], v[100:103]
    v_and_b32 v25, s39, v168
    v_mfma_f32_16x16x32_bf16 v[104:107], a[24:27], a[216:219], v[104:107]
    v_mul_u32_u24 v26, s38, v169
    v_mfma_f32_16x16x32_bf16 v[108:111], a[24:27], a[220:223], v[108:111]
    buffer_load_dwordx4 a[24:27], v1, s[12:15], s36 offen offset:2048
    v_mfma_f32_16x16x32_bf16 v[144:147], a[28:31], a[208:211], v[144:147]
    v_and_b32 v27, s39, v169
    v_mul_u32_u24 v28, s38, v172
    v_mfma_f32_16x16x32_bf16 v[148:151], a[28:31], a[212:215], v[148:151]
    v_and_b32 v29, s39, v172
    v_mfma_f32_16x16x32_bf16 v[152:155], a[28:31], a[216:219], v[152:155]
    v_mul_u32_u24 v30, s38, v173
    v_and_b32 v31, s39, v173
    v_mfma_f32_16x16x32_bf16 v[156:159], a[28:31], a[220:223], v[156:159]
    buffer_load_dwordx4 a[28:31], v1, s[12:15], s36 offen offset:3072
    s_waitcnt vmcnt(45) lgkmcnt(4)
    v_mfma_f32_16x16x32_bf16 v[80:83], a[32:35], a[224:227], v[80:83]
    ds_read_b128 a[192:195], v1 offset:57344
    v_mfma_f32_16x16x32_bf16 v[84:87], a[32:35], a[228:231], v[84:87]
    ds_read_b128 a[196:199], v1 offset:58368
    v_mfma_f32_16x16x32_bf16 v[88:91], a[32:35], a[232:235], v[88:91]
    ds_read_b128 a[200:203], v1 offset:59392
    v_mfma_f32_16x16x32_bf16 v[92:95], a[32:35], a[236:239], v[92:95]
    s_add_u32 s36, s36, 4096
    buffer_load_dwordx4 a[32:35], v1, s[12:15], s36 offen offset:0
    v_mfma_f32_16x16x32_bf16 v[96:99], a[36:39], a[224:227], v[96:99]
    ds_read_b128 a[204:207], v1 offset:60416
    v_mul_u32_u24 v32, s38, v162
    v_mfma_f32_16x16x32_bf16 v[100:103], a[36:39], a[228:231], v[100:103]
    v_and_b32 v33, s39, v162
    v_mfma_f32_16x16x32_bf16 v[104:107], a[36:39], a[232:235], v[104:107]
    v_mul_u32_u24 v34, s38, v163
    v_mfma_f32_16x16x32_bf16 v[108:111], a[36:39], a[236:239], v[108:111]
pad0_56:
    s_cbranch_execz kf_kernel_done
    buffer_load_dwordx4 a[36:39], v1, s[12:15], s36 offen offset:1024
    v_mfma_f32_16x16x32_bf16 v[144:147], a[40:43], a[224:227], v[144:147]
    v_and_b32 v35, s39, v163
    v_mul_u32_u24 v36, s38, v166
    v_mfma_f32_16x16x32_bf16 v[148:151], a[40:43], a[228:231], v[148:151]
    v_and_b32 v37, s39, v166
    v_mfma_f32_16x16x32_bf16 v[152:155], a[40:43], a[232:235], v[152:155]
    v_mul_u32_u24 v38, s38, v167
    v_and_b32 v39, s39, v167
    v_mfma_f32_16x16x32_bf16 v[156:159], a[40:43], a[236:239], v[156:159]
    buffer_load_dwordx4 a[40:43], v1, s[12:15], s36 offen offset:2048
    s_waitcnt vmcnt(45) lgkmcnt(4)
    v_mfma_f32_16x16x32_bf16 v[80:83], a[44:47], a[240:243], v[80:83]
    ds_read_b128 a[208:211], v1 offset:61440
    v_mfma_f32_16x16x32_bf16 v[84:87], a[44:47], a[244:247], v[84:87]
    ds_read_b128 a[212:215], v1 offset:62464
    v_mfma_f32_16x16x32_bf16 v[88:91], a[44:47], a[248:251], v[88:91]
    ds_read_b128 a[216:219], v1 offset:63488
    v_mfma_f32_16x16x32_bf16 v[92:95], a[44:47], a[252:255], v[92:95]
    buffer_load_dwordx4 a[44:47], v1, s[12:15], s36 offen offset:3072
    v_mfma_f32_16x16x32_bf16 v[96:99], a[48:51], a[240:243], v[96:99]
    ds_read_b128 a[220:223], v1 offset:64512
    v_mul_u32_u24 v40, s38, v170
    v_mfma_f32_16x16x32_bf16 v[100:103], a[48:51], a[244:247], v[100:103]
    v_and_b32 v41, s39, v170
    v_mfma_f32_16x16x32_bf16 v[104:107], a[48:51], a[248:251], v[104:107]
    v_mul_u32_u24 v42, s38, v171
    v_mfma_f32_16x16x32_bf16 v[108:111], a[48:51], a[252:255], v[108:111]
    s_add_u32 s36, s36, 4096
    buffer_load_dwordx4 a[48:51], v1, s[12:15], s36 offen offset:0
    v_mfma_f32_16x16x32_bf16 v[144:147], a[52:55], a[240:243], v[144:147]
    v_and_b32 v43, s39, v171
    v_mul_u32_u24 v44, s38, v174
    v_mfma_f32_16x16x32_bf16 v[148:151], a[52:55], a[244:247], v[148:151]
    v_and_b32 v45, s39, v174
    v_mfma_f32_16x16x32_bf16 v[152:155], a[52:55], a[248:251], v[152:155]
    v_mul_u32_u24 v46, s38, v175
    v_and_b32 v47, s39, v175
    v_mfma_f32_16x16x32_bf16 v[156:159], a[52:55], a[252:255], v[156:159]
pad0_57:
    s_cbranch_execz kf_kernel_done
    buffer_load_dwordx4 a[52:55], v1, s[12:15], s36 offen offset:1024
    s_waitcnt vmcnt(45) lgkmcnt(4)
    v_mfma_f32_16x16x32_bf16 v[80:83], a[56:59], a[192:195], v[80:83]
    ds_read_b128 a[224:227], v6 offset:0
    v_mfma_f32_16x16x32_bf16 v[84:87], a[56:59], a[196:199], v[84:87]
    ds_read_b128 a[228:231], v6 offset:1024
    v_mfma_f32_16x16x32_bf16 v[88:91], a[56:59], a[200:203], v[88:91]
    ds_read_b128 a[232:235], v6 offset:2048
    v_mfma_f32_16x16x32_bf16 v[92:95], a[56:59], a[204:207], v[92:95]
    buffer_load_dwordx4 a[56:59], v1, s[12:15], s36 offen offset:2048
    v_mfma_f32_16x16x32_bf16 v[96:99], a[60:63], a[192:195], v[96:99]
    ds_read_b128 a[236:239], v6 offset:3072
    v_mul_u32_u24 v48, s38, v176
    v_mfma_f32_16x16x32_bf16 v[100:103], a[60:63], a[196:199], v[100:103]
    v_and_b32 v49, s39, v176
    v_mfma_f32_16x16x32_bf16 v[104:107], a[60:63], a[200:203], v[104:107]
    v_mul_u32_u24 v50, s38, v177
    v_mfma_f32_16x16x32_bf16 v[108:111], a[60:63], a[204:207], v[108:111]
    buffer_load_dwordx4 a[60:63], v1, s[12:15], s36 offen offset:3072
    v_mfma_f32_16x16x32_bf16 v[144:147], a[64:67], a[192:195], v[144:147]
    v_and_b32 v51, s39, v177
    v_mul_u32_u24 v52, s38, v180
    v_mfma_f32_16x16x32_bf16 v[148:151], a[64:67], a[196:199], v[148:151]
    v_and_b32 v53, s39, v180
    v_mfma_f32_16x16x32_bf16 v[152:155], a[64:67], a[200:203], v[152:155]
    v_mul_u32_u24 v54, s38, v181
    v_and_b32 v55, s39, v181
    v_mfma_f32_16x16x32_bf16 v[156:159], a[64:67], a[204:207], v[156:159]
    s_add_u32 s36, s36, 4096
    buffer_load_dwordx4 a[64:67], v1, s[12:15], s36 offen offset:0
    s_waitcnt vmcnt(45) lgkmcnt(4)
    v_mfma_f32_16x16x32_bf16 v[80:83], a[68:71], a[208:211], v[80:83]
    ds_read_b128 a[240:243], v6 offset:4096
    v_mfma_f32_16x16x32_bf16 v[84:87], a[68:71], a[212:215], v[84:87]
    ds_read_b128 a[244:247], v6 offset:5120
    v_mfma_f32_16x16x32_bf16 v[88:91], a[68:71], a[216:219], v[88:91]
pad0_58:
    s_cbranch_execz kf_kernel_done
    ds_read_b128 a[248:251], v6 offset:6144
    v_mfma_f32_16x16x32_bf16 v[92:95], a[68:71], a[220:223], v[92:95]
    buffer_load_dwordx4 a[68:71], v1, s[12:15], s36 offen offset:1024
    v_mfma_f32_16x16x32_bf16 v[96:99], a[72:75], a[208:211], v[96:99]
    ds_read_b128 a[252:255], v6 offset:7168
    v_mul_u32_u24 v56, s38, v184
    v_mfma_f32_16x16x32_bf16 v[100:103], a[72:75], a[212:215], v[100:103]
    v_and_b32 v57, s39, v184
    v_mfma_f32_16x16x32_bf16 v[104:107], a[72:75], a[216:219], v[104:107]
    v_mul_u32_u24 v58, s38, v185
    v_mfma_f32_16x16x32_bf16 v[108:111], a[72:75], a[220:223], v[108:111]
    buffer_load_dwordx4 a[72:75], v1, s[12:15], s36 offen offset:2048
    v_mfma_f32_16x16x32_bf16 v[144:147], a[76:79], a[208:211], v[144:147]
    v_and_b32 v59, s39, v185
    v_mul_u32_u24 v60, s38, v188
    v_mfma_f32_16x16x32_bf16 v[148:151], a[76:79], a[212:215], v[148:151]
    v_and_b32 v61, s39, v188
    v_mfma_f32_16x16x32_bf16 v[152:155], a[76:79], a[216:219], v[152:155]
    v_mul_u32_u24 v62, s38, v189
    v_and_b32 v63, s39, v189
    v_mfma_f32_16x16x32_bf16 v[156:159], a[76:79], a[220:223], v[156:159]
    buffer_load_dwordx4 a[76:79], v1, s[12:15], s36 offen offset:3072
    s_waitcnt vmcnt(45) lgkmcnt(4)
    v_mfma_f32_16x16x32_bf16 v[80:83], a[80:83], a[224:227], v[80:83]
    ds_read_b128 a[192:195], v1 offset:0
    v_mfma_f32_16x16x32_bf16 v[84:87], a[80:83], a[228:231], v[84:87]
    ds_read_b128 a[196:199], v1 offset:1024
    v_mfma_f32_16x16x32_bf16 v[88:91], a[80:83], a[232:235], v[88:91]
    ds_read_b128 a[200:203], v1 offset:2048
    v_mfma_f32_16x16x32_bf16 v[92:95], a[80:83], a[236:239], v[92:95]
    s_add_u32 s36, s36, 4096
    buffer_load_dwordx4 a[80:83], v1, s[12:15], s36 offen offset:0
    v_mfma_f32_16x16x32_bf16 v[96:99], a[84:87], a[224:227], v[96:99]
    ds_read_b128 a[204:207], v1 offset:3072
    v_mul_u32_u24 v64, s38, v178
    v_mfma_f32_16x16x32_bf16 v[100:103], a[84:87], a[228:231], v[100:103]
    v_and_b32 v65, s39, v178
pad0_59:
    s_cbranch_execz kf_kernel_done
    v_mfma_f32_16x16x32_bf16 v[104:107], a[84:87], a[232:235], v[104:107]
    v_mul_u32_u24 v66, s38, v179
    v_mfma_f32_16x16x32_bf16 v[108:111], a[84:87], a[236:239], v[108:111]
    buffer_load_dwordx4 a[84:87], v1, s[12:15], s36 offen offset:1024
    v_mfma_f32_16x16x32_bf16 v[144:147], a[88:91], a[224:227], v[144:147]
    v_and_b32 v67, s39, v179
    v_mul_u32_u24 v68, s38, v182
    v_mfma_f32_16x16x32_bf16 v[148:151], a[88:91], a[228:231], v[148:151]
    v_and_b32 v69, s39, v182
    v_mfma_f32_16x16x32_bf16 v[152:155], a[88:91], a[232:235], v[152:155]
    v_mul_u32_u24 v70, s38, v183
    v_and_b32 v71, s39, v183
    v_mfma_f32_16x16x32_bf16 v[156:159], a[88:91], a[236:239], v[156:159]
    buffer_load_dwordx4 a[88:91], v1, s[12:15], s36 offen offset:2048
    s_waitcnt vmcnt(45) lgkmcnt(4)
    v_mfma_f32_16x16x32_bf16 v[80:83], a[92:95], a[240:243], v[80:83]
    ds_read_b128 a[208:211], v1 offset:4096
    v_mfma_f32_16x16x32_bf16 v[84:87], a[92:95], a[244:247], v[84:87]
    ds_read_b128 a[212:215], v1 offset:5120
    v_mfma_f32_16x16x32_bf16 v[88:91], a[92:95], a[248:251], v[88:91]
    ds_read_b128 a[216:219], v1 offset:6144
    v_mfma_f32_16x16x32_bf16 v[92:95], a[92:95], a[252:255], v[92:95]
    buffer_load_dwordx4 a[92:95], v1, s[12:15], s36 offen offset:3072
    v_mfma_f32_16x16x32_bf16 v[96:99], a[96:99], a[240:243], v[96:99]
    ds_read_b128 a[220:223], v1 offset:7168
    v_mul_u32_u24 v72, s38, v186
    v_mfma_f32_16x16x32_bf16 v[100:103], a[96:99], a[244:247], v[100:103]
    v_and_b32 v73, s39, v186
    v_mfma_f32_16x16x32_bf16 v[104:107], a[96:99], a[248:251], v[104:107]
    v_mul_u32_u24 v74, s38, v187
    v_mfma_f32_16x16x32_bf16 v[108:111], a[96:99], a[252:255], v[108:111]
    s_add_u32 s36, s36, 4096
    buffer_load_dwordx4 a[96:99], v1, s[12:15], s36 offen offset:0
    v_mfma_f32_16x16x32_bf16 v[144:147], a[100:103], a[240:243], v[144:147]
    v_and_b32 v75, s39, v187
    v_mul_u32_u24 v76, s38, v190
    v_mfma_f32_16x16x32_bf16 v[148:151], a[100:103], a[244:247], v[148:151]
    v_and_b32 v77, s39, v190
pad0_60:
    s_cbranch_execz kf_kernel_done
    v_mfma_f32_16x16x32_bf16 v[152:155], a[100:103], a[248:251], v[152:155]
    v_mul_u32_u24 v78, s38, v191
    v_and_b32 v79, s39, v191
    v_mfma_f32_16x16x32_bf16 v[156:159], a[100:103], a[252:255], v[156:159]
    buffer_load_dwordx4 a[100:103], v1, s[12:15], s36 offen offset:1024
    s_waitcnt vmcnt(46) lgkmcnt(4)
    v_mfma_f32_16x16x32_bf16 v[112:115], a[104:107], a[192:195], 0
    ds_read_b128 a[224:227], v1 offset:8192
    v_mfma_f32_16x16x32_bf16 v[116:119], a[104:107], a[196:199], 0
    v_mfma_f32_16x16x32_bf16 v[120:123], a[104:107], a[200:203], 0
    ds_read_b128 a[228:231], v1 offset:9216
    v_mfma_f32_16x16x32_bf16 v[124:127], a[104:107], a[204:207], 0
    buffer_load_dwordx4 a[104:107], v1, s[12:15], s36 offen offset:2048
    v_mfma_f32_16x16x32_bf16 v[128:131], a[108:111], a[192:195], 0
    ds_read_b128 a[232:235], v1 offset:10240
    v_mfma_f32_16x16x32_bf16 v[132:135], a[108:111], a[196:199], 0
    v_mfma_f32_16x16x32_bf16 v[136:139], a[108:111], a[200:203], 0
    ds_read_b128 a[236:239], v1 offset:11264
    v_mfma_f32_16x16x32_bf16 v[140:143], a[108:111], a[204:207], 0
    buffer_load_dwordx4 a[108:111], v1, s[12:15], s36 offen offset:3072
    s_waitcnt vmcnt(46) lgkmcnt(4)
    v_mfma_f32_16x16x32_bf16 v[112:115], a[112:115], a[208:211], v[112:115]
    ds_read_b128 a[240:243], v1 offset:12288
    v_mfma_f32_16x16x32_bf16 v[116:119], a[112:115], a[212:215], v[116:119]
    ds_read_b128 a[244:247], v1 offset:13312
    v_mfma_f32_16x16x32_bf16 v[120:123], a[112:115], a[216:219], v[120:123]
    ds_read_b128 a[248:251], v1 offset:14336
    v_mfma_f32_16x16x32_bf16 v[124:127], a[112:115], a[220:223], v[124:127]
    s_add_u32 s36, s36, 4096
    buffer_load_dwordx4 a[112:115], v1, s[12:15], s36 offen offset:0
    v_mfma_f32_16x16x32_bf16 v[128:131], a[116:119], a[208:211], v[128:131]
    ds_read_b128 a[252:255], v1 offset:15360
    v_cvt_pk_bf16_f32 v244, v80, v81
    v_mfma_f32_16x16x32_bf16 v[132:135], a[116:119], a[212:215], v[132:135]
pad0_61:
    s_cbranch_execz kf_kernel_done
    v_cvt_pk_bf16_f32 v245, v82, v83
    v_mfma_f32_16x16x32_bf16 v[136:139], a[116:119], a[216:219], v[136:139]
    v_cvt_pk_bf16_f32 v246, v96, v97
    v_cvt_pk_bf16_f32 v247, v98, v99
    v_mfma_f32_16x16x32_bf16 v[140:143], a[116:119], a[220:223], v[140:143]
    buffer_load_dwordx4 a[116:119], v1, s[12:15], s36 offen offset:1024
    s_waitcnt vmcnt(46) lgkmcnt(4)
    v_mfma_f32_16x16x32_bf16 v[112:115], a[120:123], a[224:227], v[112:115]
    ds_read_b128 a[192:195], v1 offset:16384
    v_mfma_f32_16x16x32_bf16 v[116:119], a[120:123], a[228:231], v[116:119]
    ds_read_b128 a[196:199], v1 offset:17408
    v_mfma_f32_16x16x32_bf16 v[120:123], a[120:123], a[232:235], v[120:123]
    ds_read_b128 a[200:203], v1 offset:18432
    v_mfma_f32_16x16x32_bf16 v[124:127], a[120:123], a[236:239], v[124:127]
    buffer_load_dwordx4 a[120:123], v1, s[12:15], s36 offen offset:2048
    v_mfma_f32_16x16x32_bf16 v[128:131], a[124:127], a[224:227], v[128:131]
    ds_read_b128 a[204:207], v1 offset:19456
    v_pk_max_i16 v244, v244, 0
    v_mfma_f32_16x16x32_bf16 v[132:135], a[124:127], a[228:231], v[132:135]
    v_pk_max_i16 v245, v245, 0
    v_mfma_f32_16x16x32_bf16 v[136:139], a[124:127], a[232:235], v[136:139]
    v_pk_max_i16 v246, v246, 0
    v_pk_max_i16 v247, v247, 0
    v_mfma_f32_16x16x32_bf16 v[140:143], a[124:127], a[236:239], v[140:143]
    buffer_load_dwordx4 a[124:127], v1, s[12:15], s36 offen offset:3072
    s_waitcnt vmcnt(46) lgkmcnt(4)
    v_mfma_f32_16x16x32_bf16 v[112:115], a[128:131], a[240:243], v[112:115]
    ds_read_b128 a[208:211], v1 offset:20480
    v_mfma_f32_16x16x32_bf16 v[116:119], a[128:131], a[244:247], v[116:119]
    ds_read_b128 a[212:215], v1 offset:21504
    v_mfma_f32_16x16x32_bf16 v[120:123], a[128:131], a[248:251], v[120:123]
    ds_read_b128 a[216:219], v1 offset:22528
pad0_62:
    s_cbranch_execz kf_kernel_done
    v_mfma_f32_16x16x32_bf16 v[124:127], a[128:131], a[252:255], v[124:127]
    s_add_u32 s36, s36, 4096
    buffer_load_dwordx4 a[128:131], v1, s[12:15], s36 offen offset:0
    v_mfma_f32_16x16x32_bf16 v[128:131], a[132:135], a[240:243], v[128:131]
    ds_read_b128 a[220:223], v1 offset:23552
    ds_write_b128 v4, v[244:247] offset:8192
    v_mfma_f32_16x16x32_bf16 v[132:135], a[132:135], a[244:247], v[132:135]
    v_cvt_pk_bf16_f32 v248, v84, v85
    v_mfma_f32_16x16x32_bf16 v[136:139], a[132:135], a[248:251], v[136:139]
    v_cvt_pk_bf16_f32 v249, v86, v87
    v_cvt_pk_bf16_f32 v250, v100, v101
    v_mfma_f32_16x16x32_bf16 v[140:143], a[132:135], a[252:255], v[140:143]
    buffer_load_dwordx4 a[132:135], v1, s[12:15], s36 offen offset:1024
    s_waitcnt vmcnt(46) lgkmcnt(5)
    v_mfma_f32_16x16x32_bf16 v[112:115], a[136:139], a[192:195], v[112:115]
    ds_read_b128 a[224:227], v1 offset:24576
    v_mfma_f32_16x16x32_bf16 v[116:119], a[136:139], a[196:199], v[116:119]
    ds_read_b128 a[228:231], v1 offset:25600
    v_mfma_f32_16x16x32_bf16 v[120:123], a[136:139], a[200:203], v[120:123]
    ds_read_b128 a[232:235], v1 offset:26624
    v_mfma_f32_16x16x32_bf16 v[124:127], a[136:139], a[204:207], v[124:127]
    buffer_load_dwordx4 a[136:139], v1, s[12:15], s36 offen offset:2048
    v_mfma_f32_16x16x32_bf16 v[128:131], a[140:143], a[192:195], v[128:131]
    ds_read_b128 a[236:239], v1 offset:27648
    v_cvt_pk_bf16_f32 v251, v102, v103
    v_mfma_f32_16x16x32_bf16 v[132:135], a[140:143], a[196:199], v[132:135]
    v_pk_max_i16 v248, v248, 0
    v_mfma_f32_16x16x32_bf16 v[136:139], a[140:143], a[200:203], v[136:139]
    v_pk_max_i16 v249, v249, 0
    v_pk_max_i16 v250, v250, 0
    v_mfma_f32_16x16x32_bf16 v[140:143], a[140:143], a[204:207], v[140:143]
    buffer_load_dwordx4 a[140:143], v1, s[12:15], s36 offen offset:3072
pad0_63:
    s_cbranch_execz kf_kernel_done
    s_waitcnt vmcnt(46) lgkmcnt(5)
    v_mfma_f32_16x16x32_bf16 v[112:115], a[160:163], a[208:211], v[112:115]
    ds_read_b128 a[240:243], v1 offset:28672
    v_mfma_f32_16x16x32_bf16 v[116:119], a[160:163], a[212:215], v[116:119]
    ds_read_b128 a[244:247], v1 offset:29696
    v_mfma_f32_16x16x32_bf16 v[120:123], a[160:163], a[216:219], v[120:123]
    ds_read_b128 a[248:251], v1 offset:30720
    v_mfma_f32_16x16x32_bf16 v[124:127], a[160:163], a[220:223], v[124:127]
    s_add_u32 s36, s36, 4096
    buffer_load_dwordx4 a[160:163], v1, s[12:15], s36 offen offset:0
    v_mfma_f32_16x16x32_bf16 v[128:131], a[164:167], a[208:211], v[128:131]
    ds_read_b128 a[252:255], v1 offset:31744
    v_pk_max_i16 v251, v251, 0
    v_mfma_f32_16x16x32_bf16 v[132:135], a[164:167], a[212:215], v[132:135]
    ds_write_b128 v4, v[248:251] offset:9216
    v_mfma_f32_16x16x32_bf16 v[136:139], a[164:167], a[216:219], v[136:139]
    v_cvt_pk_bf16_f32 v252, v88, v89
    v_cvt_pk_bf16_f32 v253, v90, v91
    v_mfma_f32_16x16x32_bf16 v[140:143], a[164:167], a[220:223], v[140:143]
    buffer_load_dwordx4 a[164:167], v1, s[12:15], s36 offen offset:1024
    s_waitcnt vmcnt(46) lgkmcnt(5)
    v_mfma_f32_16x16x32_bf16 v[112:115], a[168:171], a[224:227], v[112:115]
    ds_read_b128 a[192:195], v1 offset:32768
    v_mfma_f32_16x16x32_bf16 v[116:119], a[168:171], a[228:231], v[116:119]
    ds_read_b128 a[196:199], v1 offset:33792
    v_mfma_f32_16x16x32_bf16 v[120:123], a[168:171], a[232:235], v[120:123]
    ds_read_b128 a[200:203], v1 offset:34816
    v_mfma_f32_16x16x32_bf16 v[124:127], a[168:171], a[236:239], v[124:127]
    buffer_load_dwordx4 a[168:171], v1, s[12:15], s36 offen offset:2048
    v_mfma_f32_16x16x32_bf16 v[128:131], a[172:175], a[224:227], v[128:131]
    ds_read_b128 a[204:207], v1 offset:35840
    v_cvt_pk_bf16_f32 v254, v104, v105
    v_mfma_f32_16x16x32_bf16 v[132:135], a[172:175], a[228:231], v[132:135]
pad0_64:
    s_cbranch_execz kf_kernel_done
    v_cvt_pk_bf16_f32 v255, v106, v107
    v_mfma_f32_16x16x32_bf16 v[136:139], a[172:175], a[232:235], v[136:139]
    v_pk_max_i16 v252, v252, 0
    v_pk_max_i16 v253, v253, 0
    v_mfma_f32_16x16x32_bf16 v[140:143], a[172:175], a[236:239], v[140:143]
    buffer_load_dwordx4 a[172:175], v1, s[12:15], s36 offen offset:3072
    s_waitcnt vmcnt(46) lgkmcnt(5)
    v_mfma_f32_16x16x32_bf16 v[112:115], a[176:179], a[240:243], v[112:115]
    ds_read_b128 a[208:211], v1 offset:36864
    v_mfma_f32_16x16x32_bf16 v[116:119], a[176:179], a[244:247], v[116:119]
    ds_read_b128 a[212:215], v1 offset:37888
    v_mfma_f32_16x16x32_bf16 v[120:123], a[176:179], a[248:251], v[120:123]
    ds_read_b128 a[216:219], v1 offset:38912
    v_mfma_f32_16x16x32_bf16 v[124:127], a[176:179], a[252:255], v[124:127]
    s_add_u32 s36, s36, 4096
    buffer_load_dwordx4 a[176:179], v1, s[12:15], s36 offen offset:0
    v_mfma_f32_16x16x32_bf16 v[128:131], a[180:183], a[240:243], v[128:131]
    ds_read_b128 a[220:223], v1 offset:39936
    v_pk_max_i16 v254, v254, 0
    v_mfma_f32_16x16x32_bf16 v[132:135], a[180:183], a[244:247], v[132:135]
    v_pk_max_i16 v255, v255, 0
    v_mfma_f32_16x16x32_bf16 v[136:139], a[180:183], a[248:251], v[136:139]
    ds_write_b128 v4, v[252:255] offset:10240
    v_cvt_pk_bf16_f32 v232, v92, v93
    v_mfma_f32_16x16x32_bf16 v[140:143], a[180:183], a[252:255], v[140:143]
    buffer_load_dwordx4 a[180:183], v1, s[12:15], s36 offen offset:1024
    s_waitcnt vmcnt(46) lgkmcnt(5)
    v_mfma_f32_16x16x32_bf16 v[112:115], a[184:187], a[192:195], v[112:115]
    ds_read_b128 a[224:227], v1 offset:40960
    v_mfma_f32_16x16x32_bf16 v[116:119], a[184:187], a[196:199], v[116:119]
    ds_read_b128 a[228:231], v1 offset:41984
    v_mfma_f32_16x16x32_bf16 v[120:123], a[184:187], a[200:203], v[120:123]
pad0_65:
    s_cbranch_execz kf_kernel_done
    ds_read_b128 a[232:235], v1 offset:43008
    v_mfma_f32_16x16x32_bf16 v[124:127], a[184:187], a[204:207], v[124:127]
    buffer_load_dwordx4 a[184:187], v1, s[12:15], s36 offen offset:2048
    v_mfma_f32_16x16x32_bf16 v[128:131], a[188:191], a[192:195], v[128:131]
    ds_read_b128 a[236:239], v1 offset:44032
    v_cvt_pk_bf16_f32 v233, v94, v95
    v_mfma_f32_16x16x32_bf16 v[132:135], a[188:191], a[196:199], v[132:135]
    v_cvt_pk_bf16_f32 v234, v108, v109
    v_mfma_f32_16x16x32_bf16 v[136:139], a[188:191], a[200:203], v[136:139]
    v_cvt_pk_bf16_f32 v235, v110, v111
    v_pk_max_i16 v232, v232, 0
    v_mfma_f32_16x16x32_bf16 v[140:143], a[188:191], a[204:207], v[140:143]
    buffer_load_dwordx4 a[188:191], v1, s[12:15], s36 offen offset:3072
    s_waitcnt vmcnt(46) lgkmcnt(5)
    v_mfma_f32_16x16x32_bf16 v[112:115], a[144:147], a[208:211], v[112:115]
    ds_read_b128 a[240:243], v1 offset:45056
    v_mfma_f32_16x16x32_bf16 v[116:119], a[144:147], a[212:215], v[116:119]
    ds_read_b128 a[244:247], v1 offset:46080
    v_mfma_f32_16x16x32_bf16 v[120:123], a[144:147], a[216:219], v[120:123]
    ds_read_b128 a[248:251], v1 offset:47104
    v_mfma_f32_16x16x32_bf16 v[124:127], a[144:147], a[220:223], v[124:127]
    s_add_u32 s36, s36, 4096
    buffer_load_dwordx4 a[144:147], v1, s[12:15], s36 offen offset:0
    v_mfma_f32_16x16x32_bf16 v[128:131], a[148:151], a[208:211], v[128:131]
    ds_read_b128 a[252:255], v1 offset:48128
    v_pk_max_i16 v233, v233, 0
    v_mfma_f32_16x16x32_bf16 v[132:135], a[148:151], a[212:215], v[132:135]
    v_pk_max_i16 v234, v234, 0
    v_mfma_f32_16x16x32_bf16 v[136:139], a[148:151], a[216:219], v[136:139]
    v_pk_max_i16 v235, v235, 0
    ds_write_b128 v4, v[232:235] offset:11264
    v_mfma_f32_16x16x32_bf16 v[140:143], a[148:151], a[220:223], v[140:143]
pad0_66:
    s_cbranch_execz kf_kernel_done
    buffer_load_dwordx4 a[148:151], v1, s[12:15], s36 offen offset:1024
    s_waitcnt vmcnt(46) lgkmcnt(5)
    v_mfma_f32_16x16x32_bf16 v[112:115], a[152:155], a[224:227], v[112:115]
    ds_read_b128 a[192:195], v1 offset:49152
    v_mfma_f32_16x16x32_bf16 v[116:119], a[152:155], a[228:231], v[116:119]
    ds_read_b128 a[196:199], v1 offset:50176
    v_mfma_f32_16x16x32_bf16 v[120:123], a[152:155], a[232:235], v[120:123]
    ds_read_b128 a[200:203], v1 offset:51200
    v_mfma_f32_16x16x32_bf16 v[124:127], a[152:155], a[236:239], v[124:127]
    buffer_load_dwordx4 a[152:155], v1, s[12:15], s36 offen offset:2048
    v_mfma_f32_16x16x32_bf16 v[128:131], a[156:159], a[224:227], v[128:131]
    ds_read_b128 a[204:207], v1 offset:52224
    v_cvt_pk_bf16_f32 v236, v144, v145
    v_mfma_f32_16x16x32_bf16 v[132:135], a[156:159], a[228:231], v[132:135]
    v_cvt_pk_bf16_f32 v237, v146, v147
    v_mfma_f32_16x16x32_bf16 v[136:139], a[156:159], a[232:235], v[136:139]
    v_pk_max_i16 v236, v236, 0
    v_pk_max_i16 v237, v237, 0
    v_mfma_f32_16x16x32_bf16 v[140:143], a[156:159], a[236:239], v[140:143]
    buffer_load_dwordx4 a[156:159], v1, s[12:15], s36 offen offset:3072
    s_waitcnt vmcnt(46) lgkmcnt(5)
    v_mfma_f32_16x16x32_bf16 v[112:115], a[0:3], a[240:243], v[112:115]
    ds_read_b128 a[208:211], v1 offset:53248
    v_mfma_f32_16x16x32_bf16 v[116:119], a[0:3], a[244:247], v[116:119]
    ds_read_b128 a[212:215], v1 offset:54272
    v_mfma_f32_16x16x32_bf16 v[120:123], a[0:3], a[248:251], v[120:123]
    ds_read_b128 a[216:219], v1 offset:55296
    v_mfma_f32_16x16x32_bf16 v[124:127], a[0:3], a[252:255], v[124:127]
    s_add_u32 s36, s36, 4096
    buffer_load_dwordx4 a[0:3], v1, s[12:15], s36 offen offset:0
    v_mfma_f32_16x16x32_bf16 v[128:131], a[4:7], a[240:243], v[128:131]
    ds_read_b128 a[220:223], v1 offset:56320
    ds_write_b64 v5, v[236:237] offset:0
pad0_67:
    s_cbranch_execz kf_kernel_done
    v_mfma_f32_16x16x32_bf16 v[132:135], a[4:7], a[244:247], v[132:135]
    v_cvt_pk_bf16_f32 v240, v148, v149
    v_mfma_f32_16x16x32_bf16 v[136:139], a[4:7], a[248:251], v[136:139]
    v_cvt_pk_bf16_f32 v241, v150, v151
    v_pk_max_i16 v240, v240, 0
    v_mfma_f32_16x16x32_bf16 v[140:143], a[4:7], a[252:255], v[140:143]
    buffer_load_dwordx4 a[4:7], v1, s[12:15], s36 offen offset:1024
    s_waitcnt vmcnt(46) lgkmcnt(5)
    v_mfma_f32_16x16x32_bf16 v[112:115], a[8:11], a[192:195], v[112:115]
    ds_read_b128 a[224:227], v1 offset:57344
    v_mfma_f32_16x16x32_bf16 v[116:119], a[8:11], a[196:199], v[116:119]
    ds_read_b128 a[228:231], v1 offset:58368
    v_mfma_f32_16x16x32_bf16 v[120:123], a[8:11], a[200:203], v[120:123]
    ds_read_b128 a[232:235], v1 offset:59392
    v_mfma_f32_16x16x32_bf16 v[124:127], a[8:11], a[204:207], v[124:127]
    buffer_load_dwordx4 a[8:11], v1, s[12:15], s36 offen offset:2048
    v_mfma_f32_16x16x32_bf16 v[128:131], a[12:15], a[192:195], v[128:131]
    ds_read_b128 a[236:239], v1 offset:60416
    v_pk_max_i16 v241, v241, 0
    v_mfma_f32_16x16x32_bf16 v[132:135], a[12:15], a[196:199], v[132:135]
    ds_write_b64 v5, v[240:241] offset:1024
    v_mfma_f32_16x16x32_bf16 v[136:139], a[12:15], a[200:203], v[136:139]
    v_cvt_pk_bf16_f32 v244, v152, v153
    v_cvt_pk_bf16_f32 v245, v154, v155
    v_mfma_f32_16x16x32_bf16 v[140:143], a[12:15], a[204:207], v[140:143]
    buffer_load_dwordx4 a[12:15], v1, s[12:15], s36 offen offset:3072
    s_waitcnt vmcnt(46) lgkmcnt(6)
    v_mfma_f32_16x16x32_bf16 v[112:115], a[16:19], a[208:211], v[112:115]
    ds_read_b128 a[240:243], v1 offset:61440
    v_mfma_f32_16x16x32_bf16 v[116:119], a[16:19], a[212:215], v[116:119]
    ds_read_b128 a[244:247], v1 offset:62464
    v_mfma_f32_16x16x32_bf16 v[120:123], a[16:19], a[216:219], v[120:123]
pad0_68:
    s_cbranch_execz kf_kernel_done
    ds_read_b128 a[248:251], v1 offset:63488
    v_mfma_f32_16x16x32_bf16 v[124:127], a[16:19], a[220:223], v[124:127]
    s_add_u32 s36, s36, 4096
    buffer_load_dwordx4 a[16:19], v1, s[12:15], s36 offen offset:0
    v_mfma_f32_16x16x32_bf16 v[128:131], a[20:23], a[208:211], v[128:131]
    ds_read_b128 a[252:255], v1 offset:64512
    v_pk_max_i16 v244, v244, 0
    v_mfma_f32_16x16x32_bf16 v[132:135], a[20:23], a[212:215], v[132:135]
    v_pk_max_i16 v245, v245, 0
    v_mfma_f32_16x16x32_bf16 v[136:139], a[20:23], a[216:219], v[136:139]
    ds_write_b64 v5, v[244:245] offset:2048
    v_cvt_pk_bf16_f32 v248, v156, v157
    v_mfma_f32_16x16x32_bf16 v[140:143], a[20:23], a[220:223], v[140:143]
    buffer_load_dwordx4 a[20:23], v1, s[12:15], s36 offen offset:1024
    s_waitcnt vmcnt(46) lgkmcnt(6)
    v_mfma_f32_16x16x32_bf16 v[112:115], a[24:27], a[224:227], v[112:115]
    ds_read_b128 a[192:195], v6 offset:0
    v_mfma_f32_16x16x32_bf16 v[116:119], a[24:27], a[228:231], v[116:119]
    ds_read_b128 a[196:199], v6 offset:1024
    v_mfma_f32_16x16x32_bf16 v[120:123], a[24:27], a[232:235], v[120:123]
    ds_read_b128 a[200:203], v6 offset:2048
    v_mfma_f32_16x16x32_bf16 v[124:127], a[24:27], a[236:239], v[124:127]
    buffer_load_dwordx4 a[24:27], v1, s[12:15], s36 offen offset:2048
    v_mfma_f32_16x16x32_bf16 v[128:131], a[28:31], a[224:227], v[128:131]
    ds_read_b128 a[204:207], v6 offset:3072
    v_cvt_pk_bf16_f32 v249, v158, v159
    v_mfma_f32_16x16x32_bf16 v[132:135], a[28:31], a[228:231], v[132:135]
    v_pk_max_i16 v248, v248, 0
    v_mfma_f32_16x16x32_bf16 v[136:139], a[28:31], a[232:235], v[136:139]
    v_pk_max_i16 v249, v249, 0
    ds_write_b64 v5, v[248:249] offset:3072
    v_mfma_f32_16x16x32_bf16 v[140:143], a[28:31], a[236:239], v[140:143]
pad0_69:
    s_cbranch_execz kf_kernel_done
    buffer_load_dwordx4 a[28:31], v1, s[12:15], s36 offen offset:3072
    s_waitcnt vmcnt(46) lgkmcnt(6)
    v_mfma_f32_16x16x32_bf16 v[112:115], a[32:35], a[240:243], v[112:115]
    ds_read_b128 a[208:211], v6 offset:4096
    v_mfma_f32_16x16x32_bf16 v[116:119], a[32:35], a[244:247], v[116:119]
    v_mfma_f32_16x16x32_bf16 v[120:123], a[32:35], a[248:251], v[120:123]
    ds_read_b128 a[212:215], v6 offset:5120
    v_mfma_f32_16x16x32_bf16 v[124:127], a[32:35], a[252:255], v[124:127]
    s_add_u32 s36, s36, 4096
    buffer_load_dwordx4 a[32:35], v1, s[12:15], s36 offen offset:0
    v_mfma_f32_16x16x32_bf16 v[128:131], a[36:39], a[240:243], v[128:131]
    ds_read_b128 a[216:219], v6 offset:6144
    v_mfma_f32_16x16x32_bf16 v[132:135], a[36:39], a[244:247], v[132:135]
    v_mfma_f32_16x16x32_bf16 v[136:139], a[36:39], a[248:251], v[136:139]
    ds_read_b128 a[220:223], v6 offset:7168
    v_mfma_f32_16x16x32_bf16 v[140:143], a[36:39], a[252:255], v[140:143]
    buffer_load_dwordx4 a[36:39], v1, s[12:15], s36 offen offset:1024
    s_waitcnt lgkmcnt(0)
    s_barrier
    s_waitcnt vmcnt(46)
    v_mfma_f32_16x16x32_bf16 v[112:115], a[40:43], a[192:195], v[112:115]
    ds_read_b128 a[224:227], v6 offset:8192
    v_mfma_f32_16x16x32_bf16 v[116:119], a[40:43], a[196:199], v[116:119]
    v_mfma_f32_16x16x32_bf16 v[120:123], a[40:43], a[200:203], v[120:123]
    ds_read_b128 a[228:231], v6 offset:9216
    v_mfma_f32_16x16x32_bf16 v[124:127], a[40:43], a[204:207], v[124:127]
    buffer_load_dwordx4 a[40:43], v1, s[12:15], s36 offen offset:2048
    v_mfma_f32_16x16x32_bf16 v[128:131], a[44:47], a[192:195], v[128:131]
    ds_read_b128 a[232:235], v6 offset:10240
    v_mfma_f32_16x16x32_bf16 v[132:135], a[44:47], a[196:199], v[132:135]
    v_mfma_f32_16x16x32_bf16 v[136:139], a[44:47], a[200:203], v[136:139]
    ds_read_b128 a[236:239], v6 offset:11264
    v_mfma_f32_16x16x32_bf16 v[140:143], a[44:47], a[204:207], v[140:143]
    buffer_load_dwordx4 a[44:47], v1, s[12:15], s36 offen offset:3072
pad0_70:
    s_cbranch_execz kf_kernel_done
    s_waitcnt vmcnt(46)
    v_mfma_f32_16x16x32_bf16 v[112:115], a[48:51], a[208:211], v[112:115]
    ds_read_b128 a[240:243], v6 offset:12288
    v_mfma_f32_16x16x32_bf16 v[116:119], a[48:51], a[212:215], v[116:119]
    v_mfma_f32_16x16x32_bf16 v[120:123], a[48:51], a[216:219], v[120:123]
    ds_read_b128 a[244:247], v6 offset:13312
    v_mfma_f32_16x16x32_bf16 v[124:127], a[48:51], a[220:223], v[124:127]
    s_add_u32 s36, s36, 4096
    buffer_load_dwordx4 a[48:51], v1, s[12:15], s36 offen offset:0
    v_mfma_f32_16x16x32_bf16 v[128:131], a[52:55], a[208:211], v[128:131]
    ds_read_b128 a[248:251], v6 offset:14336
    v_mfma_f32_16x16x32_bf16 v[132:135], a[52:55], a[212:215], v[132:135]
    v_mfma_f32_16x16x32_bf16 v[136:139], a[52:55], a[216:219], v[136:139]
    ds_read_b128 a[252:255], v6 offset:15360
    v_mfma_f32_16x16x32_bf16 v[140:143], a[52:55], a[220:223], v[140:143]
    buffer_load_dwordx4 a[52:55], v1, s[12:15], s36 offen offset:1024
    s_waitcnt vmcnt(44) lgkmcnt(4)
    v_mfma_f32_16x16x32_bf16 v[16:19], a[56:59], a[224:227], v[16:19]
    ds_read_b128 a[192:195], v6 offset:16384
    v_mfma_f32_16x16x32_bf16 v[20:23], a[56:59], a[228:231], v[20:23]
    v_mfma_f32_16x16x32_bf16 v[24:27], a[56:59], a[232:235], v[24:27]
    v_mfma_f32_16x16x32_bf16 v[28:31], a[56:59], a[236:239], v[28:31]
    buffer_load_dwordx4 a[56:59], v1, s[12:15], s36 offen offset:2048
    v_mfma_f32_16x16x32_bf16 v[32:35], a[60:63], a[224:227], v[32:35]
    ds_read_b128 a[196:199], v6 offset:17408
    v_mfma_f32_16x16x32_bf16 v[36:39], a[60:63], a[228:231], v[36:39]
    v_mfma_f32_16x16x32_bf16 v[40:43], a[60:63], a[232:235], v[40:43]
    v_mfma_f32_16x16x32_bf16 v[44:47], a[60:63], a[236:239], v[44:47]
    buffer_load_dwordx4 a[60:63], v1, s[12:15], s36 offen offset:3072
    v_mfma_f32_16x16x32_bf16 v[48:51], a[64:67], a[224:227], v[48:51]
    ds_read_b128 a[200:203], v6 offset:18432
    v_mfma_f32_16x16x32_bf16 v[52:55], a[64:67], a[228:231], v[52:55]
pad0_71:
    s_cbranch_execz kf_kernel_done
    v_mfma_f32_16x16x32_bf16 v[56:59], a[64:67], a[232:235], v[56:59]
    v_mfma_f32_16x16x32_bf16 v[60:63], a[64:67], a[236:239], v[60:63]
    s_add_u32 s36, s36, 4096
    buffer_load_dwordx4 a[64:67], v1, s[12:15], s36 offen offset:0
    v_mfma_f32_16x16x32_bf16 v[64:67], a[68:71], a[224:227], v[64:67]
    ds_read_b128 a[204:207], v6 offset:19456
    v_mfma_f32_16x16x32_bf16 v[68:71], a[68:71], a[228:231], v[68:71]
    v_mfma_f32_16x16x32_bf16 v[72:75], a[68:71], a[232:235], v[72:75]
    v_mfma_f32_16x16x32_bf16 v[76:79], a[68:71], a[236:239], v[76:79]
    buffer_load_dwordx4 a[68:71], v1, s[12:15], s36 offen offset:1024
    s_waitcnt vmcnt(44) lgkmcnt(4)
    v_mfma_f32_16x16x32_bf16 v[16:19], a[72:75], a[240:243], v[16:19]
    ds_read_b128 a[208:211], v6 offset:24576
    v_mfma_f32_16x16x32_bf16 v[20:23], a[72:75], a[244:247], v[20:23]
    v_mfma_f32_16x16x32_bf16 v[24:27], a[72:75], a[248:251], v[24:27]
    ds_read_b128 a[212:215], v6 offset:25600
    v_mfma_f32_16x16x32_bf16 v[28:31], a[72:75], a[252:255], v[28:31]
    buffer_load_dwordx4 a[72:75], v1, s[12:15], s36 offen offset:2048
    v_mfma_f32_16x16x32_bf16 v[32:35], a[76:79], a[240:243], v[32:35]
    ds_read_b128 a[216:219], v6 offset:26624
    v_mfma_f32_16x16x32_bf16 v[36:39], a[76:79], a[244:247], v[36:39]
    v_mfma_f32_16x16x32_bf16 v[40:43], a[76:79], a[248:251], v[40:43]
    ds_read_b128 a[220:223], v6 offset:27648
    v_mfma_f32_16x16x32_bf16 v[44:47], a[76:79], a[252:255], v[44:47]
    buffer_load_dwordx4 a[76:79], v1, s[12:15], s36 offen offset:3072
    v_mfma_f32_16x16x32_bf16 v[48:51], a[80:83], a[240:243], v[48:51]
    v_cvt_pk_bf16_f32 v252, v112, v113
    v_mfma_f32_16x16x32_bf16 v[52:55], a[80:83], a[244:247], v[52:55]
    v_mfma_f32_16x16x32_bf16 v[56:59], a[80:83], a[248:251], v[56:59]
    v_cvt_pk_bf16_f32 v253, v114, v115
    v_mfma_f32_16x16x32_bf16 v[60:63], a[80:83], a[252:255], v[60:63]
    s_add_u32 s36, s36, 4096
pad0_72:
    s_cbranch_execz kf_kernel_done
    buffer_load_dwordx4 a[80:83], v1, s[12:15], s36 offen offset:0
    v_mfma_f32_16x16x32_bf16 v[64:67], a[84:87], a[240:243], v[64:67]
    v_cvt_pk_bf16_f32 v254, v128, v129
    v_mfma_f32_16x16x32_bf16 v[68:71], a[84:87], a[244:247], v[68:71]
    v_mfma_f32_16x16x32_bf16 v[72:75], a[84:87], a[248:251], v[72:75]
    v_cvt_pk_bf16_f32 v255, v130, v131
    v_mfma_f32_16x16x32_bf16 v[76:79], a[84:87], a[252:255], v[76:79]
    buffer_load_dwordx4 a[84:87], v1, s[12:15], s36 offen offset:1024
    s_waitcnt vmcnt(44) lgkmcnt(4)
    v_mfma_f32_16x16x32_bf16 v[16:19], a[88:91], a[192:195], v[16:19]
    ds_read_b128 a[224:227], v6 offset:28672
    v_mfma_f32_16x16x32_bf16 v[20:23], a[88:91], a[196:199], v[20:23]
    ds_read_b128 a[228:231], v6 offset:29696
    v_mfma_f32_16x16x32_bf16 v[24:27], a[88:91], a[200:203], v[24:27]
    v_mfma_f32_16x16x32_bf16 v[28:31], a[88:91], a[204:207], v[28:31]
    buffer_load_dwordx4 a[88:91], v1, s[12:15], s36 offen offset:2048
    v_mfma_f32_16x16x32_bf16 v[32:35], a[92:95], a[192:195], v[32:35]
    ds_read_b128 a[232:235], v6 offset:30720
    v_mfma_f32_16x16x32_bf16 v[36:39], a[92:95], a[196:199], v[36:39]
    ds_read_b128 a[236:239], v6 offset:31744
    v_mfma_f32_16x16x32_bf16 v[40:43], a[92:95], a[200:203], v[40:43]
    v_mfma_f32_16x16x32_bf16 v[44:47], a[92:95], a[204:207], v[44:47]
    buffer_load_dwordx4 a[92:95], v1, s[12:15], s36 offen offset:3072
    v_mfma_f32_16x16x32_bf16 v[48:51], a[96:99], a[192:195], v[48:51]
    v_pk_max_i16 v252, v252, 0
    v_pk_max_i16 v253, v253, 0
    v_mfma_f32_16x16x32_bf16 v[52:55], a[96:99], a[196:199], v[52:55]
    v_mfma_f32_16x16x32_bf16 v[56:59], a[96:99], a[200:203], v[56:59]
    v_pk_max_i16 v254, v254, 0
    v_mfma_f32_16x16x32_bf16 v[60:63], a[96:99], a[204:207], v[60:63]
    s_add_u32 s36, s36, 4096
    buffer_load_dwordx4 a[96:99], v1, s[12:15], s36 offen offset:0
pad0_73:
    s_cbranch_execz kf_kernel_done
    v_mfma_f32_16x16x32_bf16 v[64:67], a[100:103], a[192:195], v[64:67]
    v_pk_max_i16 v255, v255, 0
    v_mfma_f32_16x16x32_bf16 v[68:71], a[100:103], a[196:199], v[68:71]
    v_mfma_f32_16x16x32_bf16 v[72:75], a[100:103], a[200:203], v[72:75]
    ds_write_b128 v4, v[252:255] offset:12288
    v_mfma_f32_16x16x32_bf16 v[76:79], a[100:103], a[204:207], v[76:79]
    buffer_load_dwordx4 a[100:103], v1, s[12:15], s36 offen offset:1024
    s_waitcnt vmcnt(44) lgkmcnt(5)
    v_mfma_f32_16x16x32_bf16 v[16:19], a[104:107], a[208:211], v[16:19]
    ds_read_b128 a[240:243], v6 offset:32768
    v_mfma_f32_16x16x32_bf16 v[20:23], a[104:107], a[212:215], v[20:23]
    v_mfma_f32_16x16x32_bf16 v[24:27], a[104:107], a[216:219], v[24:27]
    ds_read_b128 a[244:247], v6 offset:33792
    v_mfma_f32_16x16x32_bf16 v[28:31], a[104:107], a[220:223], v[28:31]
    buffer_load_dwordx4 a[104:107], v1, s[12:15], s36 offen offset:2048
    v_mfma_f32_16x16x32_bf16 v[32:35], a[108:111], a[208:211], v[32:35]
    ds_read_b128 a[248:251], v6 offset:34816
    v_mfma_f32_16x16x32_bf16 v[36:39], a[108:111], a[212:215], v[36:39]
    v_mfma_f32_16x16x32_bf16 v[40:43], a[108:111], a[216:219], v[40:43]
    ds_read_b128 a[252:255], v6 offset:35840
    v_mfma_f32_16x16x32_bf16 v[44:47], a[108:111], a[220:223], v[44:47]
    buffer_load_dwordx4 a[108:111], v1, s[12:15], s36 offen offset:3072
    v_mfma_f32_16x16x32_bf16 v[48:51], a[112:115], a[208:211], v[48:51]
    v_cvt_pk_bf16_f32 v232, v116, v117
    v_mfma_f32_16x16x32_bf16 v[52:55], a[112:115], a[212:215], v[52:55]
    v_mfma_f32_16x16x32_bf16 v[56:59], a[112:115], a[216:219], v[56:59]
    v_cvt_pk_bf16_f32 v233, v118, v119
    v_mfma_f32_16x16x32_bf16 v[60:63], a[112:115], a[220:223], v[60:63]
    s_add_u32 s36, s36, 4096
    buffer_load_dwordx4 a[112:115], v1, s[12:15], s36 offen offset:0
    v_mfma_f32_16x16x32_bf16 v[64:67], a[116:119], a[208:211], v[64:67]
    v_cvt_pk_bf16_f32 v234, v132, v133
pad0_74:
    s_cbranch_execz kf_kernel_done
    v_mfma_f32_16x16x32_bf16 v[68:71], a[116:119], a[212:215], v[68:71]
    v_mfma_f32_16x16x32_bf16 v[72:75], a[116:119], a[216:219], v[72:75]
    v_cvt_pk_bf16_f32 v235, v134, v135
    v_mfma_f32_16x16x32_bf16 v[76:79], a[116:119], a[220:223], v[76:79]
    buffer_load_dwordx4 a[116:119], v1, s[12:15], s36 offen offset:1024
    s_waitcnt vmcnt(44) lgkmcnt(5)
    v_mfma_f32_16x16x32_bf16 v[16:19], a[120:123], a[224:227], v[16:19]
    ds_read_b128 a[192:195], v6 offset:40960
    v_mfma_f32_16x16x32_bf16 v[20:23], a[120:123], a[228:231], v[20:23]
    ds_read_b128 a[196:199], v6 offset:41984
    v_mfma_f32_16x16x32_bf16 v[24:27], a[120:123], a[232:235], v[24:27]
    v_mfma_f32_16x16x32_bf16 v[28:31], a[120:123], a[236:239], v[28:31]
    buffer_load_dwordx4 a[120:123], v1, s[12:15], s36 offen offset:2048
    v_mfma_f32_16x16x32_bf16 v[32:35], a[124:127], a[224:227], v[32:35]
    ds_read_b128 a[200:203], v6 offset:43008
    v_mfma_f32_16x16x32_bf16 v[36:39], a[124:127], a[228:231], v[36:39]
    ds_read_b128 a[204:207], v6 offset:44032
    v_mfma_f32_16x16x32_bf16 v[40:43], a[124:127], a[232:235], v[40:43]
    v_mfma_f32_16x16x32_bf16 v[44:47], a[124:127], a[236:239], v[44:47]
    buffer_load_dwordx4 a[124:127], v1, s[12:15], s36 offen offset:3072
    v_mfma_f32_16x16x32_bf16 v[48:51], a[128:131], a[224:227], v[48:51]
    v_pk_max_i16 v232, v232, 0
    v_pk_max_i16 v233, v233, 0
    v_mfma_f32_16x16x32_bf16 v[52:55], a[128:131], a[228:231], v[52:55]
    v_mfma_f32_16x16x32_bf16 v[56:59], a[128:131], a[232:235], v[56:59]
    v_pk_max_i16 v234, v234, 0
    v_mfma_f32_16x16x32_bf16 v[60:63], a[128:131], a[236:239], v[60:63]
    s_add_u32 s36, s36, 4096
    buffer_load_dwordx4 a[128:131], v1, s[12:15], s36 offen offset:0
    v_mfma_f32_16x16x32_bf16 v[64:67], a[132:135], a[224:227], v[64:67]
    v_pk_max_i16 v235, v235, 0
    v_mfma_f32_16x16x32_bf16 v[68:71], a[132:135], a[228:231], v[68:71]
pad0_75:
    s_cbranch_execz kf_kernel_done
    v_mfma_f32_16x16x32_bf16 v[72:75], a[132:135], a[232:235], v[72:75]
    ds_write_b128 v4, v[232:235] offset:13312
    v_mfma_f32_16x16x32_bf16 v[76:79], a[132:135], a[236:239], v[76:79]
    buffer_load_dwordx4 a[132:135], v1, s[12:15], s36 offen offset:1024
    s_waitcnt vmcnt(44) lgkmcnt(5)
    v_mfma_f32_16x16x32_bf16 v[16:19], a[136:139], a[240:243], v[16:19]
    ds_read_b128 a[208:211], v6 offset:45056
    v_mfma_f32_16x16x32_bf16 v[20:23], a[136:139], a[244:247], v[20:23]
    v_mfma_f32_16x16x32_bf16 v[24:27], a[136:139], a[248:251], v[24:27]
    ds_read_b128 a[212:215], v6 offset:46080
    v_mfma_f32_16x16x32_bf16 v[28:31], a[136:139], a[252:255], v[28:31]
    buffer_load_dwordx4 a[136:139], v1, s[12:15], s36 offen offset:2048
    v_mfma_f32_16x16x32_bf16 v[32:35], a[140:143], a[240:243], v[32:35]
    ds_read_b128 a[216:219], v6 offset:47104
    v_mfma_f32_16x16x32_bf16 v[36:39], a[140:143], a[244:247], v[36:39]
    v_mfma_f32_16x16x32_bf16 v[40:43], a[140:143], a[248:251], v[40:43]
    ds_read_b128 a[220:223], v6 offset:48128
    v_mfma_f32_16x16x32_bf16 v[44:47], a[140:143], a[252:255], v[44:47]
    buffer_load_dwordx4 a[140:143], v1, s[12:15], s36 offen offset:3072
    v_mfma_f32_16x16x32_bf16 v[48:51], a[160:163], a[240:243], v[48:51]
    v_cvt_pk_bf16_f32 v236, v120, v121
    v_mfma_f32_16x16x32_bf16 v[52:55], a[160:163], a[244:247], v[52:55]
    v_mfma_f32_16x16x32_bf16 v[56:59], a[160:163], a[248:251], v[56:59]
    v_cvt_pk_bf16_f32 v237, v122, v123
    v_mfma_f32_16x16x32_bf16 v[60:63], a[160:163], a[252:255], v[60:63]
    s_add_u32 s36, s36, 4096
    buffer_load_dwordx4 a[160:163], v1, s[12:15], s36 offen offset:0
    v_mfma_f32_16x16x32_bf16 v[64:67], a[164:167], a[240:243], v[64:67]
    v_cvt_pk_bf16_f32 v238, v136, v137
    v_mfma_f32_16x16x32_bf16 v[68:71], a[164:167], a[244:247], v[68:71]
    v_mfma_f32_16x16x32_bf16 v[72:75], a[164:167], a[248:251], v[72:75]
    v_cvt_pk_bf16_f32 v239, v138, v139
pad0_76:
    s_cbranch_execz kf_kernel_done
    v_mfma_f32_16x16x32_bf16 v[76:79], a[164:167], a[252:255], v[76:79]
    buffer_load_dwordx4 a[164:167], v1, s[12:15], s36 offen offset:1024
    s_waitcnt vmcnt(44) lgkmcnt(5)
    v_mfma_f32_16x16x32_bf16 v[16:19], a[168:171], a[192:195], v[16:19]
    ds_read_b128 a[224:227], v6 offset:49152
    v_mfma_f32_16x16x32_bf16 v[20:23], a[168:171], a[196:199], v[20:23]
    ds_read_b128 a[228:231], v6 offset:50176
    v_mfma_f32_16x16x32_bf16 v[24:27], a[168:171], a[200:203], v[24:27]
    v_mfma_f32_16x16x32_bf16 v[28:31], a[168:171], a[204:207], v[28:31]
    buffer_load_dwordx4 a[168:171], v1, s[12:15], s36 offen offset:2048
    v_mfma_f32_16x16x32_bf16 v[32:35], a[172:175], a[192:195], v[32:35]
    ds_read_b128 a[232:235], v6 offset:51200
    v_mfma_f32_16x16x32_bf16 v[36:39], a[172:175], a[196:199], v[36:39]
    ds_read_b128 a[236:239], v6 offset:52224
    v_mfma_f32_16x16x32_bf16 v[40:43], a[172:175], a[200:203], v[40:43]
    v_mfma_f32_16x16x32_bf16 v[44:47], a[172:175], a[204:207], v[44:47]
    buffer_load_dwordx4 a[172:175], v1, s[12:15], s36 offen offset:3072
    v_mfma_f32_16x16x32_bf16 v[48:51], a[176:179], a[192:195], v[48:51]
    v_pk_max_i16 v236, v236, 0
    v_pk_max_i16 v237, v237, 0
    v_mfma_f32_16x16x32_bf16 v[52:55], a[176:179], a[196:199], v[52:55]
    v_mfma_f32_16x16x32_bf16 v[56:59], a[176:179], a[200:203], v[56:59]
    v_pk_max_i16 v238, v238, 0
    v_mfma_f32_16x16x32_bf16 v[60:63], a[176:179], a[204:207], v[60:63]
    s_add_u32 s36, s36, 4096
    buffer_load_dwordx4 a[176:179], v1, s[12:15], s36 offen offset:0
    v_mfma_f32_16x16x32_bf16 v[64:67], a[180:183], a[192:195], v[64:67]
    v_pk_max_i16 v239, v239, 0
    v_mfma_f32_16x16x32_bf16 v[68:71], a[180:183], a[196:199], v[68:71]
    v_mfma_f32_16x16x32_bf16 v[72:75], a[180:183], a[200:203], v[72:75]
    ds_write_b128 v4, v[236:239] offset:14336
    v_mfma_f32_16x16x32_bf16 v[76:79], a[180:183], a[204:207], v[76:79]
pad0_77:
    s_cbranch_execz kf_kernel_done
    buffer_load_dwordx4 a[180:183], v1, s[12:15], s36 offen offset:1024
    s_waitcnt vmcnt(44) lgkmcnt(5)
    v_mfma_f32_16x16x32_bf16 v[16:19], a[184:187], a[208:211], v[16:19]
    ds_read_b128 a[240:243], v6 offset:57344
    v_mfma_f32_16x16x32_bf16 v[20:23], a[184:187], a[212:215], v[20:23]
    v_mfma_f32_16x16x32_bf16 v[24:27], a[184:187], a[216:219], v[24:27]
    ds_read_b128 a[244:247], v6 offset:58368
    v_mfma_f32_16x16x32_bf16 v[28:31], a[184:187], a[220:223], v[28:31]
    buffer_load_dwordx4 a[184:187], v1, s[12:15], s36 offen offset:2048
    v_mfma_f32_16x16x32_bf16 v[32:35], a[188:191], a[208:211], v[32:35]
    ds_read_b128 a[248:251], v6 offset:59392
    v_mfma_f32_16x16x32_bf16 v[36:39], a[188:191], a[212:215], v[36:39]
    v_mfma_f32_16x16x32_bf16 v[40:43], a[188:191], a[216:219], v[40:43]
    ds_read_b128 a[252:255], v6 offset:60416
    v_mfma_f32_16x16x32_bf16 v[44:47], a[188:191], a[220:223], v[44:47]
    buffer_load_dwordx4 a[188:191], v1, s[12:15], s36 offen offset:3072
    v_mfma_f32_16x16x32_bf16 v[48:51], a[144:147], a[208:211], v[48:51]
    v_cvt_pk_bf16_f32 v240, v124, v125
    v_mfma_f32_16x16x32_bf16 v[52:55], a[144:147], a[212:215], v[52:55]
    v_mfma_f32_16x16x32_bf16 v[56:59], a[144:147], a[216:219], v[56:59]
    v_cvt_pk_bf16_f32 v241, v126, v127
    v_mfma_f32_16x16x32_bf16 v[60:63], a[144:147], a[220:223], v[60:63]
    s_add_u32 s36, s36, 4096
    buffer_load_dwordx4 a[144:147], v1, s[12:15], s36 offen offset:0
    v_mfma_f32_16x16x32_bf16 v[64:67], a[148:151], a[208:211], v[64:67]
    v_cvt_pk_bf16_f32 v242, v140, v141
    v_mfma_f32_16x16x32_bf16 v[68:71], a[148:151], a[212:215], v[68:71]
    v_mfma_f32_16x16x32_bf16 v[72:75], a[148:151], a[216:219], v[72:75]
    v_cvt_pk_bf16_f32 v243, v142, v143
    v_mfma_f32_16x16x32_bf16 v[76:79], a[148:151], a[220:223], v[76:79]
    buffer_load_dwordx4 a[148:151], v1, s[12:15], s36 offen offset:1024
    s_waitcnt vmcnt(44) lgkmcnt(5)
    v_mfma_f32_16x16x32_bf16 v[16:19], a[152:155], a[224:227], v[16:19]
pad0_78:
    s_cbranch_execz kf_kernel_done
    ds_read_b128 a[192:195], v6 offset:61440
    v_mfma_f32_16x16x32_bf16 v[20:23], a[152:155], a[228:231], v[20:23]
    ds_read_b128 a[196:199], v6 offset:62464
    v_mfma_f32_16x16x32_bf16 v[24:27], a[152:155], a[232:235], v[24:27]
    v_mfma_f32_16x16x32_bf16 v[28:31], a[152:155], a[236:239], v[28:31]
    buffer_load_dwordx4 a[152:155], v1, s[12:15], s36 offen offset:2048
    v_mfma_f32_16x16x32_bf16 v[32:35], a[156:159], a[224:227], v[32:35]
    ds_read_b128 a[200:203], v6 offset:63488
    v_mfma_f32_16x16x32_bf16 v[36:39], a[156:159], a[228:231], v[36:39]
    ds_read_b128 a[204:207], v6 offset:64512
    v_mfma_f32_16x16x32_bf16 v[40:43], a[156:159], a[232:235], v[40:43]
    v_mfma_f32_16x16x32_bf16 v[44:47], a[156:159], a[236:239], v[44:47]
    buffer_load_dwordx4 a[156:159], v1, s[12:15], s36 offen offset:3072
    v_mfma_f32_16x16x32_bf16 v[48:51], a[0:3], a[224:227], v[48:51]
    v_pk_max_i16 v240, v240, 0
    v_pk_max_i16 v241, v241, 0
    v_mfma_f32_16x16x32_bf16 v[52:55], a[0:3], a[228:231], v[52:55]
    v_mfma_f32_16x16x32_bf16 v[56:59], a[0:3], a[232:235], v[56:59]
    v_pk_max_i16 v242, v242, 0
    v_mfma_f32_16x16x32_bf16 v[60:63], a[0:3], a[236:239], v[60:63]
    s_add_u32 s36, s36, 4096
    buffer_load_dwordx4 a[0:3], v1, s[12:15], s36 offen offset:0
    v_mfma_f32_16x16x32_bf16 v[64:67], a[4:7], a[224:227], v[64:67]
    v_pk_max_i16 v243, v243, 0
    v_mfma_f32_16x16x32_bf16 v[68:71], a[4:7], a[228:231], v[68:71]
    v_mfma_f32_16x16x32_bf16 v[72:75], a[4:7], a[232:235], v[72:75]
    ds_write_b128 v4, v[240:243] offset:15360
    v_mfma_f32_16x16x32_bf16 v[76:79], a[4:7], a[236:239], v[76:79]
    buffer_load_dwordx4 a[4:7], v1, s[12:15], s36 offen offset:1024
    s_waitcnt vmcnt(44) lgkmcnt(5)
    v_mfma_f32_16x16x32_bf16 v[16:19], a[8:11], a[240:243], v[16:19]
    ds_read_b128 a[208:211], v7 offset:0
pad0_79:
    s_cbranch_execz kf_kernel_done
    v_mfma_f32_16x16x32_bf16 v[20:23], a[8:11], a[244:247], v[20:23]
    ds_read_b128 a[212:215], v7 offset:1024
    v_mfma_f32_16x16x32_bf16 v[24:27], a[8:11], a[248:251], v[24:27]
    ds_read_b128 a[216:219], v7 offset:2048
    v_mfma_f32_16x16x32_bf16 v[28:31], a[8:11], a[252:255], v[28:31]
    buffer_load_dwordx4 a[8:11], v1, s[12:15], s36 offen offset:2048
    v_mfma_f32_16x16x32_bf16 v[32:35], a[12:15], a[240:243], v[32:35]
    ds_read_b128 a[220:223], v7 offset:3072
    v_mfma_f32_16x16x32_bf16 v[36:39], a[12:15], a[244:247], v[36:39]
    v_mul_u32_u24 v80, s38, v192
    v_mfma_f32_16x16x32_bf16 v[40:43], a[12:15], a[248:251], v[40:43]
    v_and_b32 v81, s39, v192
    v_mfma_f32_16x16x32_bf16 v[44:47], a[12:15], a[252:255], v[44:47]
    buffer_load_dwordx4 a[12:15], v1, s[12:15], s36 offen offset:3072
    v_mfma_f32_16x16x32_bf16 v[48:51], a[16:19], a[240:243], v[48:51]
    v_mul_u32_u24 v82, s38, v193
    v_mfma_f32_16x16x32_bf16 v[52:55], a[16:19], a[244:247], v[52:55]
    v_and_b32 v83, s39, v193
    v_mfma_f32_16x16x32_bf16 v[56:59], a[16:19], a[248:251], v[56:59]
    v_mul_u32_u24 v84, s38, v196
    v_mfma_f32_16x16x32_bf16 v[60:63], a[16:19], a[252:255], v[60:63]
    s_add_u32 s36, s36, 4096
    buffer_load_dwordx4 a[16:19], v1, s[12:15], s36 offen offset:0
    v_mfma_f32_16x16x32_bf16 v[64:67], a[20:23], a[240:243], v[64:67]
    v_and_b32 v85, s39, v196
    v_mfma_f32_16x16x32_bf16 v[68:71], a[20:23], a[244:247], v[68:71]
    v_mul_u32_u24 v86, s38, v197
    v_mfma_f32_16x16x32_bf16 v[72:75], a[20:23], a[248:251], v[72:75]
    v_and_b32 v87, s39, v197
    v_mfma_f32_16x16x32_bf16 v[76:79], a[20:23], a[252:255], v[76:79]
    buffer_load_dwordx4 a[20:23], v1, s[12:15], s36 offen offset:1024
    s_waitcnt lgkmcnt(0)
    s_barrier
    s_waitcnt vmcnt(44)
    v_mfma_f32_16x16x32_bf16 v[16:19], a[24:27], a[192:195], v[16:19]
    ds_read_b128 a[224:227], v7 offset:8192
    v_mfma_f32_16x16x32_bf16 v[20:23], a[24:27], a[196:199], v[20:23]
pad0_80:
    s_cbranch_execz kf_kernel_done
    ds_read_b128 a[228:231], v7 offset:9216
    v_mfma_f32_16x16x32_bf16 v[24:27], a[24:27], a[200:203], v[24:27]
    ds_read_b128 a[232:235], v7 offset:10240
    v_mfma_f32_16x16x32_bf16 v[28:31], a[24:27], a[204:207], v[28:31]
    buffer_load_dwordx4 a[24:27], v1, s[12:15], s36 offen offset:2048
    v_mfma_f32_16x16x32_bf16 v[32:35], a[28:31], a[192:195], v[32:35]
    ds_read_b128 a[236:239], v7 offset:11264
    v_mul_u32_u24 v88, s38, v200
    v_mfma_f32_16x16x32_bf16 v[36:39], a[28:31], a[196:199], v[36:39]
    v_mfma_f32_16x16x32_bf16 v[40:43], a[28:31], a[200:203], v[40:43]
    v_and_b32 v89, s39, v200
    v_mfma_f32_16x16x32_bf16 v[44:47], a[28:31], a[204:207], v[44:47]
    buffer_load_dwordx4 a[28:31], v1, s[12:15], s36 offen offset:3072
    v_mfma_f32_16x16x32_bf16 v[48:51], a[32:35], a[192:195], v[48:51]
    v_mul_u32_u24 v90, s38, v201
    v_and_b32 v91, s39, v201
    v_mfma_f32_16x16x32_bf16 v[52:55], a[32:35], a[196:199], v[52:55]
    v_mul_u32_u24 v92, s38, v204
    v_mfma_f32_16x16x32_bf16 v[56:59], a[32:35], a[200:203], v[56:59]
    v_mfma_f32_16x16x32_bf16 v[60:63], a[32:35], a[204:207], v[60:63]
    s_add_u32 s36, s36, 4096
    buffer_load_dwordx4 a[32:35], v1, s[12:15], s36 offen offset:0
    v_mfma_f32_16x16x32_bf16 v[64:67], a[36:39], a[192:195], v[64:67]
    v_and_b32 v93, s39, v204
    v_mul_u32_u24 v94, s38, v205
    v_mfma_f32_16x16x32_bf16 v[68:71], a[36:39], a[196:199], v[68:71]
    v_and_b32 v95, s39, v205
    v_mfma_f32_16x16x32_bf16 v[72:75], a[36:39], a[200:203], v[72:75]
    v_mul_u32_u24 v96, s38, v194
    v_mfma_f32_16x16x32_bf16 v[76:79], a[36:39], a[204:207], v[76:79]
    buffer_load_dwordx4 a[36:39], v1, s[12:15], s36 offen offset:1024
    s_waitcnt vmcnt(44)
    v_mfma_f32_16x16x32_bf16 v[16:19], a[40:43], a[208:211], v[16:19]
    ds_read_b128 a[240:243], v7 offset:12288
    v_mfma_f32_16x16x32_bf16 v[20:23], a[40:43], a[212:215], v[20:23]
    ds_read_b128 a[244:247], v7 offset:13312
pad0_81:
    s_cbranch_execz kf_kernel_done
    v_mfma_f32_16x16x32_bf16 v[24:27], a[40:43], a[216:219], v[24:27]
    ds_read_b128 a[248:251], v7 offset:14336
    v_mfma_f32_16x16x32_bf16 v[28:31], a[40:43], a[220:223], v[28:31]
    buffer_load_dwordx4 a[40:43], v1, s[12:15], s36 offen offset:2048
    v_mfma_f32_16x16x32_bf16 v[32:35], a[44:47], a[208:211], v[32:35]
    ds_read_b128 a[252:255], v7 offset:15360
    v_and_b32 v97, s39, v194
    v_mfma_f32_16x16x32_bf16 v[36:39], a[44:47], a[212:215], v[36:39]
    v_mfma_f32_16x16x32_bf16 v[40:43], a[44:47], a[216:219], v[40:43]
    v_mul_u32_u24 v98, s38, v195
    v_mfma_f32_16x16x32_bf16 v[44:47], a[44:47], a[220:223], v[44:47]
    buffer_load_dwordx4 a[44:47], v1, s[12:15], s36 offen offset:3072
    v_mfma_f32_16x16x32_bf16 v[48:51], a[48:51], a[208:211], v[48:51]
    v_and_b32 v99, s39, v195
    v_mul_u32_u24 v100, s38, v198
    v_mfma_f32_16x16x32_bf16 v[52:55], a[48:51], a[212:215], v[52:55]
    v_and_b32 v101, s39, v198
    v_mfma_f32_16x16x32_bf16 v[56:59], a[48:51], a[216:219], v[56:59]
    v_mfma_f32_16x16x32_bf16 v[60:63], a[48:51], a[220:223], v[60:63]
    s_add_u32 s36, s36, 4096
    buffer_load_dwordx4 a[48:51], v1, s[12:15], s36 offen offset:0
    v_mfma_f32_16x16x32_bf16 v[64:67], a[52:55], a[208:211], v[64:67]
    v_mul_u32_u24 v102, s38, v199
    v_and_b32 v103, s39, v199
    v_mfma_f32_16x16x32_bf16 v[68:71], a[52:55], a[212:215], v[68:71]
    v_mul_u32_u24 v104, s38, v202
    v_mfma_f32_16x16x32_bf16 v[72:75], a[52:55], a[216:219], v[72:75]
    v_and_b32 v105, s39, v202
    v_mfma_f32_16x16x32_bf16 v[76:79], a[52:55], a[220:223], v[76:79]
    buffer_load_dwordx4 a[52:55], v1, s[12:15], s36 offen offset:1024
    s_waitcnt vmcnt(44) lgkmcnt(4)
    v_mfma_f32_16x16x32_bf16 v[16:19], a[56:59], a[224:227], v[16:19]
    ds_read_b128 a[192:195], v6 offset:20480
    v_mfma_f32_16x16x32_bf16 v[20:23], a[56:59], a[228:231], v[20:23]
    ds_read_b128 a[196:199], v6 offset:21504
    v_mfma_f32_16x16x32_bf16 v[24:27], a[56:59], a[232:235], v[24:27]
    ds_read_b128 a[200:203], v6 offset:22528
pad0_82:
    s_cbranch_execz kf_kernel_done
    v_mfma_f32_16x16x32_bf16 v[28:31], a[56:59], a[236:239], v[28:31]
    buffer_load_dwordx4 a[56:59], v1, s[12:15], s36 offen offset:2048
    v_mfma_f32_16x16x32_bf16 v[32:35], a[60:63], a[224:227], v[32:35]
    ds_read_b128 a[204:207], v6 offset:23552
    v_mul_u32_u24 v106, s38, v203
    v_mfma_f32_16x16x32_bf16 v[36:39], a[60:63], a[228:231], v[36:39]
    v_mfma_f32_16x16x32_bf16 v[40:43], a[60:63], a[232:235], v[40:43]
    v_and_b32 v107, s39, v203
    v_mfma_f32_16x16x32_bf16 v[44:47], a[60:63], a[236:239], v[44:47]
    buffer_load_dwordx4 a[60:63], v1, s[12:15], s36 offen offset:3072
    v_mfma_f32_16x16x32_bf16 v[48:51], a[64:67], a[224:227], v[48:51]
    v_mul_u32_u24 v108, s38, v206
    v_and_b32 v109, s39, v206
    v_mfma_f32_16x16x32_bf16 v[52:55], a[64:67], a[228:231], v[52:55]
    v_mul_u32_u24 v110, s38, v207
    v_mfma_f32_16x16x32_bf16 v[56:59], a[64:67], a[232:235], v[56:59]
    v_mfma_f32_16x16x32_bf16 v[60:63], a[64:67], a[236:239], v[60:63]
    s_add_u32 s36, s36, 4096
    buffer_load_dwordx4 a[64:67], v1, s[12:15], s36 offen offset:0
    v_mfma_f32_16x16x32_bf16 v[64:67], a[68:71], a[224:227], v[64:67]
    v_and_b32 v111, s39, v207
    v_mul_u32_u24 v144, s38, v224
    v_mfma_f32_16x16x32_bf16 v[68:71], a[68:71], a[228:231], v[68:71]
    v_and_b32 v145, s39, v224
    v_mfma_f32_16x16x32_bf16 v[72:75], a[68:71], a[232:235], v[72:75]
    v_mul_u32_u24 v146, s38, v225
    v_mfma_f32_16x16x32_bf16 v[76:79], a[68:71], a[236:239], v[76:79]
    buffer_load_dwordx4 a[68:71], v1, s[12:15], s36 offen offset:1024
    s_waitcnt vmcnt(44) lgkmcnt(4)
    v_mfma_f32_16x16x32_bf16 v[16:19], a[72:75], a[240:243], v[16:19]
    ds_read_b128 a[208:211], v6 offset:36864
    v_mfma_f32_16x16x32_bf16 v[20:23], a[72:75], a[244:247], v[20:23]
    ds_read_b128 a[212:215], v6 offset:37888
    v_mfma_f32_16x16x32_bf16 v[24:27], a[72:75], a[248:251], v[24:27]
    ds_read_b128 a[216:219], v6 offset:38912
    v_mfma_f32_16x16x32_bf16 v[28:31], a[72:75], a[252:255], v[28:31]
pad0_83:
    s_cbranch_execz kf_kernel_done
    buffer_load_dwordx4 a[72:75], v1, s[12:15], s36 offen offset:2048
    v_mfma_f32_16x16x32_bf16 v[32:35], a[76:79], a[240:243], v[32:35]
    ds_read_b128 a[220:223], v6 offset:39936
    v_and_b32 v147, s39, v225
    v_mfma_f32_16x16x32_bf16 v[36:39], a[76:79], a[244:247], v[36:39]
    v_mfma_f32_16x16x32_bf16 v[40:43], a[76:79], a[248:251], v[40:43]
    v_mul_u32_u24 v148, s38, v226
    v_mfma_f32_16x16x32_bf16 v[44:47], a[76:79], a[252:255], v[44:47]
    buffer_load_dwordx4 a[76:79], v1, s[12:15], s36 offen offset:3072
    v_mfma_f32_16x16x32_bf16 v[48:51], a[80:83], a[240:243], v[48:51]
    v_and_b32 v149, s39, v226
    v_mul_u32_u24 v150, s38, v227
    v_mfma_f32_16x16x32_bf16 v[52:55], a[80:83], a[244:247], v[52:55]
    v_and_b32 v151, s39, v227
    v_mfma_f32_16x16x32_bf16 v[56:59], a[80:83], a[248:251], v[56:59]
    v_mfma_f32_16x16x32_bf16 v[60:63], a[80:83], a[252:255], v[60:63]
    s_add_u32 s36, s36, 4096
    buffer_load_dwordx4 a[80:83], v1, s[12:15], s36 offen offset:0
    v_mfma_f32_16x16x32_bf16 v[64:67], a[84:87], a[240:243], v[64:67]
    v_mul_u32_u24 v152, s38, v228
    v_and_b32 v153, s39, v228
    v_mfma_f32_16x16x32_bf16 v[68:71], a[84:87], a[244:247], v[68:71]
    v_mul_u32_u24 v154, s38, v229
    v_mfma_f32_16x16x32_bf16 v[72:75], a[84:87], a[248:251], v[72:75]
    v_and_b32 v155, s39, v229
    v_mfma_f32_16x16x32_bf16 v[76:79], a[84:87], a[252:255], v[76:79]
    buffer_load_dwordx4 a[84:87], v1, s[12:15], s36 offen offset:1024
    s_waitcnt vmcnt(44) lgkmcnt(4)
    v_mfma_f32_16x16x32_bf16 v[16:19], a[88:91], a[192:195], v[16:19]
    ds_read_b128 a[224:227], v6 offset:53248
    v_mfma_f32_16x16x32_bf16 v[20:23], a[88:91], a[196:199], v[20:23]
    ds_read_b128 a[228:231], v6 offset:54272
    v_mfma_f32_16x16x32_bf16 v[24:27], a[88:91], a[200:203], v[24:27]
    ds_read_b128 a[232:235], v6 offset:55296
    v_mfma_f32_16x16x32_bf16 v[28:31], a[88:91], a[204:207], v[28:31]
    buffer_load_dwordx4 a[88:91], v1, s[12:15], s36 offen offset:2048
    v_mfma_f32_16x16x32_bf16 v[32:35], a[92:95], a[192:195], v[32:35]
pad0_84:
    s_cbranch_execz kf_kernel_done
    ds_read_b128 a[236:239], v6 offset:56320
    v_mul_u32_u24 v156, s38, v230
    v_mfma_f32_16x16x32_bf16 v[36:39], a[92:95], a[196:199], v[36:39]
    v_mfma_f32_16x16x32_bf16 v[40:43], a[92:95], a[200:203], v[40:43]
    v_and_b32 v157, s39, v230
    v_mfma_f32_16x16x32_bf16 v[44:47], a[92:95], a[204:207], v[44:47]
    buffer_load_dwordx4 a[92:95], v1, s[12:15], s36 offen offset:3072
    v_mfma_f32_16x16x32_bf16 v[48:51], a[96:99], a[192:195], v[48:51]
    v_mul_u32_u24 v158, s38, v231
    v_and_b32 v159, s39, v231
    v_mfma_f32_16x16x32_bf16 v[52:55], a[96:99], a[196:199], v[52:55]
    v_mul_u32_u24 v112, s38, v208
    v_mfma_f32_16x16x32_bf16 v[56:59], a[96:99], a[200:203], v[56:59]
    v_mfma_f32_16x16x32_bf16 v[60:63], a[96:99], a[204:207], v[60:63]
    s_add_u32 s36, s36, 4096
    buffer_load_dwordx4 a[96:99], v1, s[12:15], s36 offen offset:0
    v_mfma_f32_16x16x32_bf16 v[64:67], a[100:103], a[192:195], v[64:67]
    v_and_b32 v113, s39, v208
    v_mul_u32_u24 v114, s38, v209
    v_mfma_f32_16x16x32_bf16 v[68:71], a[100:103], a[196:199], v[68:71]
    v_and_b32 v115, s39, v209
    v_mfma_f32_16x16x32_bf16 v[72:75], a[100:103], a[200:203], v[72:75]
    v_mul_u32_u24 v116, s38, v212
    v_mfma_f32_16x16x32_bf16 v[76:79], a[100:103], a[204:207], v[76:79]
    buffer_load_dwordx4 a[100:103], v1, s[12:15], s36 offen offset:1024
    s_waitcnt vmcnt(44) lgkmcnt(4)
    v_mfma_f32_16x16x32_bf16 v[16:19], a[104:107], a[208:211], v[16:19]
    ds_read_b128 a[240:243], v7 offset:4096
    v_mfma_f32_16x16x32_bf16 v[20:23], a[104:107], a[212:215], v[20:23]
    ds_read_b128 a[244:247], v7 offset:5120
    v_mfma_f32_16x16x32_bf16 v[24:27], a[104:107], a[216:219], v[24:27]
    ds_read_b128 a[248:251], v7 offset:6144
    v_mfma_f32_16x16x32_bf16 v[28:31], a[104:107], a[220:223], v[28:31]
    buffer_load_dwordx4 a[104:107], v1, s[12:15], s36 offen offset:2048
    v_mfma_f32_16x16x32_bf16 v[32:35], a[108:111], a[208:211], v[32:35]
    ds_read_b128 a[252:255], v7 offset:7168
pad0_85:
    s_cbranch_execz kf_kernel_done
    v_and_b32 v117, s39, v212
    v_mfma_f32_16x16x32_bf16 v[36:39], a[108:111], a[212:215], v[36:39]
    v_mfma_f32_16x16x32_bf16 v[40:43], a[108:111], a[216:219], v[40:43]
    v_mul_u32_u24 v118, s38, v213
    v_mfma_f32_16x16x32_bf16 v[44:47], a[108:111], a[220:223], v[44:47]
    buffer_load_dwordx4 a[108:111], v1, s[12:15], s36 offen offset:3072
    v_mfma_f32_16x16x32_bf16 v[48:51], a[112:115], a[208:211], v[48:51]
    v_and_b32 v119, s39, v213
    v_mul_u32_u24 v120, s38, v216
    v_mfma_f32_16x16x32_bf16 v[52:55], a[112:115], a[212:215], v[52:55]
    v_and_b32 v121, s39, v216
    v_mfma_f32_16x16x32_bf16 v[56:59], a[112:115], a[216:219], v[56:59]
    v_mfma_f32_16x16x32_bf16 v[60:63], a[112:115], a[220:223], v[60:63]
    s_add_u32 s36, s36, 4096
    buffer_load_dwordx4 a[112:115], v1, s[12:15], s36 offen offset:0
    v_mfma_f32_16x16x32_bf16 v[64:67], a[116:119], a[208:211], v[64:67]
    v_mul_u32_u24 v122, s38, v217
    v_and_b32 v123, s39, v217
    v_mfma_f32_16x16x32_bf16 v[68:71], a[116:119], a[212:215], v[68:71]
    v_mul_u32_u24 v124, s38, v220
    v_mfma_f32_16x16x32_bf16 v[72:75], a[116:119], a[216:219], v[72:75]
    v_and_b32 v125, s39, v220
    v_mfma_f32_16x16x32_bf16 v[76:79], a[116:119], a[220:223], v[76:79]
    buffer_load_dwordx4 a[116:119], v1, s[12:15], s36 offen offset:1024
    s_waitcnt vmcnt(44) lgkmcnt(4)
    v_mfma_f32_16x16x32_bf16 v[16:19], a[120:123], a[224:227], v[16:19]
    ds_read_b128 a[192:195], v6 offset:8192
    v_mfma_f32_16x16x32_bf16 v[20:23], a[120:123], a[228:231], v[20:23]
    ds_read_b128 a[196:199], v6 offset:9216
    v_mfma_f32_16x16x32_bf16 v[24:27], a[120:123], a[232:235], v[24:27]
    ds_read_b128 a[200:203], v6 offset:10240
    v_mfma_f32_16x16x32_bf16 v[28:31], a[120:123], a[236:239], v[28:31]
    buffer_load_dwordx4 a[120:123], v1, s[12:15], s36 offen offset:2048
    v_mfma_f32_16x16x32_bf16 v[32:35], a[124:127], a[224:227], v[32:35]
    ds_read_b128 a[204:207], v6 offset:11264
    v_mul_u32_u24 v126, s38, v221
    v_mfma_f32_16x16x32_bf16 v[36:39], a[124:127], a[228:231], v[36:39]
pad0_86:
    s_cbranch_execz kf_kernel_done
    v_mfma_f32_16x16x32_bf16 v[40:43], a[124:127], a[232:235], v[40:43]
    v_and_b32 v127, s39, v221
    v_mfma_f32_16x16x32_bf16 v[44:47], a[124:127], a[236:239], v[44:47]
    buffer_load_dwordx4 a[124:127], v1, s[12:15], s36 offen offset:3072
    v_mfma_f32_16x16x32_bf16 v[48:51], a[128:131], a[224:227], v[48:51]
    v_mul_u32_u24 v128, s38, v210
    v_and_b32 v129, s39, v210
    v_mfma_f32_16x16x32_bf16 v[52:55], a[128:131], a[228:231], v[52:55]
    v_mul_u32_u24 v130, s38, v211
    v_mfma_f32_16x16x32_bf16 v[56:59], a[128:131], a[232:235], v[56:59]
    v_mfma_f32_16x16x32_bf16 v[60:63], a[128:131], a[236:239], v[60:63]
    s_add_u32 s36, s36, 4096
    buffer_load_dwordx4 a[128:131], v1, s[12:15], s36 offen offset:0
    v_mfma_f32_16x16x32_bf16 v[64:67], a[132:135], a[224:227], v[64:67]
    v_and_b32 v131, s39, v211
    v_mul_u32_u24 v132, s38, v214
    v_mfma_f32_16x16x32_bf16 v[68:71], a[132:135], a[228:231], v[68:71]
    v_and_b32 v133, s39, v214
    v_mfma_f32_16x16x32_bf16 v[72:75], a[132:135], a[232:235], v[72:75]
    v_mul_u32_u24 v134, s38, v215
    v_mfma_f32_16x16x32_bf16 v[76:79], a[132:135], a[236:239], v[76:79]
    buffer_load_dwordx4 a[132:135], v1, s[12:15], s36 offen offset:1024
    s_waitcnt vmcnt(44) lgkmcnt(4)
    v_mfma_f32_16x16x32_bf16 v[16:19], a[136:139], a[240:243], v[16:19]
    ds_read_b128 a[208:211], v6 offset:12288
    v_mfma_f32_16x16x32_bf16 v[20:23], a[136:139], a[244:247], v[20:23]
    ds_read_b128 a[212:215], v6 offset:13312
    v_mfma_f32_16x16x32_bf16 v[24:27], a[136:139], a[248:251], v[24:27]
    ds_read_b128 a[216:219], v6 offset:14336
    v_mfma_f32_16x16x32_bf16 v[28:31], a[136:139], a[252:255], v[28:31]
    buffer_load_dwordx4 a[136:139], v1, s[12:15], s36 offen offset:2048
    v_mfma_f32_16x16x32_bf16 v[32:35], a[140:143], a[240:243], v[32:35]
    ds_read_b128 a[220:223], v6 offset:15360
    v_and_b32 v135, s39, v215
    v_mfma_f32_16x16x32_bf16 v[36:39], a[140:143], a[244:247], v[36:39]
    v_mfma_f32_16x16x32_bf16 v[40:43], a[140:143], a[248:251], v[40:43]
    v_mul_u32_u24 v136, s38, v218
pad0_87:
    s_cbranch_execz kf_kernel_done
    v_mfma_f32_16x16x32_bf16 v[44:47], a[140:143], a[252:255], v[44:47]
    buffer_load_dwordx4 a[140:143], v1, s[12:15], s36 offen offset:3072
    v_mfma_f32_16x16x32_bf16 v[48:51], a[160:163], a[240:243], v[48:51]
    v_and_b32 v137, s39, v218
    v_mul_u32_u24 v138, s38, v219
    v_mfma_f32_16x16x32_bf16 v[52:55], a[160:163], a[244:247], v[52:55]
    v_and_b32 v139, s39, v219
    v_mfma_f32_16x16x32_bf16 v[56:59], a[160:163], a[248:251], v[56:59]
    v_mfma_f32_16x16x32_bf16 v[60:63], a[160:163], a[252:255], v[60:63]
    s_add_u32 s36, s36, 4096
    buffer_load_dwordx4 a[160:163], v1, s[12:15], s36 offen offset:0
    v_mfma_f32_16x16x32_bf16 v[64:67], a[164:167], a[240:243], v[64:67]
    v_mul_u32_u24 v140, s38, v222
    v_and_b32 v141, s39, v222
    v_mfma_f32_16x16x32_bf16 v[68:71], a[164:167], a[244:247], v[68:71]
    v_mul_u32_u24 v142, s38, v223
    v_mfma_f32_16x16x32_bf16 v[72:75], a[164:167], a[248:251], v[72:75]
    v_and_b32 v143, s39, v223
    v_mfma_f32_16x16x32_bf16 v[76:79], a[164:167], a[252:255], v[76:79]
    buffer_load_dwordx4 a[164:167], v1, s[12:15], s36 offen offset:1024
    s_waitcnt vmcnt(45) lgkmcnt(4)
    v_mfma_f32_16x16x32_bf16 v[80:83], a[168:171], a[192:195], v[80:83]
    ds_read_b128 a[224:227], v6 offset:16384
    v_mfma_f32_16x16x32_bf16 v[84:87], a[168:171], a[196:199], v[84:87]
    v_mfma_f32_16x16x32_bf16 v[88:91], a[168:171], a[200:203], v[88:91]
    v_mfma_f32_16x16x32_bf16 v[92:95], a[168:171], a[204:207], v[92:95]
    buffer_load_dwordx4 a[168:171], v1, s[12:15], s36 offen offset:2048
    v_mfma_f32_16x16x32_bf16 v[96:99], a[172:175], a[192:195], v[96:99]
    ds_read_b128 a[228:231], v6 offset:17408
    v_mfma_f32_16x16x32_bf16 v[100:103], a[172:175], a[196:199], v[100:103]
    v_mfma_f32_16x16x32_bf16 v[104:107], a[172:175], a[200:203], v[104:107]
    ds_read_b128 a[232:235], v6 offset:18432
    v_mfma_f32_16x16x32_bf16 v[108:111], a[172:175], a[204:207], v[108:111]
    buffer_load_dwordx4 a[172:175], v1, s[12:15], s36 offen offset:3072
    v_mfma_f32_16x16x32_bf16 v[144:147], a[176:179], a[192:195], v[144:147]
    v_mfma_f32_16x16x32_bf16 v[148:151], a[176:179], a[196:199], v[148:151]
pad0_88:
    s_cbranch_execz kf_kernel_done
    ds_read_b128 a[236:239], v6 offset:19456
    v_mfma_f32_16x16x32_bf16 v[152:155], a[176:179], a[200:203], v[152:155]
    v_mfma_f32_16x16x32_bf16 v[156:159], a[176:179], a[204:207], v[156:159]
    s_add_u32 s36, s36, 4096
    buffer_load_dwordx4 a[176:179], v1, s[12:15], s36 offen offset:0
    s_waitcnt vmcnt(45) lgkmcnt(4)
    v_mfma_f32_16x16x32_bf16 v[80:83], a[180:183], a[208:211], v[80:83]
    ds_read_b128 a[240:243], v6 offset:20480
    v_mfma_f32_16x16x32_bf16 v[84:87], a[180:183], a[212:215], v[84:87]
    v_mfma_f32_16x16x32_bf16 v[88:91], a[180:183], a[216:219], v[88:91]
    ds_read_b128 a[244:247], v6 offset:21504
    v_mfma_f32_16x16x32_bf16 v[92:95], a[180:183], a[220:223], v[92:95]
    buffer_load_dwordx4 a[180:183], v1, s[12:15], s36 offen offset:1024
    v_mfma_f32_16x16x32_bf16 v[96:99], a[184:187], a[208:211], v[96:99]
    ds_read_b128 a[248:251], v6 offset:22528
    v_mfma_f32_16x16x32_bf16 v[100:103], a[184:187], a[212:215], v[100:103]
    v_mfma_f32_16x16x32_bf16 v[104:107], a[184:187], a[216:219], v[104:107]
    ds_read_b128 a[252:255], v6 offset:23552
    v_mfma_f32_16x16x32_bf16 v[108:111], a[184:187], a[220:223], v[108:111]
    buffer_load_dwordx4 a[184:187], v1, s[12:15], s36 offen offset:2048
    v_mfma_f32_16x16x32_bf16 v[144:147], a[188:191], a[208:211], v[144:147]
    v_cvt_pk_bf16_f32 v244, v16, v17
    v_mfma_f32_16x16x32_bf16 v[148:151], a[188:191], a[212:215], v[148:151]
    v_mfma_f32_16x16x32_bf16 v[152:155], a[188:191], a[216:219], v[152:155]
    v_cvt_pk_bf16_f32 v245, v18, v19
    v_mfma_f32_16x16x32_bf16 v[156:159], a[188:191], a[220:223], v[156:159]
    buffer_load_dwordx4 a[188:191], v1, s[12:15], s36 offen offset:3072
    s_waitcnt vmcnt(45) lgkmcnt(4)
    v_mfma_f32_16x16x32_bf16 v[80:83], a[144:147], a[224:227], v[80:83]
    ds_read_b128 a[192:195], v6 offset:24576
    v_mfma_f32_16x16x32_bf16 v[84:87], a[144:147], a[228:231], v[84:87]
    ds_read_b128 a[196:199], v6 offset:25600
pad0_89:
    s_cbranch_execz kf_kernel_done
    v_mfma_f32_16x16x32_bf16 v[88:91], a[144:147], a[232:235], v[88:91]
    v_mfma_f32_16x16x32_bf16 v[92:95], a[144:147], a[236:239], v[92:95]
    s_add_u32 s36, s36, 4096
    buffer_load_dwordx4 a[144:147], v1, s[12:15], s36 offen offset:0
    v_mfma_f32_16x16x32_bf16 v[96:99], a[148:151], a[224:227], v[96:99]
    ds_read_b128 a[200:203], v6 offset:26624
    v_mfma_f32_16x16x32_bf16 v[100:103], a[148:151], a[228:231], v[100:103]
    ds_read_b128 a[204:207], v6 offset:27648
    v_mfma_f32_16x16x32_bf16 v[104:107], a[148:151], a[232:235], v[104:107]
    v_cvt_pk_bf16_f32 v246, v32, v33
    v_mfma_f32_16x16x32_bf16 v[108:111], a[148:151], a[236:239], v[108:111]
    buffer_load_dwordx4 a[148:151], v1, s[12:15], s36 offen offset:1024
    v_mfma_f32_16x16x32_bf16 v[144:147], a[152:155], a[224:227], v[144:147]
    v_cvt_pk_bf16_f32 v247, v34, v35
    v_mfma_f32_16x16x32_bf16 v[148:151], a[152:155], a[228:231], v[148:151]
    v_mfma_f32_16x16x32_bf16 v[152:155], a[152:155], a[232:235], v[152:155]
    buffer_store_dwordx4 v[244:247], v2, s[28:31], s40 offen offset:0 sc1
    v_mfma_f32_16x16x32_bf16 v[156:159], a[152:155], a[236:239], v[156:159]
    buffer_load_dwordx4 a[152:155], v1, s[12:15], s36 offen offset:2048
    s_waitcnt vmcnt(46) lgkmcnt(4)
    v_mfma_f32_16x16x32_bf16 v[80:83], a[156:159], a[240:243], v[80:83]
    ds_read_b128 a[208:211], v6 offset:28672
    v_mfma_f32_16x16x32_bf16 v[84:87], a[156:159], a[244:247], v[84:87]
    v_mfma_f32_16x16x32_bf16 v[88:91], a[156:159], a[248:251], v[88:91]
    ds_read_b128 a[212:215], v6 offset:29696
    v_mfma_f32_16x16x32_bf16 v[92:95], a[156:159], a[252:255], v[92:95]
    buffer_load_dwordx4 a[156:159], v1, s[12:15], s36 offen offset:3072
    v_mfma_f32_16x16x32_bf16 v[96:99], a[0:3], a[240:243], v[96:99]
    ds_read_b128 a[216:219], v6 offset:30720
    v_mfma_f32_16x16x32_bf16 v[100:103], a[0:3], a[244:247], v[100:103]
    v_mfma_f32_16x16x32_bf16 v[104:107], a[0:3], a[248:251], v[104:107]
    ds_read_b128 a[220:223], v6 offset:31744
pad0_90:
    s_cbranch_execz kf_kernel_done
    v_mfma_f32_16x16x32_bf16 v[108:111], a[0:3], a[252:255], v[108:111]
    s_add_u32 s36, s36, 4096
    buffer_load_dwordx4 a[0:3], v1, s[12:15], s36 offen offset:0
    v_mfma_f32_16x16x32_bf16 v[144:147], a[4:7], a[240:243], v[144:147]
    v_cvt_pk_bf16_f32 v248, v20, v21
    v_mfma_f32_16x16x32_bf16 v[148:151], a[4:7], a[244:247], v[148:151]
    v_mfma_f32_16x16x32_bf16 v[152:155], a[4:7], a[248:251], v[152:155]
    v_cvt_pk_bf16_f32 v249, v22, v23
    v_mfma_f32_16x16x32_bf16 v[156:159], a[4:7], a[252:255], v[156:159]
    buffer_load_dwordx4 a[4:7], v1, s[12:15], s36 offen offset:1024
    s_waitcnt vmcnt(46) lgkmcnt(4)
    v_mfma_f32_16x16x32_bf16 v[80:83], a[8:11], a[192:195], v[80:83]
    ds_read_b128 a[224:227], v6 offset:32768
    v_mfma_f32_16x16x32_bf16 v[84:87], a[8:11], a[196:199], v[84:87]
    ds_read_b128 a[228:231], v6 offset:33792
    v_mfma_f32_16x16x32_bf16 v[88:91], a[8:11], a[200:203], v[88:91]
    v_mfma_f32_16x16x32_bf16 v[92:95], a[8:11], a[204:207], v[92:95]
    buffer_load_dwordx4 a[8:11], v1, s[12:15], s36 offen offset:2048
    v_mfma_f32_16x16x32_bf16 v[96:99], a[12:15], a[192:195], v[96:99]
    ds_read_b128 a[232:235], v6 offset:34816
    v_mfma_f32_16x16x32_bf16 v[100:103], a[12:15], a[196:199], v[100:103]
    ds_read_b128 a[236:239], v6 offset:35840
    v_mfma_f32_16x16x32_bf16 v[104:107], a[12:15], a[200:203], v[104:107]
    v_cvt_pk_bf16_f32 v250, v36, v37
    v_mfma_f32_16x16x32_bf16 v[108:111], a[12:15], a[204:207], v[108:111]
    buffer_load_dwordx4 a[12:15], v1, s[12:15], s36 offen offset:3072
    v_mfma_f32_16x16x32_bf16 v[144:147], a[16:19], a[192:195], v[144:147]
    v_cvt_pk_bf16_f32 v251, v38, v39
    v_mfma_f32_16x16x32_bf16 v[148:151], a[16:19], a[196:199], v[148:151]
    v_mfma_f32_16x16x32_bf16 v[152:155], a[16:19], a[200:203], v[152:155]
    buffer_store_dwordx4 v[248:251], v2, s[28:31], s40 offen offset:1024 sc1
    v_mfma_f32_16x16x32_bf16 v[156:159], a[16:19], a[204:207], v[156:159]
pad0_91:
    s_cbranch_execz kf_kernel_done
    s_add_u32 s36, s36, 4096
    buffer_load_dwordx4 a[16:19], v1, s[12:15], s36 offen offset:0
    s_waitcnt vmcnt(47) lgkmcnt(4)
    v_mfma_f32_16x16x32_bf16 v[80:83], a[20:23], a[208:211], v[80:83]
    ds_read_b128 a[240:243], v6 offset:36864
    v_mfma_f32_16x16x32_bf16 v[84:87], a[20:23], a[212:215], v[84:87]
    v_mfma_f32_16x16x32_bf16 v[88:91], a[20:23], a[216:219], v[88:91]
    ds_read_b128 a[244:247], v6 offset:37888
    v_mfma_f32_16x16x32_bf16 v[92:95], a[20:23], a[220:223], v[92:95]
    buffer_load_dwordx4 a[20:23], v1, s[12:15], s36 offen offset:1024
    v_mfma_f32_16x16x32_bf16 v[96:99], a[24:27], a[208:211], v[96:99]
    ds_read_b128 a[248:251], v6 offset:38912
    v_mfma_f32_16x16x32_bf16 v[100:103], a[24:27], a[212:215], v[100:103]
    v_mfma_f32_16x16x32_bf16 v[104:107], a[24:27], a[216:219], v[104:107]
    ds_read_b128 a[252:255], v6 offset:39936
    v_mfma_f32_16x16x32_bf16 v[108:111], a[24:27], a[220:223], v[108:111]
    buffer_load_dwordx4 a[24:27], v1, s[12:15], s36 offen offset:2048
    v_mfma_f32_16x16x32_bf16 v[144:147], a[28:31], a[208:211], v[144:147]
    v_cvt_pk_bf16_f32 v252, v24, v25
    v_mfma_f32_16x16x32_bf16 v[148:151], a[28:31], a[212:215], v[148:151]
    v_mfma_f32_16x16x32_bf16 v[152:155], a[28:31], a[216:219], v[152:155]
    v_cvt_pk_bf16_f32 v253, v26, v27
    v_mfma_f32_16x16x32_bf16 v[156:159], a[28:31], a[220:223], v[156:159]
    buffer_load_dwordx4 a[28:31], v1, s[12:15], s36 offen offset:3072
    s_waitcnt vmcnt(47) lgkmcnt(4)
    v_mfma_f32_16x16x32_bf16 v[80:83], a[32:35], a[224:227], v[80:83]
    ds_read_b128 a[192:195], v6 offset:40960
    v_mfma_f32_16x16x32_bf16 v[84:87], a[32:35], a[228:231], v[84:87]
    ds_read_b128 a[196:199], v6 offset:41984
    v_mfma_f32_16x16x32_bf16 v[88:91], a[32:35], a[232:235], v[88:91]
    v_mfma_f32_16x16x32_bf16 v[92:95], a[32:35], a[236:239], v[92:95]
    s_add_u32 s36, s36, 4096
    buffer_load_dwordx4 a[32:35], v1, s[12:15], s36 offen offset:0
pad0_92:
    s_cbranch_execz kf_kernel_done
    v_mfma_f32_16x16x32_bf16 v[96:99], a[36:39], a[224:227], v[96:99]
    ds_read_b128 a[200:203], v6 offset:43008
    v_mfma_f32_16x16x32_bf16 v[100:103], a[36:39], a[228:231], v[100:103]
    ds_read_b128 a[204:207], v6 offset:44032
    v_mfma_f32_16x16x32_bf16 v[104:107], a[36:39], a[232:235], v[104:107]
    v_cvt_pk_bf16_f32 v254, v40, v41
    v_mfma_f32_16x16x32_bf16 v[108:111], a[36:39], a[236:239], v[108:111]
    buffer_load_dwordx4 a[36:39], v1, s[12:15], s36 offen offset:1024
    v_mfma_f32_16x16x32_bf16 v[144:147], a[40:43], a[224:227], v[144:147]
    v_cvt_pk_bf16_f32 v255, v42, v43
    v_mfma_f32_16x16x32_bf16 v[148:151], a[40:43], a[228:231], v[148:151]
    v_mfma_f32_16x16x32_bf16 v[152:155], a[40:43], a[232:235], v[152:155]
    buffer_store_dwordx4 v[252:255], v2, s[28:31], s40 offen offset:2048 sc1
    v_mfma_f32_16x16x32_bf16 v[156:159], a[40:43], a[236:239], v[156:159]
    buffer_load_dwordx4 a[40:43], v1, s[12:15], s36 offen offset:2048
    s_waitcnt vmcnt(48) lgkmcnt(4)
    v_mfma_f32_16x16x32_bf16 v[80:83], a[44:47], a[240:243], v[80:83]
    ds_read_b128 a[208:211], v6 offset:45056
    v_mfma_f32_16x16x32_bf16 v[84:87], a[44:47], a[244:247], v[84:87]
    v_mfma_f32_16x16x32_bf16 v[88:91], a[44:47], a[248:251], v[88:91]
    ds_read_b128 a[212:215], v6 offset:46080
    v_mfma_f32_16x16x32_bf16 v[92:95], a[44:47], a[252:255], v[92:95]
    buffer_load_dwordx4 a[44:47], v1, s[12:15], s36 offen offset:3072
    v_mfma_f32_16x16x32_bf16 v[96:99], a[48:51], a[240:243], v[96:99]
    ds_read_b128 a[216:219], v6 offset:47104
    v_mfma_f32_16x16x32_bf16 v[100:103], a[48:51], a[244:247], v[100:103]
    v_mfma_f32_16x16x32_bf16 v[104:107], a[48:51], a[248:251], v[104:107]
    ds_read_b128 a[220:223], v6 offset:48128
    v_mfma_f32_16x16x32_bf16 v[108:111], a[48:51], a[252:255], v[108:111]
    s_add_u32 s36, s36, 4096
    buffer_load_dwordx4 a[48:51], v1, s[12:15], s36 offen offset:0
    v_mfma_f32_16x16x32_bf16 v[144:147], a[52:55], a[240:243], v[144:147]
pad0_93:
    s_cbranch_execz kf_kernel_done
    v_cvt_pk_bf16_f32 v232, v28, v29
    v_mfma_f32_16x16x32_bf16 v[148:151], a[52:55], a[244:247], v[148:151]
    v_mfma_f32_16x16x32_bf16 v[152:155], a[52:55], a[248:251], v[152:155]
    v_cvt_pk_bf16_f32 v233, v30, v31
    v_mfma_f32_16x16x32_bf16 v[156:159], a[52:55], a[252:255], v[156:159]
    buffer_load_dwordx4 a[52:55], v1, s[12:15], s36 offen offset:1024
    s_waitcnt vmcnt(48) lgkmcnt(4)
    v_mfma_f32_16x16x32_bf16 v[80:83], a[56:59], a[192:195], v[80:83]
    ds_read_b128 a[224:227], v6 offset:49152
    v_mfma_f32_16x16x32_bf16 v[84:87], a[56:59], a[196:199], v[84:87]
    ds_read_b128 a[228:231], v6 offset:50176
    v_mfma_f32_16x16x32_bf16 v[88:91], a[56:59], a[200:203], v[88:91]
    v_mfma_f32_16x16x32_bf16 v[92:95], a[56:59], a[204:207], v[92:95]
    buffer_load_dwordx4 a[56:59], v1, s[12:15], s36 offen offset:2048
    v_mfma_f32_16x16x32_bf16 v[96:99], a[60:63], a[192:195], v[96:99]
    ds_read_b128 a[232:235], v6 offset:51200
    v_mfma_f32_16x16x32_bf16 v[100:103], a[60:63], a[196:199], v[100:103]
    ds_read_b128 a[236:239], v6 offset:52224
    v_mfma_f32_16x16x32_bf16 v[104:107], a[60:63], a[200:203], v[104:107]
    v_cvt_pk_bf16_f32 v234, v44, v45
    v_mfma_f32_16x16x32_bf16 v[108:111], a[60:63], a[204:207], v[108:111]
    buffer_load_dwordx4 a[60:63], v1, s[12:15], s36 offen offset:3072
    v_mfma_f32_16x16x32_bf16 v[144:147], a[64:67], a[192:195], v[144:147]
    v_cvt_pk_bf16_f32 v235, v46, v47
    v_mfma_f32_16x16x32_bf16 v[148:151], a[64:67], a[196:199], v[148:151]
    v_mfma_f32_16x16x32_bf16 v[152:155], a[64:67], a[200:203], v[152:155]
    buffer_store_dwordx4 v[232:235], v2, s[28:31], s40 offen offset:3072 sc1
    v_mfma_f32_16x16x32_bf16 v[156:159], a[64:67], a[204:207], v[156:159]
    s_add_u32 s36, s36, 4096
    buffer_load_dwordx4 a[64:67], v1, s[12:15], s36 offen offset:0
    s_waitcnt vmcnt(49) lgkmcnt(4)
    v_mfma_f32_16x16x32_bf16 v[80:83], a[68:71], a[208:211], v[80:83]
pad0_94:
    s_cbranch_execz kf_kernel_done
    ds_read_b128 a[240:243], v6 offset:53248
    v_mfma_f32_16x16x32_bf16 v[84:87], a[68:71], a[212:215], v[84:87]
    v_mfma_f32_16x16x32_bf16 v[88:91], a[68:71], a[216:219], v[88:91]
    ds_read_b128 a[244:247], v6 offset:54272
    v_mfma_f32_16x16x32_bf16 v[92:95], a[68:71], a[220:223], v[92:95]
    buffer_load_dwordx4 a[68:71], v1, s[12:15], s36 offen offset:1024
    v_mfma_f32_16x16x32_bf16 v[96:99], a[72:75], a[208:211], v[96:99]
    ds_read_b128 a[248:251], v6 offset:55296
    v_mfma_f32_16x16x32_bf16 v[100:103], a[72:75], a[212:215], v[100:103]
    v_mfma_f32_16x16x32_bf16 v[104:107], a[72:75], a[216:219], v[104:107]
    ds_read_b128 a[252:255], v6 offset:56320
    v_mfma_f32_16x16x32_bf16 v[108:111], a[72:75], a[220:223], v[108:111]
    buffer_load_dwordx4 a[72:75], v1, s[12:15], s36 offen offset:2048
    v_mfma_f32_16x16x32_bf16 v[144:147], a[76:79], a[208:211], v[144:147]
    v_cvt_pk_bf16_f32 v236, v48, v49
    v_mfma_f32_16x16x32_bf16 v[148:151], a[76:79], a[212:215], v[148:151]
    v_mfma_f32_16x16x32_bf16 v[152:155], a[76:79], a[216:219], v[152:155]
    v_cvt_pk_bf16_f32 v237, v50, v51
    v_mfma_f32_16x16x32_bf16 v[156:159], a[76:79], a[220:223], v[156:159]
    buffer_load_dwordx4 a[76:79], v1, s[12:15], s36 offen offset:3072
    s_waitcnt vmcnt(49) lgkmcnt(4)
    v_mfma_f32_16x16x32_bf16 v[80:83], a[80:83], a[224:227], v[80:83]
    ds_read_b128 a[192:195], v6 offset:57344
    v_mfma_f32_16x16x32_bf16 v[84:87], a[80:83], a[228:231], v[84:87]
    ds_read_b128 a[196:199], v6 offset:58368
    v_mfma_f32_16x16x32_bf16 v[88:91], a[80:83], a[232:235], v[88:91]
    v_mfma_f32_16x16x32_bf16 v[92:95], a[80:83], a[236:239], v[92:95]
    s_add_u32 s36, s36, 4096
    buffer_load_dwordx4 a[80:83], v1, s[12:15], s36 offen offset:0
    v_mfma_f32_16x16x32_bf16 v[96:99], a[84:87], a[224:227], v[96:99]
    ds_read_b128 a[200:203], v6 offset:59392
    v_mfma_f32_16x16x32_bf16 v[100:103], a[84:87], a[228:231], v[100:103]
pad0_95:
    s_cbranch_execz kf_kernel_done
    ds_read_b128 a[204:207], v6 offset:60416
    v_mfma_f32_16x16x32_bf16 v[104:107], a[84:87], a[232:235], v[104:107]
    v_cvt_pk_bf16_f32 v238, v64, v65
    v_mfma_f32_16x16x32_bf16 v[108:111], a[84:87], a[236:239], v[108:111]
    buffer_load_dwordx4 a[84:87], v1, s[12:15], s36 offen offset:1024
    v_mfma_f32_16x16x32_bf16 v[144:147], a[88:91], a[224:227], v[144:147]
    v_cvt_pk_bf16_f32 v239, v66, v67
    v_mfma_f32_16x16x32_bf16 v[148:151], a[88:91], a[228:231], v[148:151]
    v_mfma_f32_16x16x32_bf16 v[152:155], a[88:91], a[232:235], v[152:155]
    buffer_store_dwordx4 v[236:239], v2, s[28:31], s41 offen offset:0 sc1
    v_mfma_f32_16x16x32_bf16 v[156:159], a[88:91], a[236:239], v[156:159]
    buffer_load_dwordx4 a[88:91], v1, s[12:15], s36 offen offset:2048
    s_waitcnt vmcnt(50) lgkmcnt(4)
    v_mfma_f32_16x16x32_bf16 v[80:83], a[92:95], a[240:243], v[80:83]
    ds_read_b128 a[208:211], v6 offset:61440
    v_mfma_f32_16x16x32_bf16 v[84:87], a[92:95], a[244:247], v[84:87]
    v_mfma_f32_16x16x32_bf16 v[88:91], a[92:95], a[248:251], v[88:91]
    ds_read_b128 a[212:215], v6 offset:62464
    v_mfma_f32_16x16x32_bf16 v[92:95], a[92:95], a[252:255], v[92:95]
    buffer_load_dwordx4 a[92:95], v1, s[12:15], s36 offen offset:3072
    v_mfma_f32_16x16x32_bf16 v[96:99], a[96:99], a[240:243], v[96:99]
    ds_read_b128 a[216:219], v6 offset:63488
    v_mfma_f32_16x16x32_bf16 v[100:103], a[96:99], a[244:247], v[100:103]
    v_mfma_f32_16x16x32_bf16 v[104:107], a[96:99], a[248:251], v[104:107]
    ds_read_b128 a[220:223], v6 offset:64512
    v_mfma_f32_16x16x32_bf16 v[108:111], a[96:99], a[252:255], v[108:111]
    s_add_u32 s36, s36, 4096
    buffer_load_dwordx4 a[96:99], v1, s[12:15], s36 offen offset:0
    v_mfma_f32_16x16x32_bf16 v[144:147], a[100:103], a[240:243], v[144:147]
    v_cvt_pk_bf16_f32 v240, v52, v53
    v_mfma_f32_16x16x32_bf16 v[148:151], a[100:103], a[244:247], v[148:151]
    v_mfma_f32_16x16x32_bf16 v[152:155], a[100:103], a[248:251], v[152:155]
pad0_96:
    s_cbranch_execz kf_kernel_done
    v_cvt_pk_bf16_f32 v241, v54, v55
    v_mfma_f32_16x16x32_bf16 v[156:159], a[100:103], a[252:255], v[156:159]
    buffer_load_dwordx4 a[100:103], v1, s[12:15], s36 offen offset:1024
    s_waitcnt vmcnt(50) lgkmcnt(4)
    v_mfma_f32_16x16x32_bf16 v[80:83], a[104:107], a[192:195], v[80:83]
    ds_read_b128 a[224:227], v7 offset:0
    v_mfma_f32_16x16x32_bf16 v[84:87], a[104:107], a[196:199], v[84:87]
    ds_read_b128 a[228:231], v7 offset:1024
    v_mfma_f32_16x16x32_bf16 v[88:91], a[104:107], a[200:203], v[88:91]
    v_mfma_f32_16x16x32_bf16 v[92:95], a[104:107], a[204:207], v[92:95]
    buffer_load_dwordx4 a[104:107], v1, s[12:15], s36 offen offset:2048
    v_mfma_f32_16x16x32_bf16 v[96:99], a[108:111], a[192:195], v[96:99]
    ds_read_b128 a[232:235], v7 offset:2048
    v_mfma_f32_16x16x32_bf16 v[100:103], a[108:111], a[196:199], v[100:103]
    ds_read_b128 a[236:239], v7 offset:3072
    v_mfma_f32_16x16x32_bf16 v[104:107], a[108:111], a[200:203], v[104:107]
    v_cvt_pk_bf16_f32 v242, v68, v69
    v_mfma_f32_16x16x32_bf16 v[108:111], a[108:111], a[204:207], v[108:111]
    buffer_load_dwordx4 a[108:111], v1, s[12:15], s36 offen offset:3072
    v_mfma_f32_16x16x32_bf16 v[144:147], a[112:115], a[192:195], v[144:147]
    v_cvt_pk_bf16_f32 v243, v70, v71
    v_mfma_f32_16x16x32_bf16 v[148:151], a[112:115], a[196:199], v[148:151]
    v_mfma_f32_16x16x32_bf16 v[152:155], a[112:115], a[200:203], v[152:155]
    buffer_store_dwordx4 v[240:243], v2, s[28:31], s41 offen offset:1024 sc1
    v_mfma_f32_16x16x32_bf16 v[156:159], a[112:115], a[204:207], v[156:159]
    s_add_u32 s36, s36, 4096
    buffer_load_dwordx4 a[112:115], v1, s[12:15], s36 offen offset:0
    s_waitcnt vmcnt(51) lgkmcnt(4)
    v_mfma_f32_16x16x32_bf16 v[80:83], a[116:119], a[208:211], v[80:83]
    ds_read_b128 a[240:243], v7 offset:4096
    v_mfma_f32_16x16x32_bf16 v[84:87], a[116:119], a[212:215], v[84:87]
    v_mfma_f32_16x16x32_bf16 v[88:91], a[116:119], a[216:219], v[88:91]
    ds_read_b128 a[244:247], v7 offset:5120
pad0_97:
    s_cbranch_execz kf_kernel_done
    v_mfma_f32_16x16x32_bf16 v[92:95], a[116:119], a[220:223], v[92:95]
    buffer_load_dwordx4 a[116:119], v1, s[12:15], s36 offen offset:1024
    v_mfma_f32_16x16x32_bf16 v[96:99], a[120:123], a[208:211], v[96:99]
    ds_read_b128 a[248:251], v7 offset:6144
    v_mfma_f32_16x16x32_bf16 v[100:103], a[120:123], a[212:215], v[100:103]
    v_mfma_f32_16x16x32_bf16 v[104:107], a[120:123], a[216:219], v[104:107]
    ds_read_b128 a[252:255], v7 offset:7168
    v_mfma_f32_16x16x32_bf16 v[108:111], a[120:123], a[220:223], v[108:111]
    buffer_load_dwordx4 a[120:123], v1, s[12:15], s36 offen offset:2048
    v_mfma_f32_16x16x32_bf16 v[144:147], a[124:127], a[208:211], v[144:147]
    v_cvt_pk_bf16_f32 v244, v56, v57
    v_mfma_f32_16x16x32_bf16 v[148:151], a[124:127], a[212:215], v[148:151]
    v_mfma_f32_16x16x32_bf16 v[152:155], a[124:127], a[216:219], v[152:155]
    v_cvt_pk_bf16_f32 v245, v58, v59
    v_mfma_f32_16x16x32_bf16 v[156:159], a[124:127], a[220:223], v[156:159]
    buffer_load_dwordx4 a[124:127], v1, s[12:15], s36 offen offset:3072
    s_waitcnt vmcnt(51) lgkmcnt(4)
    v_mfma_f32_16x16x32_bf16 v[80:83], a[128:131], a[224:227], v[80:83]
    ds_read_b128 a[192:195], v7 offset:8192
    v_mfma_f32_16x16x32_bf16 v[84:87], a[128:131], a[228:231], v[84:87]
    ds_read_b128 a[196:199], v7 offset:9216
    v_mfma_f32_16x16x32_bf16 v[88:91], a[128:131], a[232:235], v[88:91]
    v_mfma_f32_16x16x32_bf16 v[92:95], a[128:131], a[236:239], v[92:95]
    v_mfma_f32_16x16x32_bf16 v[96:99], a[132:135], a[224:227], v[96:99]
    ds_read_b128 a[200:203], v7 offset:10240
    v_mfma_f32_16x16x32_bf16 v[100:103], a[132:135], a[228:231], v[100:103]
    ds_read_b128 a[204:207], v7 offset:11264
    v_mfma_f32_16x16x32_bf16 v[104:107], a[132:135], a[232:235], v[104:107]
    v_cvt_pk_bf16_f32 v246, v72, v73
    v_mfma_f32_16x16x32_bf16 v[108:111], a[132:135], a[236:239], v[108:111]
    v_mfma_f32_16x16x32_bf16 v[144:147], a[136:139], a[224:227], v[144:147]
    v_cvt_pk_bf16_f32 v247, v74, v75
pad0_98:
    s_cbranch_execz kf_kernel_done
    v_mfma_f32_16x16x32_bf16 v[148:151], a[136:139], a[228:231], v[148:151]
    v_mfma_f32_16x16x32_bf16 v[152:155], a[136:139], a[232:235], v[152:155]
    buffer_store_dwordx4 v[244:247], v2, s[28:31], s41 offen offset:2048 sc1
    v_mfma_f32_16x16x32_bf16 v[156:159], a[136:139], a[236:239], v[156:159]
    s_waitcnt vmcnt(49) lgkmcnt(4)
    v_mfma_f32_16x16x32_bf16 v[80:83], a[140:143], a[240:243], v[80:83]
    ds_read_b128 a[208:211], v7 offset:12288
    v_mfma_f32_16x16x32_bf16 v[84:87], a[140:143], a[244:247], v[84:87]
    v_mfma_f32_16x16x32_bf16 v[88:91], a[140:143], a[248:251], v[88:91]
    ds_read_b128 a[212:215], v7 offset:13312
    v_mfma_f32_16x16x32_bf16 v[92:95], a[140:143], a[252:255], v[92:95]
    v_mfma_f32_16x16x32_bf16 v[96:99], a[160:163], a[240:243], v[96:99]
    ds_read_b128 a[216:219], v7 offset:14336
    v_mfma_f32_16x16x32_bf16 v[100:103], a[160:163], a[244:247], v[100:103]
    v_mfma_f32_16x16x32_bf16 v[104:107], a[160:163], a[248:251], v[104:107]
    ds_read_b128 a[220:223], v7 offset:15360
    v_mfma_f32_16x16x32_bf16 v[108:111], a[160:163], a[252:255], v[108:111]
    v_mfma_f32_16x16x32_bf16 v[144:147], a[164:167], a[240:243], v[144:147]
    v_cvt_pk_bf16_f32 v248, v60, v61
    v_mfma_f32_16x16x32_bf16 v[148:151], a[164:167], a[244:247], v[148:151]
    v_mfma_f32_16x16x32_bf16 v[152:155], a[164:167], a[248:251], v[152:155]
    v_cvt_pk_bf16_f32 v249, v62, v63
    v_mfma_f32_16x16x32_bf16 v[156:159], a[164:167], a[252:255], v[156:159]
    s_waitcnt vmcnt(46) lgkmcnt(4)
    v_mfma_f32_16x16x32_bf16 v[80:83], a[168:171], a[192:195], v[80:83]
    ds_read_b128 a[224:227], v6 offset:8192
    v_mfma_f32_16x16x32_bf16 v[84:87], a[168:171], a[196:199], v[84:87]
    ds_read_b128 a[228:231], v6 offset:9216
    v_mfma_f32_16x16x32_bf16 v[88:91], a[168:171], a[200:203], v[88:91]
    v_mfma_f32_16x16x32_bf16 v[92:95], a[168:171], a[204:207], v[92:95]
    v_mfma_f32_16x16x32_bf16 v[96:99], a[172:175], a[192:195], v[96:99]
    ds_read_b128 a[232:235], v6 offset:10240
pad0_99:
    s_cbranch_execz kf_kernel_done
    v_mfma_f32_16x16x32_bf16 v[100:103], a[172:175], a[196:199], v[100:103]
    ds_read_b128 a[236:239], v6 offset:11264
    v_mfma_f32_16x16x32_bf16 v[104:107], a[172:175], a[200:203], v[104:107]
    v_cvt_pk_bf16_f32 v250, v76, v77
    v_mfma_f32_16x16x32_bf16 v[108:111], a[172:175], a[204:207], v[108:111]
    v_mfma_f32_16x16x32_bf16 v[144:147], a[176:179], a[192:195], v[144:147]
    v_cvt_pk_bf16_f32 v251, v78, v79
    v_mfma_f32_16x16x32_bf16 v[148:151], a[176:179], a[196:199], v[148:151]
    v_mfma_f32_16x16x32_bf16 v[152:155], a[176:179], a[200:203], v[152:155]
    buffer_store_dwordx4 v[248:251], v2, s[28:31], s41 offen offset:3072 sc1
    v_mfma_f32_16x16x32_bf16 v[156:159], a[176:179], a[204:207], v[156:159]
    s_waitcnt vmcnt(44) lgkmcnt(4)
    v_mfma_f32_16x16x32_bf16 v[80:83], a[180:183], a[208:211], v[80:83]
    ds_read_b128 a[240:243], v6 offset:12288
    v_mfma_f32_16x16x32_bf16 v[84:87], a[180:183], a[212:215], v[84:87]
    v_mfma_f32_16x16x32_bf16 v[88:91], a[180:183], a[216:219], v[88:91]
    v_mfma_f32_16x16x32_bf16 v[92:95], a[180:183], a[220:223], v[92:95]
    v_mfma_f32_16x16x32_bf16 v[96:99], a[184:187], a[208:211], v[96:99]
    ds_read_b128 a[244:247], v6 offset:13312
    v_mfma_f32_16x16x32_bf16 v[100:103], a[184:187], a[212:215], v[100:103]
    v_mfma_f32_16x16x32_bf16 v[104:107], a[184:187], a[216:219], v[104:107]
    ds_read_b128 a[248:251], v6 offset:14336
    v_mfma_f32_16x16x32_bf16 v[108:111], a[184:187], a[220:223], v[108:111]
    v_mfma_f32_16x16x32_bf16 v[144:147], a[188:191], a[208:211], v[144:147]
    v_mfma_f32_16x16x32_bf16 v[148:151], a[188:191], a[212:215], v[148:151]
    ds_read_b128 a[252:255], v6 offset:15360
    v_mfma_f32_16x16x32_bf16 v[152:155], a[188:191], a[216:219], v[152:155]
    v_mfma_f32_16x16x32_bf16 v[156:159], a[188:191], a[220:223], v[156:159]
    s_waitcnt vmcnt(42) lgkmcnt(4)
    v_mfma_f32_16x16x32_bf16 v[112:115], a[144:147], a[224:227], v[112:115]
    ds_read_b128 a[192:195], v6 offset:16384
    v_mfma_f32_16x16x32_bf16 v[116:119], a[144:147], a[228:231], v[116:119]
    v_mfma_f32_16x16x32_bf16 v[120:123], a[144:147], a[232:235], v[120:123]
pad0_100:
    s_cbranch_execz kf_kernel_done
    ds_read_b128 a[196:199], v6 offset:17408
    v_mfma_f32_16x16x32_bf16 v[124:127], a[144:147], a[236:239], v[124:127]
    v_mfma_f32_16x16x32_bf16 v[128:131], a[148:151], a[224:227], v[128:131]
    ds_read_b128 a[200:203], v6 offset:18432
    v_mfma_f32_16x16x32_bf16 v[132:135], a[148:151], a[228:231], v[132:135]
    v_mfma_f32_16x16x32_bf16 v[136:139], a[148:151], a[232:235], v[136:139]
    ds_read_b128 a[204:207], v6 offset:19456
    v_mfma_f32_16x16x32_bf16 v[140:143], a[148:151], a[236:239], v[140:143]
    s_waitcnt vmcnt(39) lgkmcnt(4)
    v_mfma_f32_16x16x32_bf16 v[112:115], a[152:155], a[240:243], v[112:115]
    ds_read_b128 a[208:211], v6 offset:20480
    v_mfma_f32_16x16x32_bf16 v[116:119], a[152:155], a[244:247], v[116:119]
    ds_read_b128 a[212:215], v6 offset:21504
    v_mfma_f32_16x16x32_bf16 v[120:123], a[152:155], a[248:251], v[120:123]
    ds_read_b128 a[216:219], v6 offset:22528
    v_mfma_f32_16x16x32_bf16 v[124:127], a[152:155], a[252:255], v[124:127]
    v_mfma_f32_16x16x32_bf16 v[128:131], a[156:159], a[240:243], v[128:131]
    ds_read_b128 a[220:223], v6 offset:23552
    v_cvt_pk_bf16_f32 v252, v80, v81
    v_mfma_f32_16x16x32_bf16 v[132:135], a[156:159], a[244:247], v[132:135]
    v_cvt_pk_bf16_f32 v253, v82, v83
    v_mfma_f32_16x16x32_bf16 v[136:139], a[156:159], a[248:251], v[136:139]
    v_cvt_pk_bf16_f32 v254, v96, v97
    v_cvt_pk_bf16_f32 v255, v98, v99
    v_mfma_f32_16x16x32_bf16 v[140:143], a[156:159], a[252:255], v[140:143]
    s_waitcnt vmcnt(37) lgkmcnt(4)
    v_mfma_f32_16x16x32_bf16 v[112:115], a[0:3], a[192:195], v[112:115]
    ds_read_b128 a[224:227], v6 offset:24576
    v_mfma_f32_16x16x32_bf16 v[116:119], a[0:3], a[196:199], v[116:119]
    ds_read_b128 a[228:231], v6 offset:25600
    v_mfma_f32_16x16x32_bf16 v[120:123], a[0:3], a[200:203], v[120:123]
    ds_read_b128 a[232:235], v6 offset:26624
pad0_101:
    s_cbranch_execz kf_kernel_done
    v_mfma_f32_16x16x32_bf16 v[124:127], a[0:3], a[204:207], v[124:127]
    v_mfma_f32_16x16x32_bf16 v[128:131], a[4:7], a[192:195], v[128:131]
    ds_read_b128 a[236:239], v6 offset:27648
    buffer_store_dwordx4 v[252:255], v2, s[28:31], s42 offen offset:0 sc1
    v_mfma_f32_16x16x32_bf16 v[132:135], a[4:7], a[196:199], v[132:135]
    v_cvt_pk_bf16_f32 v232, v84, v85
    v_mfma_f32_16x16x32_bf16 v[136:139], a[4:7], a[200:203], v[136:139]
    v_cvt_pk_bf16_f32 v233, v86, v87
    v_cvt_pk_bf16_f32 v234, v100, v101
    v_mfma_f32_16x16x32_bf16 v[140:143], a[4:7], a[204:207], v[140:143]
    s_waitcnt vmcnt(36) lgkmcnt(4)
    v_mfma_f32_16x16x32_bf16 v[112:115], a[8:11], a[208:211], v[112:115]
    ds_read_b128 a[240:243], v6 offset:28672
    v_mfma_f32_16x16x32_bf16 v[116:119], a[8:11], a[212:215], v[116:119]
    ds_read_b128 a[244:247], v6 offset:29696
    v_mfma_f32_16x16x32_bf16 v[120:123], a[8:11], a[216:219], v[120:123]
    ds_read_b128 a[248:251], v6 offset:30720
    v_mfma_f32_16x16x32_bf16 v[124:127], a[8:11], a[220:223], v[124:127]
    v_mfma_f32_16x16x32_bf16 v[128:131], a[12:15], a[208:211], v[128:131]
    ds_read_b128 a[252:255], v6 offset:31744
    v_cvt_pk_bf16_f32 v235, v102, v103
    v_mfma_f32_16x16x32_bf16 v[132:135], a[12:15], a[212:215], v[132:135]
    buffer_store_dwordx4 v[232:235], v2, s[28:31], s42 offen offset:1024 sc1
    v_mfma_f32_16x16x32_bf16 v[136:139], a[12:15], a[216:219], v[136:139]
    v_cvt_pk_bf16_f32 v236, v88, v89
    v_cvt_pk_bf16_f32 v237, v90, v91
    v_mfma_f32_16x16x32_bf16 v[140:143], a[12:15], a[220:223], v[140:143]
    s_waitcnt vmcnt(34) lgkmcnt(4)
    v_mfma_f32_16x16x32_bf16 v[112:115], a[16:19], a[224:227], v[112:115]
    ds_read_b128 a[192:195], v6 offset:32768
    v_mfma_f32_16x16x32_bf16 v[116:119], a[16:19], a[228:231], v[116:119]
    ds_read_b128 a[196:199], v6 offset:33792
    v_mfma_f32_16x16x32_bf16 v[120:123], a[16:19], a[232:235], v[120:123]
pad0_102:
    s_cbranch_execz kf_kernel_done
    ds_read_b128 a[200:203], v6 offset:34816
    v_mfma_f32_16x16x32_bf16 v[124:127], a[16:19], a[236:239], v[124:127]
    v_mfma_f32_16x16x32_bf16 v[128:131], a[20:23], a[224:227], v[128:131]
    ds_read_b128 a[204:207], v6 offset:35840
    v_cvt_pk_bf16_f32 v238, v104, v105
    v_mfma_f32_16x16x32_bf16 v[132:135], a[20:23], a[228:231], v[132:135]
    v_cvt_pk_bf16_f32 v239, v106, v107
    v_mfma_f32_16x16x32_bf16 v[136:139], a[20:23], a[232:235], v[136:139]
    buffer_store_dwordx4 v[236:239], v2, s[28:31], s42 offen offset:2048 sc1
    v_cvt_pk_bf16_f32 v240, v92, v93
    v_mfma_f32_16x16x32_bf16 v[140:143], a[20:23], a[236:239], v[140:143]
    s_waitcnt vmcnt(33) lgkmcnt(4)
    v_mfma_f32_16x16x32_bf16 v[112:115], a[24:27], a[240:243], v[112:115]
    ds_read_b128 a[208:211], v6 offset:36864
    v_mfma_f32_16x16x32_bf16 v[116:119], a[24:27], a[244:247], v[116:119]
    ds_read_b128 a[212:215], v6 offset:37888
    v_mfma_f32_16x16x32_bf16 v[120:123], a[24:27], a[248:251], v[120:123]
    ds_read_b128 a[216:219], v6 offset:38912
    v_mfma_f32_16x16x32_bf16 v[124:127], a[24:27], a[252:255], v[124:127]
    v_mfma_f32_16x16x32_bf16 v[128:131], a[28:31], a[240:243], v[128:131]
    ds_read_b128 a[220:223], v6 offset:39936
    v_cvt_pk_bf16_f32 v241, v94, v95
    v_mfma_f32_16x16x32_bf16 v[132:135], a[28:31], a[244:247], v[132:135]
    v_cvt_pk_bf16_f32 v242, v108, v109
    v_mfma_f32_16x16x32_bf16 v[136:139], a[28:31], a[248:251], v[136:139]
    v_cvt_pk_bf16_f32 v243, v110, v111
    buffer_store_dwordx4 v[240:243], v2, s[28:31], s42 offen offset:3072 sc1
    v_mfma_f32_16x16x32_bf16 v[140:143], a[28:31], a[252:255], v[140:143]
    s_waitcnt vmcnt(32) lgkmcnt(4)
    v_mfma_f32_16x16x32_bf16 v[112:115], a[32:35], a[192:195], v[112:115]
    ds_read_b128 a[224:227], v6 offset:40960
    v_mfma_f32_16x16x32_bf16 v[116:119], a[32:35], a[196:199], v[116:119]
pad0_103:
    s_cbranch_execz kf_kernel_done
    ds_read_b128 a[228:231], v6 offset:41984
    v_mfma_f32_16x16x32_bf16 v[120:123], a[32:35], a[200:203], v[120:123]
    ds_read_b128 a[232:235], v6 offset:43008
    v_mfma_f32_16x16x32_bf16 v[124:127], a[32:35], a[204:207], v[124:127]
    v_mfma_f32_16x16x32_bf16 v[128:131], a[36:39], a[192:195], v[128:131]
    ds_read_b128 a[236:239], v6 offset:44032
    v_cvt_pk_bf16_f32 v244, v144, v145
    v_mfma_f32_16x16x32_bf16 v[132:135], a[36:39], a[196:199], v[132:135]
    v_cvt_pk_bf16_f32 v245, v146, v147
    v_mfma_f32_16x16x32_bf16 v[136:139], a[36:39], a[200:203], v[136:139]
    buffer_store_dwordx2 v[244:245], v3, s[28:31], 0 offen offset:0 sc1
    v_cvt_pk_bf16_f32 v248, v148, v149
    v_mfma_f32_16x16x32_bf16 v[140:143], a[36:39], a[204:207], v[140:143]
    s_waitcnt vmcnt(30) lgkmcnt(4)
    v_mfma_f32_16x16x32_bf16 v[112:115], a[40:43], a[208:211], v[112:115]
    ds_read_b128 a[240:243], v6 offset:45056
    v_mfma_f32_16x16x32_bf16 v[116:119], a[40:43], a[212:215], v[116:119]
    ds_read_b128 a[244:247], v6 offset:46080
    v_mfma_f32_16x16x32_bf16 v[120:123], a[40:43], a[216:219], v[120:123]
    ds_read_b128 a[248:251], v6 offset:47104
    v_mfma_f32_16x16x32_bf16 v[124:127], a[40:43], a[220:223], v[124:127]
    v_mfma_f32_16x16x32_bf16 v[128:131], a[44:47], a[208:211], v[128:131]
    ds_read_b128 a[252:255], v6 offset:48128
    v_cvt_pk_bf16_f32 v249, v150, v151
    v_mfma_f32_16x16x32_bf16 v[132:135], a[44:47], a[212:215], v[132:135]
    buffer_store_dwordx2 v[248:249], v3, s[28:31], 0 offen offset:1024 sc1
    v_mfma_f32_16x16x32_bf16 v[136:139], a[44:47], a[216:219], v[136:139]
    v_cvt_pk_bf16_f32 v252, v152, v153
    v_cvt_pk_bf16_f32 v253, v154, v155
    v_mfma_f32_16x16x32_bf16 v[140:143], a[44:47], a[220:223], v[140:143]
    s_waitcnt vmcnt(29) lgkmcnt(4)
    v_mfma_f32_16x16x32_bf16 v[112:115], a[48:51], a[224:227], v[112:115]
    ds_read_b128 a[192:195], v6 offset:49152
pad0_104:
    s_cbranch_execz kf_kernel_done
    v_mfma_f32_16x16x32_bf16 v[116:119], a[48:51], a[228:231], v[116:119]
    ds_read_b128 a[196:199], v6 offset:50176
    v_mfma_f32_16x16x32_bf16 v[120:123], a[48:51], a[232:235], v[120:123]
    ds_read_b128 a[200:203], v6 offset:51200
    v_mfma_f32_16x16x32_bf16 v[124:127], a[48:51], a[236:239], v[124:127]
    v_mfma_f32_16x16x32_bf16 v[128:131], a[52:55], a[224:227], v[128:131]
    ds_read_b128 a[204:207], v6 offset:52224
    buffer_store_dwordx2 v[252:253], v3, s[28:31], 0 offen offset:2048 sc1
    v_mfma_f32_16x16x32_bf16 v[132:135], a[52:55], a[228:231], v[132:135]
    v_cvt_pk_bf16_f32 v232, v156, v157
    v_mfma_f32_16x16x32_bf16 v[136:139], a[52:55], a[232:235], v[136:139]
    v_cvt_pk_bf16_f32 v233, v158, v159
    buffer_store_dwordx2 v[232:233], v3, s[28:31], 0 offen offset:3072 sc1
    v_mfma_f32_16x16x32_bf16 v[140:143], a[52:55], a[236:239], v[140:143]
    s_waitcnt vmcnt(29) lgkmcnt(4)
    v_mfma_f32_16x16x32_bf16 v[112:115], a[56:59], a[240:243], v[112:115]
    ds_read_b128 a[208:211], v6 offset:53248
    v_mfma_f32_16x16x32_bf16 v[116:119], a[56:59], a[244:247], v[116:119]
    v_mfma_f32_16x16x32_bf16 v[120:123], a[56:59], a[248:251], v[120:123]
    ds_read_b128 a[212:215], v6 offset:54272
    v_mfma_f32_16x16x32_bf16 v[124:127], a[56:59], a[252:255], v[124:127]
    v_mfma_f32_16x16x32_bf16 v[128:131], a[60:63], a[240:243], v[128:131]
    ds_read_b128 a[216:219], v6 offset:55296
    v_mfma_f32_16x16x32_bf16 v[132:135], a[60:63], a[244:247], v[132:135]
    v_mfma_f32_16x16x32_bf16 v[136:139], a[60:63], a[248:251], v[136:139]
    ds_read_b128 a[220:223], v6 offset:56320
    v_mfma_f32_16x16x32_bf16 v[140:143], a[60:63], a[252:255], v[140:143]
    s_waitcnt vmcnt(26) lgkmcnt(4)
    v_mfma_f32_16x16x32_bf16 v[112:115], a[64:67], a[192:195], v[112:115]
    ds_read_b128 a[224:227], v6 offset:57344
    v_mfma_f32_16x16x32_bf16 v[116:119], a[64:67], a[196:199], v[116:119]
    v_mfma_f32_16x16x32_bf16 v[120:123], a[64:67], a[200:203], v[120:123]
pad0_105:
    s_cbranch_execz kf_kernel_done
    ds_read_b128 a[228:231], v6 offset:58368
    v_mfma_f32_16x16x32_bf16 v[124:127], a[64:67], a[204:207], v[124:127]
    v_mfma_f32_16x16x32_bf16 v[128:131], a[68:71], a[192:195], v[128:131]
    ds_read_b128 a[232:235], v6 offset:59392
    v_mfma_f32_16x16x32_bf16 v[132:135], a[68:71], a[196:199], v[132:135]
    v_mfma_f32_16x16x32_bf16 v[136:139], a[68:71], a[200:203], v[136:139]
    ds_read_b128 a[236:239], v6 offset:60416
    v_mfma_f32_16x16x32_bf16 v[140:143], a[68:71], a[204:207], v[140:143]
    s_waitcnt vmcnt(24) lgkmcnt(4)
    v_mfma_f32_16x16x32_bf16 v[112:115], a[72:75], a[208:211], v[112:115]
    ds_read_b128 a[240:243], v6 offset:61440
    v_mfma_f32_16x16x32_bf16 v[116:119], a[72:75], a[212:215], v[116:119]
    v_mfma_f32_16x16x32_bf16 v[120:123], a[72:75], a[216:219], v[120:123]
    ds_read_b128 a[244:247], v6 offset:62464
    v_mfma_f32_16x16x32_bf16 v[124:127], a[72:75], a[220:223], v[124:127]
    v_mfma_f32_16x16x32_bf16 v[128:131], a[76:79], a[208:211], v[128:131]
    ds_read_b128 a[248:251], v6 offset:63488
    v_mfma_f32_16x16x32_bf16 v[132:135], a[76:79], a[212:215], v[132:135]
    v_mfma_f32_16x16x32_bf16 v[136:139], a[76:79], a[216:219], v[136:139]
    ds_read_b128 a[252:255], v6 offset:64512
    v_mfma_f32_16x16x32_bf16 v[140:143], a[76:79], a[220:223], v[140:143]
    s_waitcnt vmcnt(22) lgkmcnt(4)
    v_mfma_f32_16x16x32_bf16 v[112:115], a[80:83], a[224:227], v[112:115]
    ds_read_b128 a[192:195], v7 offset:0
    v_mfma_f32_16x16x32_bf16 v[116:119], a[80:83], a[228:231], v[116:119]
    v_mfma_f32_16x16x32_bf16 v[120:123], a[80:83], a[232:235], v[120:123]
    ds_read_b128 a[196:199], v7 offset:1024
    v_mfma_f32_16x16x32_bf16 v[124:127], a[80:83], a[236:239], v[124:127]
    v_mfma_f32_16x16x32_bf16 v[128:131], a[84:87], a[224:227], v[128:131]
    ds_read_b128 a[200:203], v7 offset:2048
    v_mfma_f32_16x16x32_bf16 v[132:135], a[84:87], a[228:231], v[132:135]
    v_mfma_f32_16x16x32_bf16 v[136:139], a[84:87], a[232:235], v[136:139]
    ds_read_b128 a[204:207], v7 offset:3072
pad0_106:
    s_cbranch_execz kf_kernel_done
    v_mfma_f32_16x16x32_bf16 v[140:143], a[84:87], a[236:239], v[140:143]
    s_waitcnt vmcnt(19) lgkmcnt(4)
    v_mfma_f32_16x16x32_bf16 v[112:115], a[88:91], a[240:243], v[112:115]
    ds_read_b128 a[208:211], v7 offset:4096
    v_mfma_f32_16x16x32_bf16 v[116:119], a[88:91], a[244:247], v[116:119]
    v_mfma_f32_16x16x32_bf16 v[120:123], a[88:91], a[248:251], v[120:123]
    ds_read_b128 a[212:215], v7 offset:5120
    v_mfma_f32_16x16x32_bf16 v[124:127], a[88:91], a[252:255], v[124:127]
    v_mfma_f32_16x16x32_bf16 v[128:131], a[92:95], a[240:243], v[128:131]
    ds_read_b128 a[216:219], v7 offset:6144
    v_mfma_f32_16x16x32_bf16 v[132:135], a[92:95], a[244:247], v[132:135]
    v_mfma_f32_16x16x32_bf16 v[136:139], a[92:95], a[248:251], v[136:139]
    ds_read_b128 a[220:223], v7 offset:7168
    v_mfma_f32_16x16x32_bf16 v[140:143], a[92:95], a[252:255], v[140:143]
    s_waitcnt vmcnt(17) lgkmcnt(4)
    v_mfma_f32_16x16x32_bf16 v[112:115], a[96:99], a[192:195], v[112:115]
    ds_read_b128 a[224:227], v7 offset:8192
    v_mfma_f32_16x16x32_bf16 v[116:119], a[96:99], a[196:199], v[116:119]
    v_mfma_f32_16x16x32_bf16 v[120:123], a[96:99], a[200:203], v[120:123]
    ds_read_b128 a[228:231], v7 offset:9216
    v_mfma_f32_16x16x32_bf16 v[124:127], a[96:99], a[204:207], v[124:127]
    v_mfma_f32_16x16x32_bf16 v[128:131], a[100:103], a[192:195], v[128:131]
    ds_read_b128 a[232:235], v7 offset:10240
    v_mfma_f32_16x16x32_bf16 v[132:135], a[100:103], a[196:199], v[132:135]
    v_mfma_f32_16x16x32_bf16 v[136:139], a[100:103], a[200:203], v[136:139]
    ds_read_b128 a[236:239], v7 offset:11264
    v_mfma_f32_16x16x32_bf16 v[140:143], a[100:103], a[204:207], v[140:143]
    s_waitcnt vmcnt(15) lgkmcnt(4)
    v_mfma_f32_16x16x32_bf16 v[112:115], a[104:107], a[208:211], v[112:115]
    ds_read_b128 a[240:243], v7 offset:12288
    v_mfma_f32_16x16x32_bf16 v[116:119], a[104:107], a[212:215], v[116:119]
    v_mfma_f32_16x16x32_bf16 v[120:123], a[104:107], a[216:219], v[120:123]
    ds_read_b128 a[244:247], v7 offset:13312
pad0_107:
    s_cbranch_execz kf_kernel_done
    v_mfma_f32_16x16x32_bf16 v[124:127], a[104:107], a[220:223], v[124:127]
    v_mfma_f32_16x16x32_bf16 v[128:131], a[108:111], a[208:211], v[128:131]
    ds_read_b128 a[248:251], v7 offset:14336
    v_mfma_f32_16x16x32_bf16 v[132:135], a[108:111], a[212:215], v[132:135]
    v_mfma_f32_16x16x32_bf16 v[136:139], a[108:111], a[216:219], v[136:139]
    ds_read_b128 a[252:255], v7 offset:15360
    v_mfma_f32_16x16x32_bf16 v[140:143], a[108:111], a[220:223], v[140:143]
    s_waitcnt vmcnt(12) lgkmcnt(4)
    v_mfma_f32_16x16x32_bf16 v[112:115], a[112:115], a[224:227], v[112:115]
    v_mfma_f32_16x16x32_bf16 v[116:119], a[112:115], a[228:231], v[116:119]
    v_mfma_f32_16x16x32_bf16 v[120:123], a[112:115], a[232:235], v[120:123]
    v_mfma_f32_16x16x32_bf16 v[124:127], a[112:115], a[236:239], v[124:127]
    v_mfma_f32_16x16x32_bf16 v[128:131], a[116:119], a[224:227], v[128:131]
    v_mfma_f32_16x16x32_bf16 v[132:135], a[116:119], a[228:231], v[132:135]
    v_mfma_f32_16x16x32_bf16 v[136:139], a[116:119], a[232:235], v[136:139]
    v_mfma_f32_16x16x32_bf16 v[140:143], a[116:119], a[236:239], v[140:143]
    s_waitcnt vmcnt(10) lgkmcnt(0)
    v_mfma_f32_16x16x32_bf16 v[112:115], a[120:123], a[240:243], v[112:115]
    v_mfma_f32_16x16x32_bf16 v[116:119], a[120:123], a[244:247], v[116:119]
    v_mfma_f32_16x16x32_bf16 v[120:123], a[120:123], a[248:251], v[120:123]
    v_mfma_f32_16x16x32_bf16 v[124:127], a[120:123], a[252:255], v[124:127]
    v_mfma_f32_16x16x32_bf16 v[128:131], a[124:127], a[240:243], v[128:131]
    v_mfma_f32_16x16x32_bf16 v[132:135], a[124:127], a[244:247], v[132:135]
    v_mfma_f32_16x16x32_bf16 v[136:139], a[124:127], a[248:251], v[136:139]
    v_mfma_f32_16x16x32_bf16 v[140:143], a[124:127], a[252:255], v[140:143]
    s_nop 0
    v_cvt_pk_bf16_f32 v236, v112, v113
    v_cvt_pk_bf16_f32 v237, v114, v115
    s_nop 1
    v_cvt_pk_bf16_f32 v238, v128, v129
    v_cvt_pk_bf16_f32 v239, v130, v131
    buffer_store_dwordx4 v[236:239], v2, s[28:31], s43 offen offset:0 sc1
    v_cvt_pk_bf16_f32 v240, v116, v117
pad0_108:
    s_cbranch_execz kf_kernel_done
    v_cvt_pk_bf16_f32 v241, v118, v119
    v_cvt_pk_bf16_f32 v242, v132, v133
    v_cvt_pk_bf16_f32 v243, v134, v135
    buffer_store_dwordx4 v[240:243], v2, s[28:31], s43 offen offset:1024 sc1
    v_cvt_pk_bf16_f32 v244, v120, v121
    v_cvt_pk_bf16_f32 v245, v122, v123
    v_cvt_pk_bf16_f32 v246, v136, v137
    v_cvt_pk_bf16_f32 v247, v138, v139
    buffer_store_dwordx4 v[244:247], v2, s[28:31], s43 offen offset:2048 sc1
    v_cvt_pk_bf16_f32 v248, v124, v125
    v_cvt_pk_bf16_f32 v249, v126, v127
    v_cvt_pk_bf16_f32 v250, v140, v141
    v_cvt_pk_bf16_f32 v251, v142, v143
    buffer_store_dwordx4 v[248:251], v2, s[28:31], s43 offen offset:3072 sc1
kf_kernel_done:
    s_endpgm
.section .rodata,"a"
.p2align 6
.amdhsa_kernel kf_kernel
  .amdhsa_next_free_vgpr 512
  .amdhsa_next_free_sgpr 96
  .amdhsa_accum_offset 256
  .amdhsa_group_segment_fixed_size 0
  .amdhsa_kernarg_size 88
  .amdhsa_user_sgpr_count 2
  .amdhsa_user_sgpr_kernarg_segment_ptr 1
  .amdhsa_system_sgpr_workgroup_id_x 1
  .amdhsa_float_denorm_mode_32 3
  .amdhsa_float_denorm_mode_16_64 3
.end_amdhsa_kernel
.text
.globl ka2_kernel
.p2align 8
.type ka2_kernel,@function
ka2_kernel:
pad0_109:
    s_cbranch_execz ka2_kernel_done
    s_cmp_ge_u32 s2, 192
    s_cbranch_scc1 ka2_kernel_done
    s_load_dwordx2 s[4:5], s[0:1], 80
    v_lshrrev_b32 v2, 6, v0
    v_and_b32 v14, 63, v0
    v_readfirstlane_b32 s6, v2
    v_lshlrev_b32 v1, 4, v14
    v_and_b32 v12, 15, v14
    v_lshrrev_b32 v13, 4, v14
    s_and_b32 s7, s2, 7
    s_lshr_b32 s8, s2, 3
    s_and_b32 s9, s8, 7
    s_lshl_b32 s10, s7, 3
    s_add_u32 s9, s9, s10
    s_lshr_b32 s10, s8, 3
    s_and_b32 s11, s6, 1
    s_lshr_b32 s32, s6, 1
    s_and_b32 s33, s9, 31
    s_lshr_b32 s34, s9, 5
    s_lshl_b32 s34, s34, 1
    s_add_u32 s34, s34, s11
    s_mul_i32 s35, s33, 73728
    s_mul_i32 s36, s32, 12288
    s_add_u32 s35, s35, s36
    s_lshl_b32 s36, s34, 10
    s_add_u32 s35, s35, s36
    s_add_u32 s36, s35, 0
    v_add_u32 v2, s36, v1
    v_add_u32 v5, 36864, v2
    s_add_u32 s36, s35, 4096
    v_add_u32 v3, s36, v1
    v_add_u32 v6, 36864, v3
    s_add_u32 s36, s35, 8192
    v_add_u32 v4, s36, v1
    v_add_u32 v7, 36864, v4
    s_mov_b32 s40, 0
    s_mov_b32 s41, 2359296
    s_mov_b32 s42, 4718592
    s_mov_b32 s43, 7077888
    s_mov_b32 s44, 9437184
    s_mov_b32 s45, 11796480
    s_mov_b32 s46, 14155776
    s_mov_b32 s47, 16515072
    s_waitcnt lgkmcnt(0)
    s_add_u32 s20, s4, 0x1400000
    s_addc_u32 s21, s5, 0
pad0_110:
    s_cbranch_execz ka2_kernel_done
    s_and_b32 s21, s21, 0xffff
    s_mov_b32 s22, 0x1200000
    s_mov_b32 s23, 0x20000
    buffer_load_dwordx4 a[0:3], v2, s[20:23], s40 offen
    buffer_load_dwordx4 a[4:7], v5, s[20:23], s40 offen
    buffer_load_dwordx4 a[8:11], v2, s[20:23], s41 offen
    buffer_load_dwordx4 a[12:15], v5, s[20:23], s41 offen
    buffer_load_dwordx4 a[16:19], v2, s[20:23], s42 offen
    buffer_load_dwordx4 a[20:23], v5, s[20:23], s42 offen
    buffer_load_dwordx4 a[24:27], v2, s[20:23], s43 offen
    buffer_load_dwordx4 a[28:31], v5, s[20:23], s43 offen
    buffer_load_dwordx4 a[32:35], v2, s[20:23], s44 offen
    buffer_load_dwordx4 a[36:39], v5, s[20:23], s44 offen
    buffer_load_dwordx4 a[40:43], v2, s[20:23], s45 offen
    buffer_load_dwordx4 a[44:47], v5, s[20:23], s45 offen
    buffer_load_dwordx4 a[48:51], v2, s[20:23], s46 offen
    buffer_load_dwordx4 a[52:55], v5, s[20:23], s46 offen
    buffer_load_dwordx4 a[56:59], v2, s[20:23], s47 offen
    buffer_load_dwordx4 a[60:63], v5, s[20:23], s47 offen
    buffer_load_dwordx4 a[64:67], v3, s[20:23], s40 offen
    buffer_load_dwordx4 a[68:71], v6, s[20:23], s40 offen
    buffer_load_dwordx4 a[72:75], v3, s[20:23], s41 offen
    buffer_load_dwordx4 a[76:79], v6, s[20:23], s41 offen
    buffer_load_dwordx4 a[80:83], v3, s[20:23], s42 offen
    buffer_load_dwordx4 a[84:87], v6, s[20:23], s42 offen
    v_and_b32 v136, 1, v12
    v_lshlrev_b32 v136, 4, v136
    v_mov_b32 v137, 0x3f80
    v_lshlrev_b32 v136, v136, v137
    v_lshrrev_b32 v137, 1, v12
    v_lshlrev_b32 v11, 1, v13
    v_cmp_eq_u32 vcc, v137, v11
    s_nop 1
    v_cndmask_b32 v10, 0, v136, vcc
    v_add_u32 v11, 1, v11
    v_cmp_eq_u32 vcc, v137, v11
    s_nop 1
pad0_111:
    s_cbranch_execz ka2_kernel_done
    v_cndmask_b32 v11, 0, v136, vcc
    v_lshrrev_b32 v137, 2, v12
    v_cmp_eq_u32 vcc, v137, v13
    s_lshl_b32 s36, s11, 4
    v_add_u32 v144, s36, v12
    s_and_b32 s36, s32, 1
    s_mul_i32 s36, s36, 0xbe800000
    v_lshlrev_b32 v145, 2, v13
    s_mov_b32 s37, 0x3d000000
    v_add_u32 v136, 0, v145
    v_add_u32 v137, 1, v145
    v_add_u32 v138, 2, v145
    v_add_u32 v139, 3, v145
    v_add_u32 v140, 16, v145
    v_add_u32 v141, 17, v145
    v_add_u32 v142, 18, v145
    v_add_u32 v143, 19, v145
    v_mul_u32_u24 v136, v136, v144
    v_mul_u32_u24 v137, v137, v144
    v_mul_u32_u24 v138, v138, v144
    v_mul_u32_u24 v139, v139, v144
    v_mul_u32_u24 v140, v140, v144
    v_mul_u32_u24 v141, v141, v144
    v_mul_u32_u24 v142, v142, v144
    v_mul_u32_u24 v143, v143, v144
    v_cvt_f32_u32 v136, v136
    v_cvt_f32_u32 v137, v137
    v_cvt_f32_u32 v138, v138
    v_cvt_f32_u32 v139, v139
    v_cvt_f32_u32 v140, v140
    v_cvt_f32_u32 v141, v141
    v_cvt_f32_u32 v142, v142
    v_cvt_f32_u32 v143, v143
    v_mov_b32 v145, s36
    v_fma_f32 v136, s37, v136, v145
    v_fma_f32 v137, s37, v137, v145
    v_fma_f32 v138, s37, v138, v145
    v_fma_f32 v139, s37, v139, v145
    v_fma_f32 v140, s37, v140, v145
    v_fma_f32 v141, s37, v141, v145
    v_fma_f32 v142, s37, v142, v145
    v_fma_f32 v143, s37, v143, v145
    v_cos_f32 v136, v136
    v_cos_f32 v137, v137
    v_cos_f32 v138, v138
    v_cos_f32 v139, v139
    v_cos_f32 v140, v140
    v_cos_f32 v141, v141
    v_cos_f32 v142, v142
    v_cos_f32 v143, v143
    v_cvt_pk_bf16_f32 v148, v136, v137
    v_cvt_pk_bf16_f32 v149, v138, v139
pad0_112:
    s_cbranch_execz ka2_kernel_done
    v_cvt_pk_bf16_f32 v150, v140, v141
    v_cvt_pk_bf16_f32 v151, v142, v143
    s_and_b32 s36, s6, 3
    s_lshl_b32 s36, s36, 10
    v_add_u32 v144, s36, v1
    ds_write_b128 v144, v[148:151] offset:36864
    s_mul_i32 s36, s10, 3
    s_add_u32 s36, s36, s32
    s_lshl_b32 s36, s36, 5
    s_lshl_b32 s37, s11, 2
    s_add_u32 s36, s36, s37
    v_lshrrev_b32 v136, 2, v12
    v_lshlrev_b32 v136, 3, v136
    v_and_b32 v137, 3, v12
    v_add3_u32 v136, v136, v137, s36
    v_cvt_f32_u32 v136, v136
    v_mul_f32 v136, 0xbae38e39, v136
    v_lshlrev_b32 v137, 3, v13
    v_cvt_f32_u32 v137, v137
    v_mul_f32 v137, v136, v137
    v_mov_b32 v138, v137
    v_fmamk_f32 v139, v136, 0x3f800000, v137
    v_fmamk_f32 v140, v136, 0x40000000, v137
    v_fmamk_f32 v141, v136, 0x40400000, v137
    v_cos_f32 v142, v138
    v_sin_f32 v146, v138
    v_cos_f32 v143, v139
    v_sin_f32 v147, v139
    v_cos_f32 v144, v140
    v_sin_f32 v148, v140
    v_cos_f32 v145, v141
    v_sin_f32 v149, v141
    v_cvt_pk_bf16_f32 v64, v142, v143
    v_cvt_pk_bf16_f32 v65, v144, v145
    v_cvt_pk_bf16_f32 v100, v146, v147
    v_cvt_pk_bf16_f32 v101, v148, v149
    v_fmamk_f32 v138, v136, 0x40800000, v137
    v_fmamk_f32 v139, v136, 0x40a00000, v137
    v_fmamk_f32 v140, v136, 0x40c00000, v137
    v_fmamk_f32 v141, v136, 0x40e00000, v137
    v_cos_f32 v142, v138
    v_sin_f32 v146, v138
    v_cos_f32 v143, v139
    v_sin_f32 v147, v139
    v_cos_f32 v144, v140
    v_sin_f32 v148, v140
pad0_113:
    s_cbranch_execz ka2_kernel_done
    v_cos_f32 v145, v141
    v_sin_f32 v149, v141
    v_cvt_pk_bf16_f32 v66, v142, v143
    v_cvt_pk_bf16_f32 v67, v144, v145
    v_cvt_pk_bf16_f32 v102, v146, v147
    v_cvt_pk_bf16_f32 v103, v148, v149
    v_fmamk_f32 v138, v136, 0x42000000, v137
    v_fmamk_f32 v139, v136, 0x42040000, v137
    v_fmamk_f32 v140, v136, 0x42080000, v137
    v_fmamk_f32 v141, v136, 0x420c0000, v137
    v_cos_f32 v142, v138
    v_sin_f32 v146, v138
    v_cos_f32 v143, v139
    v_sin_f32 v147, v139
    v_cos_f32 v144, v140
    v_sin_f32 v148, v140
    v_cos_f32 v145, v141
    v_sin_f32 v149, v141
    v_cvt_pk_bf16_f32 v68, v142, v143
    v_cvt_pk_bf16_f32 v69, v144, v145
    v_cvt_pk_bf16_f32 v104, v146, v147
    v_cvt_pk_bf16_f32 v105, v148, v149
    v_fmamk_f32 v138, v136, 0x42100000, v137
    v_fmamk_f32 v139, v136, 0x42140000, v137
    v_fmamk_f32 v140, v136, 0x42180000, v137
    v_fmamk_f32 v141, v136, 0x421c0000, v137
    v_cos_f32 v142, v138
    v_sin_f32 v146, v138
    v_cos_f32 v143, v139
    v_sin_f32 v147, v139
    v_cos_f32 v144, v140
    v_sin_f32 v148, v140
    v_cos_f32 v145, v141
    v_sin_f32 v149, v141
    v_cvt_pk_bf16_f32 v70, v142, v143
    v_cvt_pk_bf16_f32 v71, v144, v145
    v_cvt_pk_bf16_f32 v106, v146, v147
    v_cvt_pk_bf16_f32 v107, v148, v149
    v_fmamk_f32 v138, v136, 0x42800000, v137
    v_fmamk_f32 v139, v136, 0x42820000, v137
    v_fmamk_f32 v140, v136, 0x42840000, v137
pad0_114:
    s_cbranch_execz ka2_kernel_done
    v_fmamk_f32 v141, v136, 0x42860000, v137
    v_cos_f32 v142, v138
    v_sin_f32 v146, v138
    v_cos_f32 v143, v139
    v_sin_f32 v147, v139
    v_cos_f32 v144, v140
    v_sin_f32 v148, v140
    v_cos_f32 v145, v141
    v_sin_f32 v149, v141
    s_waitcnt vmcnt(21)
    v_mfma_f32_16x16x16_bf16 v[16:19], v[10:11], a[0:1], 0
    v_mfma_f32_16x16x16_bf16 v[20:23], v[10:11], a[2:3], 0
    buffer_load_dwordx4 a[0:3], v3, s[20:23], s43 offen
    v_cvt_pk_bf16_f32 v72, v142, v143
    v_cvt_pk_bf16_f32 v73, v144, v145
    v_cvt_pk_bf16_f32 v108, v146, v147
    v_cvt_pk_bf16_f32 v109, v148, v149
    v_fmamk_f32 v138, v136, 0x42880000, v137
    v_fmamk_f32 v139, v136, 0x428a0000, v137
    s_waitcnt vmcnt(21)
    v_mfma_f32_16x16x16_bf16 v[24:27], v[10:11], a[4:5], 0
    v_mfma_f32_16x16x16_bf16 v[28:31], v[10:11], a[6:7], 0
    buffer_load_dwordx4 a[4:7], v6, s[20:23], s43 offen
    v_fmamk_f32 v140, v136, 0x428c0000, v137
    v_fmamk_f32 v141, v136, 0x428e0000, v137
    v_cos_f32 v142, v138
    v_sin_f32 v146, v138
    v_cos_f32 v143, v139
    v_sin_f32 v147, v139
    s_waitcnt vmcnt(21)
    v_mfma_f32_16x16x16_bf16 v[16:19], v[10:11], a[8:9], v[16:19]
    v_mfma_f32_16x16x16_bf16 v[20:23], v[10:11], a[10:11], v[20:23]
    buffer_load_dwordx4 a[8:11], v3, s[20:23], s44 offen
    v_cos_f32 v144, v140
    v_sin_f32 v148, v140
    v_cos_f32 v145, v141
    v_sin_f32 v149, v141
    v_cvt_pk_bf16_f32 v74, v142, v143
    v_cvt_pk_bf16_f32 v75, v144, v145
    s_waitcnt vmcnt(21)
    v_mfma_f32_16x16x16_bf16 v[24:27], v[10:11], a[12:13], v[24:27]
pad0_115:
    s_cbranch_execz ka2_kernel_done
    v_mfma_f32_16x16x16_bf16 v[28:31], v[10:11], a[14:15], v[28:31]
    buffer_load_dwordx4 a[12:15], v6, s[20:23], s44 offen
    v_cvt_pk_bf16_f32 v110, v146, v147
    v_cvt_pk_bf16_f32 v111, v148, v149
    v_fmamk_f32 v138, v136, 0x42c00000, v137
    v_fmamk_f32 v139, v136, 0x42c20000, v137
    v_fmamk_f32 v140, v136, 0x42c40000, v137
    v_fmamk_f32 v141, v136, 0x42c60000, v137
    s_waitcnt vmcnt(21)
    v_mfma_f32_16x16x16_bf16 v[16:19], v[10:11], a[16:17], v[16:19]
    v_mfma_f32_16x16x16_bf16 v[20:23], v[10:11], a[18:19], v[20:23]
    buffer_load_dwordx4 a[16:19], v3, s[20:23], s45 offen
    v_cos_f32 v142, v138
    v_sin_f32 v146, v138
    v_cos_f32 v143, v139
    v_sin_f32 v147, v139
    v_cos_f32 v144, v140
    v_sin_f32 v148, v140
    s_waitcnt vmcnt(21)
    v_mfma_f32_16x16x16_bf16 v[24:27], v[10:11], a[20:21], v[24:27]
    v_mfma_f32_16x16x16_bf16 v[28:31], v[10:11], a[22:23], v[28:31]
    buffer_load_dwordx4 a[20:23], v6, s[20:23], s45 offen
    v_cos_f32 v145, v141
    v_sin_f32 v149, v141
    v_cvt_pk_bf16_f32 v76, v142, v143
    v_cvt_pk_bf16_f32 v77, v144, v145
    v_cvt_pk_bf16_f32 v112, v146, v147
    v_cvt_pk_bf16_f32 v113, v148, v149
    s_waitcnt vmcnt(21)
    v_mfma_f32_16x16x16_bf16 v[16:19], v[10:11], a[24:25], v[16:19]
    v_mfma_f32_16x16x16_bf16 v[20:23], v[10:11], a[26:27], v[20:23]
    buffer_load_dwordx4 a[24:27], v3, s[20:23], s46 offen
    v_fmamk_f32 v138, v136, 0x42c80000, v137
    v_fmamk_f32 v139, v136, 0x42ca0000, v137
    v_fmamk_f32 v140, v136, 0x42cc0000, v137
    v_fmamk_f32 v141, v136, 0x42ce0000, v137
    v_cos_f32 v142, v138
    v_sin_f32 v146, v138
pad0_116:
    s_cbranch_execz ka2_kernel_done
    s_waitcnt vmcnt(21)
    v_mfma_f32_16x16x16_bf16 v[24:27], v[10:11], a[28:29], v[24:27]
    v_mfma_f32_16x16x16_bf16 v[28:31], v[10:11], a[30:31], v[28:31]
    buffer_load_dwordx4 a[28:31], v6, s[20:23], s46 offen
    v_cos_f32 v143, v139
    v_sin_f32 v147, v139
    v_cos_f32 v144, v140
    v_sin_f32 v148, v140
    v_cos_f32 v145, v141
    v_sin_f32 v149, v141
    s_waitcnt vmcnt(21)
    v_mfma_f32_16x16x16_bf16 v[16:19], v[10:11], a[32:33], v[16:19]
    v_mfma_f32_16x16x16_bf16 v[20:23], v[10:11], a[34:35], v[20:23]
    buffer_load_dwordx4 a[32:35], v3, s[20:23], s47 offen
    v_cvt_pk_bf16_f32 v78, v142, v143
    v_cvt_pk_bf16_f32 v79, v144, v145
    v_cvt_pk_bf16_f32 v114, v146, v147
    v_cvt_pk_bf16_f32 v115, v148, v149
    v_fmamk_f32 v138, v136, 0x43000000, v137
    v_fmamk_f32 v139, v136, 0x43010000, v137
    s_waitcnt vmcnt(21)
    v_mfma_f32_16x16x16_bf16 v[24:27], v[10:11], a[36:37], v[24:27]
    v_mfma_f32_16x16x16_bf16 v[28:31], v[10:11], a[38:39], v[28:31]
    buffer_load_dwordx4 a[36:39], v6, s[20:23], s47 offen
    v_fmamk_f32 v140, v136, 0x43020000, v137
    v_fmamk_f32 v141, v136, 0x43030000, v137
    v_cos_f32 v142, v138
    v_sin_f32 v146, v138
    v_cos_f32 v143, v139
    v_sin_f32 v147, v139
    s_waitcnt vmcnt(21)
    v_mfma_f32_16x16x16_bf16 v[16:19], v[10:11], a[40:41], v[16:19]
    v_mfma_f32_16x16x16_bf16 v[20:23], v[10:11], a[42:43], v[20:23]
    buffer_load_dwordx4 a[40:43], v4, s[20:23], s40 offen
    v_cos_f32 v144, v140
    v_sin_f32 v148, v140
    v_cos_f32 v145, v141
    v_sin_f32 v149, v141
    v_cvt_pk_bf16_f32 v80, v142, v143
    v_cvt_pk_bf16_f32 v81, v144, v145
    s_waitcnt vmcnt(21)
pad0_117:
    s_cbranch_execz ka2_kernel_done
    v_mfma_f32_16x16x16_bf16 v[24:27], v[10:11], a[44:45], v[24:27]
    v_mfma_f32_16x16x16_bf16 v[28:31], v[10:11], a[46:47], v[28:31]
    buffer_load_dwordx4 a[44:47], v7, s[20:23], s40 offen
    v_cvt_pk_bf16_f32 v116, v146, v147
    v_cvt_pk_bf16_f32 v117, v148, v149
    v_fmamk_f32 v138, v136, 0x43040000, v137
    v_fmamk_f32 v139, v136, 0x43050000, v137
    v_fmamk_f32 v140, v136, 0x43060000, v137
    v_fmamk_f32 v141, v136, 0x43070000, v137
    s_waitcnt vmcnt(21)
    v_mfma_f32_16x16x16_bf16 v[16:19], v[10:11], a[48:49], v[16:19]
    v_mfma_f32_16x16x16_bf16 v[20:23], v[10:11], a[50:51], v[20:23]
    buffer_load_dwordx4 a[48:51], v4, s[20:23], s41 offen
    v_cos_f32 v142, v138
    v_sin_f32 v146, v138
    v_cos_f32 v143, v139
    v_sin_f32 v147, v139
    v_cos_f32 v144, v140
    v_sin_f32 v148, v140
    s_waitcnt vmcnt(21)
    v_mfma_f32_16x16x16_bf16 v[24:27], v[10:11], a[52:53], v[24:27]
    v_mfma_f32_16x16x16_bf16 v[28:31], v[10:11], a[54:55], v[28:31]
    buffer_load_dwordx4 a[52:55], v7, s[20:23], s41 offen
    v_cos_f32 v145, v141
    v_sin_f32 v149, v141
    v_cvt_pk_bf16_f32 v82, v142, v143
    v_cvt_pk_bf16_f32 v83, v144, v145
    v_cvt_pk_bf16_f32 v118, v146, v147
    v_cvt_pk_bf16_f32 v119, v148, v149
    s_waitcnt vmcnt(21)
    v_mfma_f32_16x16x16_bf16 v[16:19], v[10:11], a[56:57], v[16:19]
    v_mfma_f32_16x16x16_bf16 v[20:23], v[10:11], a[58:59], v[20:23]
    buffer_load_dwordx4 a[56:59], v4, s[20:23], s42 offen
    v_fmamk_f32 v138, v136, 0x43200000, v137
    v_fmamk_f32 v139, v136, 0x43210000, v137
    v_fmamk_f32 v140, v136, 0x43220000, v137
    v_fmamk_f32 v141, v136, 0x43230000, v137
pad0_118:
    s_cbranch_execz ka2_kernel_done
    v_cos_f32 v142, v138
    v_sin_f32 v146, v138
    s_waitcnt vmcnt(21)
    v_mfma_f32_16x16x16_bf16 v[24:27], v[10:11], a[60:61], v[24:27]
    v_mfma_f32_16x16x16_bf16 v[28:31], v[10:11], a[62:63], v[28:31]
    buffer_load_dwordx4 a[60:63], v7, s[20:23], s42 offen
    v_cos_f32 v143, v139
    v_sin_f32 v147, v139
    v_cos_f32 v144, v140
    v_sin_f32 v148, v140
    v_cos_f32 v145, v141
    v_sin_f32 v149, v141
    s_waitcnt vmcnt(21)
    v_mfma_f32_16x16x16_bf16 v[32:35], v[10:11], a[64:65], 0
    v_mfma_f32_16x16x16_bf16 v[36:39], v[10:11], a[66:67], 0
    buffer_load_dwordx4 a[64:67], v4, s[20:23], s43 offen
    v_cvt_pk_bf16_f32 v84, v142, v143
    v_cvt_pk_bf16_f32 v85, v144, v145
    v_cvt_pk_bf16_f32 v120, v146, v147
    v_cvt_pk_bf16_f32 v121, v148, v149
    v_fmamk_f32 v138, v136, 0x43240000, v137
    v_fmamk_f32 v139, v136, 0x43250000, v137
    s_waitcnt vmcnt(21)
    v_mfma_f32_16x16x16_bf16 v[40:43], v[10:11], a[68:69], 0
    v_mfma_f32_16x16x16_bf16 v[44:47], v[10:11], a[70:71], 0
    buffer_load_dwordx4 a[68:71], v7, s[20:23], s43 offen
    v_fmamk_f32 v140, v136, 0x43260000, v137
    v_fmamk_f32 v141, v136, 0x43270000, v137
    v_cos_f32 v142, v138
    v_sin_f32 v146, v138
    v_cos_f32 v143, v139
    v_sin_f32 v147, v139
    s_waitcnt vmcnt(21)
    v_mfma_f32_16x16x16_bf16 v[32:35], v[10:11], a[72:73], v[32:35]
    v_mfma_f32_16x16x16_bf16 v[36:39], v[10:11], a[74:75], v[36:39]
    buffer_load_dwordx4 a[72:75], v4, s[20:23], s44 offen
    v_cos_f32 v144, v140
    v_sin_f32 v148, v140
    v_cos_f32 v145, v141
    v_sin_f32 v149, v141
    v_cvt_pk_bf16_f32 v86, v142, v143
    v_cvt_pk_bf16_f32 v87, v144, v145
pad0_119:
    s_cbranch_execz ka2_kernel_done
    s_waitcnt vmcnt(21)
    v_mfma_f32_16x16x16_bf16 v[40:43], v[10:11], a[76:77], v[40:43]
    v_mfma_f32_16x16x16_bf16 v[44:47], v[10:11], a[78:79], v[44:47]
    buffer_load_dwordx4 a[76:79], v7, s[20:23], s44 offen
    v_cvt_pk_bf16_f32 v122, v146, v147
    v_cvt_pk_bf16_f32 v123, v148, v149
    v_fmamk_f32 v138, v136, 0x43400000, v137
    v_fmamk_f32 v139, v136, 0x43410000, v137
    v_fmamk_f32 v140, v136, 0x43420000, v137
    v_fmamk_f32 v141, v136, 0x43430000, v137
    s_waitcnt vmcnt(21)
    v_mfma_f32_16x16x16_bf16 v[32:35], v[10:11], a[80:81], v[32:35]
    v_mfma_f32_16x16x16_bf16 v[36:39], v[10:11], a[82:83], v[36:39]
    buffer_load_dwordx4 a[80:83], v4, s[20:23], s45 offen
    v_cos_f32 v142, v138
    v_sin_f32 v146, v138
    v_cos_f32 v143, v139
    v_sin_f32 v147, v139
    v_cos_f32 v144, v140
    v_sin_f32 v148, v140
    s_waitcnt vmcnt(21)
    v_mfma_f32_16x16x16_bf16 v[40:43], v[10:11], a[84:85], v[40:43]
    v_mfma_f32_16x16x16_bf16 v[44:47], v[10:11], a[86:87], v[44:47]
    buffer_load_dwordx4 a[84:87], v7, s[20:23], s45 offen
    v_cos_f32 v145, v141
    v_sin_f32 v149, v141
    v_cvt_pk_bf16_f32 v88, v142, v143
    v_cvt_pk_bf16_f32 v89, v144, v145
    v_cvt_pk_bf16_f32 v124, v146, v147
    v_cvt_pk_bf16_f32 v125, v148, v149
    s_waitcnt vmcnt(21)
    v_mfma_f32_16x16x16_bf16 v[32:35], v[10:11], a[0:1], v[32:35]
    v_mfma_f32_16x16x16_bf16 v[36:39], v[10:11], a[2:3], v[36:39]
    buffer_load_dwordx4 a[0:3], v4, s[20:23], s46 offen
    v_fmamk_f32 v138, v136, 0x43440000, v137
    v_fmamk_f32 v139, v136, 0x43450000, v137
    v_fmamk_f32 v140, v136, 0x43460000, v137
pad0_120:
    s_cbranch_execz ka2_kernel_done
    v_fmamk_f32 v141, v136, 0x43470000, v137
    v_cos_f32 v142, v138
    v_sin_f32 v146, v138
    s_waitcnt vmcnt(21)
    v_mfma_f32_16x16x16_bf16 v[40:43], v[10:11], a[4:5], v[40:43]
    v_mfma_f32_16x16x16_bf16 v[44:47], v[10:11], a[6:7], v[44:47]
    buffer_load_dwordx4 a[4:7], v7, s[20:23], s46 offen
    v_cos_f32 v143, v139
    v_sin_f32 v147, v139
    v_cos_f32 v144, v140
    v_sin_f32 v148, v140
    v_cos_f32 v145, v141
    v_sin_f32 v149, v141
    s_waitcnt vmcnt(21)
    v_mfma_f32_16x16x16_bf16 v[32:35], v[10:11], a[8:9], v[32:35]
    v_mfma_f32_16x16x16_bf16 v[36:39], v[10:11], a[10:11], v[36:39]
    buffer_load_dwordx4 a[8:11], v4, s[20:23], s47 offen
    v_cvt_pk_bf16_f32 v90, v142, v143
    v_cvt_pk_bf16_f32 v91, v144, v145
    v_cvt_pk_bf16_f32 v126, v146, v147
    v_cvt_pk_bf16_f32 v127, v148, v149
    v_fmamk_f32 v138, v136, 0x43600000, v137
    v_fmamk_f32 v139, v136, 0x43610000, v137
    s_waitcnt vmcnt(21)
    v_mfma_f32_16x16x16_bf16 v[40:43], v[10:11], a[12:13], v[40:43]
    v_mfma_f32_16x16x16_bf16 v[44:47], v[10:11], a[14:15], v[44:47]
    buffer_load_dwordx4 a[12:15], v7, s[20:23], s47 offen
    v_fmamk_f32 v140, v136, 0x43620000, v137
    v_fmamk_f32 v141, v136, 0x43630000, v137
    v_cos_f32 v142, v138
    v_sin_f32 v146, v138
    v_cos_f32 v143, v139
    v_sin_f32 v147, v139
    s_waitcnt vmcnt(21)
    v_mfma_f32_16x16x16_bf16 v[32:35], v[10:11], a[16:17], v[32:35]
    v_mfma_f32_16x16x16_bf16 v[36:39], v[10:11], a[18:19], v[36:39]
    v_cos_f32 v144, v140
    v_sin_f32 v148, v140
    v_cos_f32 v145, v141
    v_sin_f32 v149, v141
    v_cvt_pk_bf16_f32 v92, v142, v143
    v_cvt_pk_bf16_f32 v93, v144, v145
pad0_121:
    s_cbranch_execz ka2_kernel_done
    s_waitcnt vmcnt(20)
    v_mfma_f32_16x16x16_bf16 v[40:43], v[10:11], a[20:21], v[40:43]
    v_mfma_f32_16x16x16_bf16 v[44:47], v[10:11], a[22:23], v[44:47]
    v_cvt_pk_bf16_f32 v128, v146, v147
    v_cvt_pk_bf16_f32 v129, v148, v149
    v_fmamk_f32 v138, v136, 0x43640000, v137
    v_fmamk_f32 v139, v136, 0x43650000, v137
    v_fmamk_f32 v140, v136, 0x43660000, v137
    v_fmamk_f32 v141, v136, 0x43670000, v137
    s_waitcnt vmcnt(19)
    v_mfma_f32_16x16x16_bf16 v[32:35], v[10:11], a[24:25], v[32:35]
    v_mfma_f32_16x16x16_bf16 v[36:39], v[10:11], a[26:27], v[36:39]
    v_cos_f32 v142, v138
    v_sin_f32 v146, v138
    v_cos_f32 v143, v139
    v_sin_f32 v147, v139
    v_cos_f32 v144, v140
    v_sin_f32 v148, v140
    s_waitcnt vmcnt(18)
    v_mfma_f32_16x16x16_bf16 v[40:43], v[10:11], a[28:29], v[40:43]
    v_mfma_f32_16x16x16_bf16 v[44:47], v[10:11], a[30:31], v[44:47]
    v_cos_f32 v145, v141
    v_sin_f32 v149, v141
    v_cvt_pk_bf16_f32 v94, v142, v143
    v_cvt_pk_bf16_f32 v95, v144, v145
    v_cvt_pk_bf16_f32 v130, v146, v147
    v_cvt_pk_bf16_f32 v131, v148, v149
    s_waitcnt vmcnt(17)
    v_mfma_f32_16x16x16_bf16 v[32:35], v[10:11], a[32:33], v[32:35]
    v_mfma_f32_16x16x16_bf16 v[36:39], v[10:11], a[34:35], v[36:39]
    v_fmamk_f32 v138, v136, 0x43800000, v137
    v_fmamk_f32 v139, v136, 0x43808000, v137
    v_fmamk_f32 v140, v136, 0x43810000, v137
    v_fmamk_f32 v141, v136, 0x43818000, v137
    v_cos_f32 v142, v138
    v_sin_f32 v146, v138
    s_waitcnt vmcnt(16)
    v_mfma_f32_16x16x16_bf16 v[40:43], v[10:11], a[36:37], v[40:43]
    v_mfma_f32_16x16x16_bf16 v[44:47], v[10:11], a[38:39], v[44:47]
pad0_122:
    s_cbranch_execz ka2_kernel_done
    v_cos_f32 v143, v139
    v_sin_f32 v147, v139
    v_cos_f32 v144, v140
    v_sin_f32 v148, v140
    v_cos_f32 v145, v141
    v_sin_f32 v149, v141
    s_waitcnt vmcnt(15)
    v_mfma_f32_16x16x16_bf16 v[48:51], v[10:11], a[40:41], 0
    v_mfma_f32_16x16x16_bf16 v[52:55], v[10:11], a[42:43], 0
    v_cvt_pk_bf16_f32 v96, v142, v143
    v_cvt_pk_bf16_f32 v97, v144, v145
    v_cvt_pk_bf16_f32 v132, v146, v147
    v_cvt_pk_bf16_f32 v133, v148, v149
    v_fmamk_f32 v138, v136, 0x43820000, v137
    v_fmamk_f32 v139, v136, 0x43828000, v137
    s_waitcnt vmcnt(14)
    v_mfma_f32_16x16x16_bf16 v[56:59], v[10:11], a[44:45], 0
    v_mfma_f32_16x16x16_bf16 v[60:63], v[10:11], a[46:47], 0
    v_fmamk_f32 v140, v136, 0x43830000, v137
    v_fmamk_f32 v141, v136, 0x43838000, v137
    v_cos_f32 v142, v138
    v_sin_f32 v146, v138
    v_cos_f32 v143, v139
    v_sin_f32 v147, v139
    s_waitcnt vmcnt(13)
    v_mfma_f32_16x16x16_bf16 v[48:51], v[10:11], a[48:49], v[48:51]
    v_mfma_f32_16x16x16_bf16 v[52:55], v[10:11], a[50:51], v[52:55]
    v_cos_f32 v144, v140
    v_sin_f32 v148, v140
    v_cos_f32 v145, v141
    v_sin_f32 v149, v141
    v_cvt_pk_bf16_f32 v98, v142, v143
    v_cvt_pk_bf16_f32 v99, v144, v145
    s_waitcnt vmcnt(12)
    v_mfma_f32_16x16x16_bf16 v[56:59], v[10:11], a[52:53], v[56:59]
    v_mfma_f32_16x16x16_bf16 v[60:63], v[10:11], a[54:55], v[60:63]
    v_cvt_pk_bf16_f32 v134, v146, v147
    v_cvt_pk_bf16_f32 v135, v148, v149
    s_waitcnt vmcnt(11)
    v_mfma_f32_16x16x16_bf16 v[48:51], v[10:11], a[56:57], v[48:51]
    v_mfma_f32_16x16x16_bf16 v[52:55], v[10:11], a[58:59], v[52:55]
pad0_123:
    s_cbranch_execz ka2_kernel_done
    s_waitcnt vmcnt(10)
    v_mfma_f32_16x16x16_bf16 v[56:59], v[10:11], a[60:61], v[56:59]
    v_mfma_f32_16x16x16_bf16 v[60:63], v[10:11], a[62:63], v[60:63]
    s_waitcnt vmcnt(9)
    v_mfma_f32_16x16x16_bf16 v[48:51], v[10:11], a[64:65], v[48:51]
    v_mfma_f32_16x16x16_bf16 v[52:55], v[10:11], a[66:67], v[52:55]
    s_waitcnt vmcnt(8)
    v_mfma_f32_16x16x16_bf16 v[56:59], v[10:11], a[68:69], v[56:59]
    v_mfma_f32_16x16x16_bf16 v[60:63], v[10:11], a[70:71], v[60:63]
    s_waitcnt vmcnt(7)
    v_mfma_f32_16x16x16_bf16 v[48:51], v[10:11], a[72:73], v[48:51]
    v_mfma_f32_16x16x16_bf16 v[52:55], v[10:11], a[74:75], v[52:55]
    s_waitcnt vmcnt(6)
    v_mfma_f32_16x16x16_bf16 v[56:59], v[10:11], a[76:77], v[56:59]
    v_mfma_f32_16x16x16_bf16 v[60:63], v[10:11], a[78:79], v[60:63]
    s_waitcnt vmcnt(5)
    v_mfma_f32_16x16x16_bf16 v[48:51], v[10:11], a[80:81], v[48:51]
    v_mfma_f32_16x16x16_bf16 v[52:55], v[10:11], a[82:83], v[52:55]
    s_waitcnt vmcnt(4)
    v_mfma_f32_16x16x16_bf16 v[56:59], v[10:11], a[84:85], v[56:59]
    v_mfma_f32_16x16x16_bf16 v[60:63], v[10:11], a[86:87], v[60:63]
    s_waitcnt vmcnt(3)
    v_mfma_f32_16x16x16_bf16 v[48:51], v[10:11], a[0:1], v[48:51]
    v_mfma_f32_16x16x16_bf16 v[52:55], v[10:11], a[2:3], v[52:55]
    s_waitcnt vmcnt(2)
    v_mfma_f32_16x16x16_bf16 v[56:59], v[10:11], a[4:5], v[56:59]
    v_mfma_f32_16x16x16_bf16 v[60:63], v[10:11], a[6:7], v[60:63]
    s_waitcnt vmcnt(1)
    v_mfma_f32_16x16x16_bf16 v[48:51], v[10:11], a[8:9], v[48:51]
    v_mfma_f32_16x16x16_bf16 v[52:55], v[10:11], a[10:11], v[52:55]
    s_waitcnt vmcnt(0)
    v_mfma_f32_16x16x16_bf16 v[56:59], v[10:11], a[12:13], v[56:59]
    v_mfma_f32_16x16x16_bf16 v[60:63], v[10:11], a[14:15], v[60:63]
    v_pk_add_f32 v[136:137], v[16:17], v[18:19]
    v_pk_mul_f32 v[138:139], v[16:17], v[16:17]
    v_pk_add_f32 v[140:141], v[20:21], v[22:23]
    v_pk_mul_f32 v[142:143], v[18:19], v[18:19]
pad0_124:
    s_cbranch_execz ka2_kernel_done
    v_pk_fma_f32 v[138:139], v[20:21], v[20:21], v[138:139]
    v_pk_fma_f32 v[142:143], v[22:23], v[22:23], v[142:143]
    v_pk_add_f32 v[136:137], v[136:137], v[24:25]
    v_pk_fma_f32 v[138:139], v[24:25], v[24:25], v[138:139]
    v_pk_add_f32 v[140:141], v[140:141], v[26:27]
    v_pk_fma_f32 v[142:143], v[26:27], v[26:27], v[142:143]
    v_pk_add_f32 v[136:137], v[136:137], v[28:29]
    v_pk_fma_f32 v[138:139], v[28:29], v[28:29], v[138:139]
    v_pk_add_f32 v[140:141], v[140:141], v[30:31]
    v_pk_fma_f32 v[142:143], v[30:31], v[30:31], v[142:143]
    v_pk_add_f32 v[136:137], v[136:137], v[32:33]
    v_pk_fma_f32 v[138:139], v[32:33], v[32:33], v[138:139]
    v_pk_add_f32 v[140:141], v[140:141], v[34:35]
    v_pk_fma_f32 v[142:143], v[34:35], v[34:35], v[142:143]
    v_pk_add_f32 v[136:137], v[136:137], v[36:37]
    v_pk_fma_f32 v[138:139], v[36:37], v[36:37], v[138:139]
    v_pk_add_f32 v[140:141], v[140:141], v[38:39]
    v_pk_fma_f32 v[142:143], v[38:39], v[38:39], v[142:143]
    v_pk_add_f32 v[136:137], v[136:137], v[40:41]
    v_pk_fma_f32 v[138:139], v[40:41], v[40:41], v[138:139]
    v_pk_add_f32 v[140:141], v[140:141], v[42:43]
    v_pk_fma_f32 v[142:143], v[42:43], v[42:43], v[142:143]
    v_pk_add_f32 v[136:137], v[136:137], v[44:45]
    v_pk_fma_f32 v[138:139], v[44:45], v[44:45], v[138:139]
    v_pk_add_f32 v[140:141], v[140:141], v[46:47]
    v_pk_fma_f32 v[142:143], v[46:47], v[46:47], v[142:143]
    v_pk_add_f32 v[136:137], v[136:137], v[48:49]
    v_pk_fma_f32 v[138:139], v[48:49], v[48:49], v[138:139]
    v_pk_add_f32 v[140:141], v[140:141], v[50:51]
    v_pk_fma_f32 v[142:143], v[50:51], v[50:51], v[142:143]
    v_pk_add_f32 v[136:137], v[136:137], v[52:53]
pad0_125:
    s_cbranch_execz ka2_kernel_done
    v_pk_fma_f32 v[138:139], v[52:53], v[52:53], v[138:139]
    v_pk_add_f32 v[140:141], v[140:141], v[54:55]
    v_pk_fma_f32 v[142:143], v[54:55], v[54:55], v[142:143]
    v_pk_add_f32 v[136:137], v[136:137], v[56:57]
    v_pk_fma_f32 v[138:139], v[56:57], v[56:57], v[138:139]
    v_pk_add_f32 v[140:141], v[140:141], v[58:59]
    v_pk_fma_f32 v[142:143], v[58:59], v[58:59], v[142:143]
    v_pk_add_f32 v[136:137], v[136:137], v[60:61]
    v_pk_fma_f32 v[138:139], v[60:61], v[60:61], v[138:139]
    v_pk_add_f32 v[140:141], v[140:141], v[62:63]
    v_pk_fma_f32 v[142:143], v[62:63], v[62:63], v[142:143]
    v_pk_add_f32 v[136:137], v[136:137], v[140:141]
    v_pk_add_f32 v[138:139], v[138:139], v[142:143]
    v_add_f32 v136, v136, v137
    v_add_f32 v137, v138, v139
    s_lshl_b32 s36, s11, 9
    s_add_u32 s36, s36, 40960
    v_lshl_add_u32 v8, v12, 5, s36
    v_permlane32_swap_b32 v136, v137
    v_add_f32 v136, v136, v137
    v_mov_b32 v137, v136
    v_lshrrev_b32 v9, 1, v13
    s_lshl_b32 s36, s32, 3
    v_lshl_add_u32 v9, v9, 2, s36
    v_add_u32 v9, v9, v8
    v_permlane16_swap_b32 v136, v137
    v_add_f32 v136, v136, v137
    ds_write_b32 v9, v136
    s_add_u32 s20, s4, 0x1100000
    s_addc_u32 s21, s5, 0
    s_and_b32 s21, s21, 0xffff
    s_mov_b32 s22, 0x240000
    s_mov_b32 s23, 0x20000
ka2_kernel_x1:
    s_cmp_lg_u32 s10, 0
    s_cbranch_scc1 ka2_kernel_x2
    v_cvt_pk_bf16_f32 v152, v16, v17
    v_cvt_pk_bf16_f32 v153, v18, v19
    v_cvt_pk_bf16_f32 v154, v20, v21
    v_cvt_pk_bf16_f32 v155, v22, v23
pad0_126:
    s_cbranch_execz ka2_kernel_done
    v_cvt_pk_bf16_f32 v156, v24, v25
    v_cvt_pk_bf16_f32 v157, v26, v27
    v_cvt_pk_bf16_f32 v158, v28, v29
    v_cvt_pk_bf16_f32 v159, v30, v31
    buffer_store_dwordx4 v[152:155], v2, s[20:23], 0 offen sc1
    buffer_store_dwordx4 v[156:159], v5, s[20:23], 0 offen sc1
    s_branch ka2_kernel_x4
ka2_kernel_x2:
    s_cmp_lg_u32 s10, 1
    s_cbranch_scc1 ka2_kernel_x3
    v_cvt_pk_bf16_f32 v152, v32, v33
    v_cvt_pk_bf16_f32 v153, v34, v35
    v_cvt_pk_bf16_f32 v154, v36, v37
    v_cvt_pk_bf16_f32 v155, v38, v39
    v_cvt_pk_bf16_f32 v156, v40, v41
    v_cvt_pk_bf16_f32 v157, v42, v43
    v_cvt_pk_bf16_f32 v158, v44, v45
    v_cvt_pk_bf16_f32 v159, v46, v47
    buffer_store_dwordx4 v[152:155], v3, s[20:23], 0 offen sc1
    buffer_store_dwordx4 v[156:159], v6, s[20:23], 0 offen sc1
    s_branch ka2_kernel_x4
ka2_kernel_x3:
    v_cvt_pk_bf16_f32 v152, v48, v49
    v_cvt_pk_bf16_f32 v153, v50, v51
    v_cvt_pk_bf16_f32 v154, v52, v53
    v_cvt_pk_bf16_f32 v155, v54, v55
    v_cvt_pk_bf16_f32 v156, v56, v57
    v_cvt_pk_bf16_f32 v157, v58, v59
    v_cvt_pk_bf16_f32 v158, v60, v61
    v_cvt_pk_bf16_f32 v159, v62, v63
    buffer_store_dwordx4 v[152:155], v4, s[20:23], 0 offen sc1
    buffer_store_dwordx4 v[156:159], v7, s[20:23], 0 offen sc1
ka2_kernel_x4:
    s_waitcnt lgkmcnt(0)
    s_barrier
    ds_read_b128 v[136:139], v8
    ds_read_b64 v[148:149], v8 offset:16
pad0_127:
    s_cbranch_execz ka2_kernel_done
    s_lshl_b32 s36, s11, 6
    s_add_u32 s36, s36, 41984
    v_lshl_add_u32 v15, v12, 2, s36
    s_mul_i32 s36, s32, 6144
    s_lshl_b32 s37, s11, 10
    s_add_u32 s36, s36, s37
    v_add_u32 v9, s36, v1
    s_cmp_eq_u32 s32, 0
    s_cselect_b32 s36, 0xffff, 0
    s_mov_b32 s37, 0
    s_waitcnt lgkmcnt(0)
    v_pk_add_f32 v[136:137], v[136:137], v[138:139]
    v_pk_add_f32 v[136:137], v[136:137], v[148:149]
    v_mul_f32 v136, 0x3ae38e39, v136
    v_mul_f32 v137, 0x3ae38e39, v137
    v_fma_f32 v137, -v136, v136, v137
    v_max_f32 v137, 0, v137
    v_cvt_pk_bf16_f32 v138, v136, v137
    v_lshlrev_b32 v136, 16, v138
    v_and_b32 v137, 0xffff0000, v138
    v_add_f32 v137, 0x3727c5ac, v137
    v_cvt_pk_bf16_f32 v138, v137, v137
    v_and_b32 v137, 0xffff0000, v138
    v_sqrt_f32 v137, v137
    s_nop 0
    v_cvt_pk_bf16_f32 v138, v137, v137
    v_and_b32 v137, 0xffff0000, v138
    v_rcp_f32 v148, v137
    v_mov_b32 v150, v136
    v_mul_f32 v149, -v136, v148
    v_fma_f32 v136, v24, v148, v149
    v_cndmask_b32 v24, v24, v150, s[36:37]
    s_cmp_lg_u32 s32, 0
    s_cbranch_scc1 ka2_kernel_k5
    s_mov_b64 exec, 0xffff
    ds_write_b32 v15, v136
    s_mov_b64 exec, -1
ka2_kernel_k5:
    v_add_f32 v149, v149, v149
    v_pk_add_f32 v[164:165], v[16:17], v[24:25]
    v_pk_add_f32 v[166:167], v[24:25], v[16:17] neg_lo:[0,1] neg_hi:[0,1]
pad0_128:
    s_cbranch_execz ka2_kernel_done
    v_pk_fma_f32 v[164:165], v[164:165], v[148:149], v[148:149] op_sel:[0,0,1] op_sel_hi:[1,0,1]
    v_pk_mul_f32 v[166:167], v[166:167], v[148:149] op_sel_hi:[1,0]
    v_cvt_pk_bf16_f32 v136, v164, v165
    v_cvt_pk_bf16_f32 v152, v166, v167
    v_pk_add_f32 v[144:145], v[18:19], v[26:27]
    v_pk_add_f32 v[146:147], v[26:27], v[18:19] neg_lo:[0,1] neg_hi:[0,1]
    v_pk_fma_f32 v[144:145], v[144:145], v[148:149], v[148:149] op_sel:[0,0,1] op_sel_hi:[1,0,1]
    v_pk_mul_f32 v[146:147], v[146:147], v[148:149] op_sel_hi:[1,0]
    v_cvt_pk_bf16_f32 v137, v144, v145
    v_cvt_pk_bf16_f32 v153, v146, v147
    v_pk_add_f32 v[164:165], v[20:21], v[28:29]
    v_pk_add_f32 v[166:167], v[28:29], v[20:21] neg_lo:[0,1] neg_hi:[0,1]
    v_pk_fma_f32 v[164:165], v[164:165], v[148:149], v[148:149] op_sel:[0,0,1] op_sel_hi:[1,0,1]
    v_pk_mul_f32 v[166:167], v[166:167], v[148:149] op_sel_hi:[1,0]
    v_cvt_pk_bf16_f32 v138, v164, v165
    v_cvt_pk_bf16_f32 v154, v166, v167
    v_pk_add_f32 v[144:145], v[22:23], v[30:31]
    v_pk_add_f32 v[146:147], v[30:31], v[22:23] neg_lo:[0,1] neg_hi:[0,1]
    v_pk_fma_f32 v[144:145], v[144:145], v[148:149], v[148:149] op_sel:[0,0,1] op_sel_hi:[1,0,1]
    v_pk_mul_f32 v[146:147], v[146:147], v[148:149] op_sel_hi:[1,0]
    v_cvt_pk_bf16_f32 v139, v144, v145
    v_cvt_pk_bf16_f32 v155, v146, v147
    ds_write_b128 v9, v[136:139] offset:0
    ds_write_b128 v9, v[152:155] offset:18432
    v_pk_add_f32 v[164:165], v[32:33], v[40:41]
    v_pk_add_f32 v[166:167], v[40:41], v[32:33] neg_lo:[0,1] neg_hi:[0,1]
    v_pk_fma_f32 v[164:165], v[164:165], v[148:149], v[148:149] op_sel:[0,0,1] op_sel_hi:[1,0,1]
    v_pk_mul_f32 v[166:167], v[166:167], v[148:149] op_sel_hi:[1,0]
    v_cvt_pk_bf16_f32 v140, v164, v165
    v_cvt_pk_bf16_f32 v156, v166, v167
    v_pk_add_f32 v[144:145], v[34:35], v[42:43]
    v_pk_add_f32 v[146:147], v[42:43], v[34:35] neg_lo:[0,1] neg_hi:[0,1]
pad0_129:
    s_cbranch_execz ka2_kernel_done
    v_pk_fma_f32 v[144:145], v[144:145], v[148:149], v[148:149] op_sel:[0,0,1] op_sel_hi:[1,0,1]
    v_pk_mul_f32 v[146:147], v[146:147], v[148:149] op_sel_hi:[1,0]
    v_cvt_pk_bf16_f32 v141, v144, v145
    v_cvt_pk_bf16_f32 v157, v146, v147
    v_pk_add_f32 v[164:165], v[36:37], v[44:45]
    v_pk_add_f32 v[166:167], v[44:45], v[36:37] neg_lo:[0,1] neg_hi:[0,1]
    v_pk_fma_f32 v[164:165], v[164:165], v[148:149], v[148:149] op_sel:[0,0,1] op_sel_hi:[1,0,1]
    v_pk_mul_f32 v[166:167], v[166:167], v[148:149] op_sel_hi:[1,0]
    v_cvt_pk_bf16_f32 v142, v164, v165
    v_cvt_pk_bf16_f32 v158, v166, v167
    v_pk_add_f32 v[144:145], v[38:39], v[46:47]
    v_pk_add_f32 v[146:147], v[46:47], v[38:39] neg_lo:[0,1] neg_hi:[0,1]
    v_pk_fma_f32 v[144:145], v[144:145], v[148:149], v[148:149] op_sel:[0,0,1] op_sel_hi:[1,0,1]
    v_pk_mul_f32 v[146:147], v[146:147], v[148:149] op_sel_hi:[1,0]
    v_cvt_pk_bf16_f32 v143, v144, v145
    v_cvt_pk_bf16_f32 v159, v146, v147
    ds_write_b128 v9, v[140:143] offset:2048
    ds_write_b128 v9, v[156:159] offset:20480
    v_pk_add_f32 v[164:165], v[48:49], v[56:57]
    v_pk_add_f32 v[166:167], v[56:57], v[48:49] neg_lo:[0,1] neg_hi:[0,1]
    v_pk_fma_f32 v[164:165], v[164:165], v[148:149], v[148:149] op_sel:[0,0,1] op_sel_hi:[1,0,1]
    v_pk_mul_f32 v[166:167], v[166:167], v[148:149] op_sel_hi:[1,0]
    v_cvt_pk_bf16_f32 v136, v164, v165
    v_cvt_pk_bf16_f32 v160, v166, v167
    v_pk_add_f32 v[144:145], v[50:51], v[58:59]
    v_pk_add_f32 v[146:147], v[58:59], v[50:51] neg_lo:[0,1] neg_hi:[0,1]
    v_pk_fma_f32 v[144:145], v[144:145], v[148:149], v[148:149] op_sel:[0,0,1] op_sel_hi:[1,0,1]
    v_pk_mul_f32 v[146:147], v[146:147], v[148:149] op_sel_hi:[1,0]
    v_cvt_pk_bf16_f32 v137, v144, v145
    v_cvt_pk_bf16_f32 v161, v146, v147
    v_pk_add_f32 v[164:165], v[52:53], v[60:61]
pad0_130:
    s_cbranch_execz ka2_kernel_done
    v_pk_add_f32 v[166:167], v[60:61], v[52:53] neg_lo:[0,1] neg_hi:[0,1]
    v_pk_fma_f32 v[164:165], v[164:165], v[148:149], v[148:149] op_sel:[0,0,1] op_sel_hi:[1,0,1]
    v_pk_mul_f32 v[166:167], v[166:167], v[148:149] op_sel_hi:[1,0]
    v_cvt_pk_bf16_f32 v138, v164, v165
    v_cvt_pk_bf16_f32 v162, v166, v167
    v_pk_add_f32 v[144:145], v[54:55], v[62:63]
    v_pk_add_f32 v[146:147], v[62:63], v[54:55] neg_lo:[0,1] neg_hi:[0,1]
    v_pk_fma_f32 v[144:145], v[144:145], v[148:149], v[148:149] op_sel:[0,0,1] op_sel_hi:[1,0,1]
    v_pk_mul_f32 v[146:147], v[146:147], v[148:149] op_sel_hi:[1,0]
    v_cvt_pk_bf16_f32 v139, v144, v145
    v_cvt_pk_bf16_f32 v163, v146, v147
    ds_write_b128 v9, v[136:139] offset:4096
    ds_write_b128 v9, v[160:163] offset:22528
    s_add_u32 s20, s4, 0xb00000
    s_addc_u32 s21, s5, 0
    s_and_b32 s21, s21, 0xffff
    s_mov_b32 s22, 0x480000
    s_mov_b32 s23, 0x20000
    s_mul_i32 s38, s10, 3
    s_add_u32 s38, s38, s32
    s_lshl_b32 s38, s38, 1
    s_add_u32 s38, s38, s11
    s_lshl_b32 s38, s38, 12
    s_lshr_b32 s39, s9, 2
    s_lshl_b32 s39, s39, 8
    s_add_u32 s38, s38, s39
    s_and_b32 s39, s9, 3
    s_lshl_b32 s39, s39, 2
    s_add_u32 s38, s38, s39
    s_mov_b32 s39, 589824
    v_lshl_add_u32 v2, v12, 4, s38
    v_mad_u32_u24 v2, v13, s39, v2
    v_add_u32 v3, 73728, v2
    s_mov_b32 s40, 0
    s_mov_b32 s41, 147456
    s_mov_b32 s42, 294912
    s_mov_b32 s43, 442368
    s_mov_b32 s44, 2359296
pad0_131:
    s_cbranch_execz ka2_kernel_done
    s_mov_b32 s45, 2506752
    s_mov_b32 s46, 2654208
    s_mov_b32 s47, 2801664
    v_lshlrev_b32 v8, 4, v13
    v_lshlrev_b32 v9, 31, v12
    s_waitcnt lgkmcnt(0)
    s_barrier
    ds_read_b128 v[16:19], v8 offset:41984
    ds_read_b128 v[20:23], v8 offset:42048
    ds_read_b128 v[136:139], v1 offset:0
    ds_read_b128 v[140:143], v1 offset:18432
    ds_read_b128 v[144:147], v1 offset:1024
    ds_read_b128 v[148:151], v1 offset:19456
    ds_read_b128 v[152:155], v1 offset:2048
    ds_read_b128 v[156:159], v1 offset:20480
    ds_read_b128 v[160:163], v1 offset:3072
    ds_read_b128 v[164:167], v1 offset:21504
    ds_read_b128 v[44:47], v1 offset:36864
    ds_read_b128 v[48:51], v1 offset:37888
    ds_read_b128 v[52:55], v1 offset:38912
    ds_read_b128 v[56:59], v1 offset:39936
    s_or_b32 s38, s10, s6
    s_cmp_eq_u32 s38, 0
    s_cbranch_scc1 ka2_kernel_sp6
    s_waitcnt lgkmcnt(12)
    v_xor_b32 v16, v9, v16
    v_xor_b32 v17, v9, v17
    v_xor_b32 v18, v9, v18
    v_xor_b32 v19, v9, v19
    v_xor_b32 v20, v9, v20
    v_xor_b32 v21, v9, v21
    v_xor_b32 v22, v9, v22
    v_xor_b32 v23, v9, v23
    s_waitcnt lgkmcnt(11)
    v_mfma_f32_16x16x32_bf16 v[16:19], v[136:139], v[64:67], v[16:19]
    ds_read_b128 v[136:139], v1 offset:4096
    s_waitcnt lgkmcnt(11)
    v_mfma_f32_16x16x32_bf16 v[24:27], v[140:143], v[100:103], 0
    ds_read_b128 v[140:143], v1 offset:22528
    s_waitcnt lgkmcnt(11)
    v_mfma_f32_16x16x32_bf16 v[20:23], v[144:147], v[64:67], v[20:23]
pad0_132:
    s_cbranch_execz ka2_kernel_done
    ds_read_b128 v[144:147], v1 offset:5120
    s_waitcnt lgkmcnt(11)
    v_mfma_f32_16x16x32_bf16 v[28:31], v[148:151], v[100:103], 0
    ds_read_b128 v[148:151], v1 offset:23552
    s_waitcnt lgkmcnt(11)
    v_mfma_f32_16x16x32_bf16 v[16:19], v[152:155], v[68:71], v[16:19]
    ds_read_b128 v[152:155], v1 offset:6144
    s_waitcnt lgkmcnt(11)
    v_mfma_f32_16x16x32_bf16 v[24:27], v[156:159], v[104:107], v[24:27]
    ds_read_b128 v[156:159], v1 offset:24576
    s_waitcnt lgkmcnt(11)
    v_mfma_f32_16x16x32_bf16 v[20:23], v[160:163], v[68:71], v[20:23]
    ds_read_b128 v[160:163], v1 offset:7168
    s_waitcnt lgkmcnt(11)
    v_mfma_f32_16x16x32_bf16 v[28:31], v[164:167], v[104:107], v[28:31]
    ds_read_b128 v[164:167], v1 offset:25600
    s_waitcnt lgkmcnt(7)
    v_mfma_f32_16x16x32_bf16 v[16:19], v[136:139], v[72:75], v[16:19]
    ds_read_b128 v[136:139], v1 offset:8192
    s_waitcnt lgkmcnt(7)
    v_mfma_f32_16x16x32_bf16 v[24:27], v[140:143], v[108:111], v[24:27]
    ds_read_b128 v[140:143], v1 offset:26624
    s_waitcnt lgkmcnt(7)
    v_mfma_f32_16x16x32_bf16 v[20:23], v[144:147], v[72:75], v[20:23]
    ds_read_b128 v[144:147], v1 offset:9216
    s_waitcnt lgkmcnt(7)
    v_mfma_f32_16x16x32_bf16 v[28:31], v[148:151], v[108:111], v[28:31]
    ds_read_b128 v[148:151], v1 offset:27648
    s_waitcnt lgkmcnt(7)
    v_mfma_f32_16x16x32_bf16 v[16:19], v[152:155], v[76:79], v[16:19]
    ds_read_b128 v[152:155], v1 offset:10240
    s_waitcnt lgkmcnt(7)
    v_mfma_f32_16x16x32_bf16 v[24:27], v[156:159], v[112:115], v[24:27]
    ds_read_b128 v[156:159], v1 offset:28672
    s_waitcnt lgkmcnt(7)
    v_mfma_f32_16x16x32_bf16 v[20:23], v[160:163], v[76:79], v[20:23]
    ds_read_b128 v[160:163], v1 offset:11264
    s_waitcnt lgkmcnt(7)
pad0_133:
    s_cbranch_execz ka2_kernel_done
    v_mfma_f32_16x16x32_bf16 v[28:31], v[164:167], v[112:115], v[28:31]
    ds_read_b128 v[164:167], v1 offset:29696
    s_waitcnt lgkmcnt(7)
    v_mfma_f32_16x16x32_bf16 v[16:19], v[136:139], v[80:83], v[16:19]
    ds_read_b128 v[136:139], v1 offset:12288
    s_waitcnt lgkmcnt(7)
    v_mfma_f32_16x16x32_bf16 v[24:27], v[140:143], v[116:119], v[24:27]
    ds_read_b128 v[140:143], v1 offset:30720
    s_waitcnt lgkmcnt(7)
    v_mfma_f32_16x16x32_bf16 v[20:23], v[144:147], v[80:83], v[20:23]
    ds_read_b128 v[144:147], v1 offset:13312
    s_waitcnt lgkmcnt(7)
    v_mfma_f32_16x16x32_bf16 v[28:31], v[148:151], v[116:119], v[28:31]
    ds_read_b128 v[148:151], v1 offset:31744
    s_waitcnt lgkmcnt(7)
    v_mfma_f32_16x16x32_bf16 v[16:19], v[152:155], v[84:87], v[16:19]
    ds_read_b128 v[152:155], v1 offset:14336
    s_waitcnt lgkmcnt(7)
    v_mfma_f32_16x16x32_bf16 v[24:27], v[156:159], v[120:123], v[24:27]
    ds_read_b128 v[156:159], v1 offset:32768
    s_waitcnt lgkmcnt(7)
    v_mfma_f32_16x16x32_bf16 v[20:23], v[160:163], v[84:87], v[20:23]
    ds_read_b128 v[160:163], v1 offset:15360
    s_waitcnt lgkmcnt(7)
    v_mfma_f32_16x16x32_bf16 v[28:31], v[164:167], v[120:123], v[28:31]
    ds_read_b128 v[164:167], v1 offset:33792
    s_waitcnt lgkmcnt(7)
    v_mfma_f32_16x16x32_bf16 v[16:19], v[136:139], v[88:91], v[16:19]
    ds_read_b128 v[136:139], v1 offset:16384
    s_waitcnt lgkmcnt(7)
    v_mfma_f32_16x16x32_bf16 v[24:27], v[140:143], v[124:127], v[24:27]
    ds_read_b128 v[140:143], v1 offset:34816
    s_waitcnt lgkmcnt(7)
    v_mfma_f32_16x16x32_bf16 v[20:23], v[144:147], v[88:91], v[20:23]
    ds_read_b128 v[144:147], v1 offset:17408
    s_waitcnt lgkmcnt(7)
    v_mfma_f32_16x16x32_bf16 v[28:31], v[148:151], v[124:127], v[28:31]
    ds_read_b128 v[148:151], v1 offset:35840
pad0_134:
    s_cbranch_execz ka2_kernel_done
    s_waitcnt lgkmcnt(7)
    v_mfma_f32_16x16x32_bf16 v[16:19], v[152:155], v[92:95], v[16:19]
    s_waitcnt lgkmcnt(6)
    v_mfma_f32_16x16x32_bf16 v[24:27], v[156:159], v[128:131], v[24:27]
    s_waitcnt lgkmcnt(5)
    v_mfma_f32_16x16x32_bf16 v[20:23], v[160:163], v[92:95], v[20:23]
    s_waitcnt lgkmcnt(4)
    v_mfma_f32_16x16x32_bf16 v[28:31], v[164:167], v[128:131], v[28:31]
    s_waitcnt lgkmcnt(3)
    v_mfma_f32_16x16x32_bf16 v[16:19], v[136:139], v[96:99], v[16:19]
    s_waitcnt lgkmcnt(2)
    v_mfma_f32_16x16x32_bf16 v[24:27], v[140:143], v[132:135], v[24:27]
    s_waitcnt lgkmcnt(1)
    v_mfma_f32_16x16x32_bf16 v[20:23], v[144:147], v[96:99], v[20:23]
    s_waitcnt lgkmcnt(0)
    v_mfma_f32_16x16x32_bf16 v[28:31], v[148:151], v[132:135], v[28:31]
    s_nop 1
    v_cvt_pk_bf16_f32 v36, v16, v17
    v_cvt_pk_bf16_f32 v37, v18, v19
    s_nop 1
    v_cvt_pk_bf16_f32 v38, v20, v21
    v_cvt_pk_bf16_f32 v39, v22, v23
    v_cvt_pk_bf16_f32 v40, v24, v25
    v_cvt_pk_bf16_f32 v41, v26, v27
    v_cvt_pk_bf16_f32 v42, v28, v29
    v_cvt_pk_bf16_f32 v43, v30, v31
    v_mfma_f32_16x16x32_bf16 v[64:67], v[44:47], v[36:39], 0
    v_mfma_f32_16x16x32_bf16 v[68:71], v[52:55], v[36:39], 0
    v_mfma_f32_16x16x32_bf16 v[72:75], v[52:55], v[40:43], 0
    v_mfma_f32_16x16x32_bf16 v[76:79], v[44:47], v[40:43], 0
    v_mfma_f32_16x16x32_bf16 v[80:83], v[48:51], v[36:39], 0
    v_mfma_f32_16x16x32_bf16 v[84:87], v[56:59], v[36:39], 0
    v_mfma_f32_16x16x32_bf16 v[88:91], v[56:59], v[40:43], 0
    v_mfma_f32_16x16x32_bf16 v[92:95], v[48:51], v[40:43], 0
    s_nop 2
    v_sub_f32 v96, v64, v72
    v_add_f32 v97, v68, v76
    v_add_f32 v98, v64, v72
pad0_135:
    s_cbranch_execz ka2_kernel_done
    v_sub_f32 v99, v68, v76
    v_cvt_pk_bf16_f32 v100, v96, v97
    v_cvt_pk_bf16_f32 v101, v98, v99
    buffer_store_dword v100, v2, s[20:23], s40 offen
    buffer_store_dword v101, v3, s[20:23], s40 offen
    v_sub_f32 v102, v65, v73
    v_add_f32 v103, v69, v77
    v_add_f32 v104, v65, v73
    v_sub_f32 v105, v69, v77
    v_cvt_pk_bf16_f32 v106, v102, v103
    v_cvt_pk_bf16_f32 v107, v104, v105
    buffer_store_dword v106, v2, s[20:23], s41 offen
    buffer_store_dword v107, v3, s[20:23], s41 offen
    v_sub_f32 v108, v66, v74
    v_add_f32 v109, v70, v78
    v_add_f32 v110, v66, v74
    v_sub_f32 v111, v70, v78
    v_cvt_pk_bf16_f32 v112, v108, v109
    v_cvt_pk_bf16_f32 v113, v110, v111
    buffer_store_dword v112, v2, s[20:23], s42 offen
    buffer_store_dword v113, v3, s[20:23], s42 offen
    v_sub_f32 v114, v67, v75
    v_add_f32 v115, v71, v79
    v_add_f32 v116, v67, v75
    v_sub_f32 v117, v71, v79
    v_cvt_pk_bf16_f32 v118, v114, v115
    v_cvt_pk_bf16_f32 v119, v116, v117
    buffer_store_dword v118, v2, s[20:23], s43 offen
    buffer_store_dword v119, v3, s[20:23], s43 offen
    v_sub_f32 v96, v80, v88
    v_add_f32 v97, v84, v92
    v_add_f32 v98, v80, v88
    v_sub_f32 v99, v84, v92
    v_cvt_pk_bf16_f32 v100, v96, v97
    v_cvt_pk_bf16_f32 v101, v98, v99
    s_mov_b64 exec, 0xffff
    buffer_store_dword v100, v2, s[20:23], s44 offen
    buffer_store_dword v101, v3, s[20:23], s44 offen
    s_mov_b64 exec, -1
    s_endpgm
ka2_kernel_sp6:
    s_mov_b32 s36, 0x00010001
pad0_136:
    s_cbranch_execz ka2_kernel_done
    s_mov_b32 s37, s36
    v_mov_b32 v33, 0xbf803f80
    v_cndmask_b32 v32, 0, v33, s[36:37]
    v_mov_b32 v33, v32
    v_mov_b32 v34, v32
    v_mov_b32 v35, v32
    s_waitcnt lgkmcnt(12)
    v_cndmask_b32 v24, 0, v16, s[36:37]
    v_xor_b32 v16, v9, v16
    v_cndmask_b32 v25, 0, v17, s[36:37]
    v_xor_b32 v17, v9, v17
    v_cndmask_b32 v26, 0, v18, s[36:37]
    v_xor_b32 v18, v9, v18
    v_cndmask_b32 v27, 0, v19, s[36:37]
    v_xor_b32 v19, v9, v19
    v_cndmask_b32 v28, 0, v20, s[36:37]
    v_xor_b32 v20, v9, v20
    v_cndmask_b32 v29, 0, v21, s[36:37]
    v_xor_b32 v21, v9, v21
    v_cndmask_b32 v30, 0, v22, s[36:37]
    v_xor_b32 v22, v9, v22
    v_cndmask_b32 v31, 0, v23, s[36:37]
    v_xor_b32 v23, v9, v23
    s_waitcnt lgkmcnt(11)
    v_mfma_f32_16x16x32_bf16 v[16:19], v[136:139], v[64:67], v[16:19]
    v_mfma_f32_16x16x32_bf16 v[24:27], v[136:139], v[32:35], v[24:27]
    ds_read_b128 v[136:139], v1 offset:4096
    s_waitcnt lgkmcnt(11)
    v_mfma_f32_16x16x32_bf16 v[24:27], v[140:143], v[100:103], v[24:27]
    ds_read_b128 v[140:143], v1 offset:22528
    s_waitcnt lgkmcnt(11)
    v_mfma_f32_16x16x32_bf16 v[20:23], v[144:147], v[64:67], v[20:23]
    v_mfma_f32_16x16x32_bf16 v[28:31], v[144:147], v[32:35], v[28:31]
    ds_read_b128 v[144:147], v1 offset:5120
    s_waitcnt lgkmcnt(11)
    v_mfma_f32_16x16x32_bf16 v[28:31], v[148:151], v[100:103], v[28:31]
    ds_read_b128 v[148:151], v1 offset:23552
    s_waitcnt lgkmcnt(11)
    v_mfma_f32_16x16x32_bf16 v[16:19], v[152:155], v[68:71], v[16:19]
    v_mfma_f32_16x16x32_bf16 v[24:27], v[152:155], v[32:35], v[24:27]
    ds_read_b128 v[152:155], v1 offset:6144
pad0_137:
    s_cbranch_execz ka2_kernel_done
    s_waitcnt lgkmcnt(11)
    v_mfma_f32_16x16x32_bf16 v[24:27], v[156:159], v[104:107], v[24:27]
    ds_read_b128 v[156:159], v1 offset:24576
    s_waitcnt lgkmcnt(11)
    v_mfma_f32_16x16x32_bf16 v[20:23], v[160:163], v[68:71], v[20:23]
    v_mfma_f32_16x16x32_bf16 v[28:31], v[160:163], v[32:35], v[28:31]
    ds_read_b128 v[160:163], v1 offset:7168
    s_waitcnt lgkmcnt(11)
    v_mfma_f32_16x16x32_bf16 v[28:31], v[164:167], v[104:107], v[28:31]
    ds_read_b128 v[164:167], v1 offset:25600
    s_waitcnt lgkmcnt(7)
    v_mfma_f32_16x16x32_bf16 v[16:19], v[136:139], v[72:75], v[16:19]
    v_mfma_f32_16x16x32_bf16 v[24:27], v[136:139], v[32:35], v[24:27]
    ds_read_b128 v[136:139], v1 offset:8192
    s_waitcnt lgkmcnt(7)
    v_mfma_f32_16x16x32_bf16 v[24:27], v[140:143], v[108:111], v[24:27]
    ds_read_b128 v[140:143], v1 offset:26624
    s_waitcnt lgkmcnt(7)
    v_mfma_f32_16x16x32_bf16 v[20:23], v[144:147], v[72:75], v[20:23]
    v_mfma_f32_16x16x32_bf16 v[28:31], v[144:147], v[32:35], v[28:31]
    ds_read_b128 v[144:147], v1 offset:9216
    s_waitcnt lgkmcnt(7)
    v_mfma_f32_16x16x32_bf16 v[28:31], v[148:151], v[108:111], v[28:31]
    ds_read_b128 v[148:151], v1 offset:27648
    s_waitcnt lgkmcnt(7)
    v_mfma_f32_16x16x32_bf16 v[16:19], v[152:155], v[76:79], v[16:19]
    v_mfma_f32_16x16x32_bf16 v[24:27], v[152:155], v[32:35], v[24:27]
    ds_read_b128 v[152:155], v1 offset:10240
    s_waitcnt lgkmcnt(7)
    v_mfma_f32_16x16x32_bf16 v[24:27], v[156:159], v[112:115], v[24:27]
    ds_read_b128 v[156:159], v1 offset:28672
    s_waitcnt lgkmcnt(7)
    v_mfma_f32_16x16x32_bf16 v[20:23], v[160:163], v[76:79], v[20:23]
    v_mfma_f32_16x16x32_bf16 v[28:31], v[160:163], v[32:35], v[28:31]
    ds_read_b128 v[160:163], v1 offset:11264
    s_waitcnt lgkmcnt(7)
    v_mfma_f32_16x16x32_bf16 v[28:31], v[164:167], v[112:115], v[28:31]
pad0_138:
    s_cbranch_execz ka2_kernel_done
    ds_read_b128 v[164:167], v1 offset:29696
    s_waitcnt lgkmcnt(7)
    v_mfma_f32_16x16x32_bf16 v[16:19], v[136:139], v[80:83], v[16:19]
    v_mfma_f32_16x16x32_bf16 v[24:27], v[136:139], v[32:35], v[24:27]
    ds_read_b128 v[136:139], v1 offset:12288
    s_waitcnt lgkmcnt(7)
    v_mfma_f32_16x16x32_bf16 v[24:27], v[140:143], v[116:119], v[24:27]
    ds_read_b128 v[140:143], v1 offset:30720
    s_waitcnt lgkmcnt(7)
    v_mfma_f32_16x16x32_bf16 v[20:23], v[144:147], v[80:83], v[20:23]
    v_mfma_f32_16x16x32_bf16 v[28:31], v[144:147], v[32:35], v[28:31]
    ds_read_b128 v[144:147], v1 offset:13312
    s_waitcnt lgkmcnt(7)
    v_mfma_f32_16x16x32_bf16 v[28:31], v[148:151], v[116:119], v[28:31]
    ds_read_b128 v[148:151], v1 offset:31744
    s_waitcnt lgkmcnt(7)
    v_mfma_f32_16x16x32_bf16 v[16:19], v[152:155], v[84:87], v[16:19]
    v_mfma_f32_16x16x32_bf16 v[24:27], v[152:155], v[32:35], v[24:27]
    ds_read_b128 v[152:155], v1 offset:14336
    s_waitcnt lgkmcnt(7)
    v_mfma_f32_16x16x32_bf16 v[24:27], v[156:159], v[120:123], v[24:27]
    ds_read_b128 v[156:159], v1 offset:32768
    s_waitcnt lgkmcnt(7)
    v_mfma_f32_16x16x32_bf16 v[20:23], v[160:163], v[84:87], v[20:23]
    v_mfma_f32_16x16x32_bf16 v[28:31], v[160:163], v[32:35], v[28:31]
    ds_read_b128 v[160:163], v1 offset:15360
    s_waitcnt lgkmcnt(7)
    v_mfma_f32_16x16x32_bf16 v[28:31], v[164:167], v[120:123], v[28:31]
    ds_read_b128 v[164:167], v1 offset:33792
    s_waitcnt lgkmcnt(7)
    v_mfma_f32_16x16x32_bf16 v[16:19], v[136:139], v[88:91], v[16:19]
    v_mfma_f32_16x16x32_bf16 v[24:27], v[136:139], v[32:35], v[24:27]
    ds_read_b128 v[136:139], v1 offset:16384
    s_waitcnt lgkmcnt(7)
    v_mfma_f32_16x16x32_bf16 v[24:27], v[140:143], v[124:127], v[24:27]
    ds_read_b128 v[140:143], v1 offset:34816
pad0_139:
    s_cbranch_execz ka2_kernel_done
    s_waitcnt lgkmcnt(7)
    v_mfma_f32_16x16x32_bf16 v[20:23], v[144:147], v[88:91], v[20:23]
    v_mfma_f32_16x16x32_bf16 v[28:31], v[144:147], v[32:35], v[28:31]
    ds_read_b128 v[144:147], v1 offset:17408
    s_waitcnt lgkmcnt(7)
    v_mfma_f32_16x16x32_bf16 v[28:31], v[148:151], v[124:127], v[28:31]
    ds_read_b128 v[148:151], v1 offset:35840
    s_waitcnt lgkmcnt(7)
    v_mfma_f32_16x16x32_bf16 v[16:19], v[152:155], v[92:95], v[16:19]
    v_mfma_f32_16x16x32_bf16 v[24:27], v[152:155], v[32:35], v[24:27]
    s_waitcnt lgkmcnt(6)
    v_mfma_f32_16x16x32_bf16 v[24:27], v[156:159], v[128:131], v[24:27]
    s_waitcnt lgkmcnt(5)
    v_mfma_f32_16x16x32_bf16 v[20:23], v[160:163], v[92:95], v[20:23]
    v_mfma_f32_16x16x32_bf16 v[28:31], v[160:163], v[32:35], v[28:31]
    s_waitcnt lgkmcnt(4)
    v_mfma_f32_16x16x32_bf16 v[28:31], v[164:167], v[128:131], v[28:31]
    s_waitcnt lgkmcnt(3)
    v_mfma_f32_16x16x32_bf16 v[16:19], v[136:139], v[96:99], v[16:19]
    v_mfma_f32_16x16x32_bf16 v[24:27], v[136:139], v[32:35], v[24:27]
    s_waitcnt lgkmcnt(2)
    v_mfma_f32_16x16x32_bf16 v[24:27], v[140:143], v[132:135], v[24:27]
    s_waitcnt lgkmcnt(1)
    v_mfma_f32_16x16x32_bf16 v[20:23], v[144:147], v[96:99], v[20:23]
    v_mfma_f32_16x16x32_bf16 v[28:31], v[144:147], v[32:35], v[28:31]
    s_waitcnt lgkmcnt(0)
    v_mfma_f32_16x16x32_bf16 v[28:31], v[148:151], v[132:135], v[28:31]
    v_cvt_pk_bf16_f32 v36, v16, v17
    v_cvt_pk_bf16_f32 v37, v18, v19
    s_nop 2
    v_cvt_pk_bf16_f32 v38, v20, v21
    v_cvt_pk_bf16_f32 v39, v22, v23
    v_cvt_pk_bf16_f32 v40, v24, v25
    v_cvt_pk_bf16_f32 v41, v26, v27
    v_cvt_pk_bf16_f32 v42, v28, v29
    v_cvt_pk_bf16_f32 v43, v30, v31
    v_mfma_f32_16x16x32_bf16 v[64:67], v[44:47], v[36:39], 0
pad0_140:
    s_cbranch_execz ka2_kernel_done
    v_mfma_f32_16x16x32_bf16 v[68:71], v[52:55], v[36:39], 0
    v_mfma_f32_16x16x32_bf16 v[72:75], v[52:55], v[40:43], 0
    v_mfma_f32_16x16x32_bf16 v[76:79], v[44:47], v[40:43], 0
    v_mfma_f32_16x16x32_bf16 v[80:83], v[48:51], v[36:39], 0
    v_mfma_f32_16x16x32_bf16 v[84:87], v[56:59], v[36:39], 0
    v_mfma_f32_16x16x32_bf16 v[88:91], v[56:59], v[40:43], 0
    v_mfma_f32_16x16x32_bf16 v[92:95], v[48:51], v[40:43], 0
    v_cmp_lt_u32 vcc, 15, v14
    v_mov_b32 v10, 0x80000000
    s_nop 0
    v_cndmask_b32 v11, 0, v10, vcc
    v_sub_f32 v96, v64, v72
    v_add_f32 v97, v68, v76
    v_add_f32 v98, v64, v72
    v_sub_f32 v99, v68, v76
    v_cndmask_b32 v96, v96, v64, s[36:37]
    v_cndmask_b32 v97, v97, v68, s[36:37]
    v_cndmask_b32 v98, v98, v76, s[36:37]
    v_cndmask_b32 v99, v99, v72, s[36:37]
    v_cvt_pk_bf16_f32 v100, v96, v97
    v_cvt_pk_bf16_f32 v101, v98, v99
    buffer_store_dword v100, v2, s[20:23], s40 offen
    buffer_store_dword v101, v3, s[20:23], s40 offen
    v_sub_f32 v102, v65, v73
    v_add_f32 v103, v69, v77
    v_add_f32 v104, v65, v73
    v_sub_f32 v105, v69, v77
    v_cndmask_b32 v102, v102, v65, s[36:37]
    v_cndmask_b32 v103, v103, v69, s[36:37]
    v_cndmask_b32 v104, v104, v77, s[36:37]
    v_cndmask_b32 v105, v105, v73, s[36:37]
    v_cvt_pk_bf16_f32 v106, v102, v103
    v_cvt_pk_bf16_f32 v107, v104, v105
    buffer_store_dword v106, v2, s[20:23], s41 offen
    buffer_store_dword v107, v3, s[20:23], s41 offen
    v_sub_f32 v108, v66, v74
    v_add_f32 v109, v70, v78
    v_add_f32 v110, v66, v74
    v_sub_f32 v111, v70, v78
pad0_141:
    s_cbranch_execz ka2_kernel_done
    v_cndmask_b32 v108, v108, v66, s[36:37]
    v_cndmask_b32 v109, v109, v70, s[36:37]
    v_cndmask_b32 v110, v110, v78, s[36:37]
    v_cndmask_b32 v111, v111, v74, s[36:37]
    v_cvt_pk_bf16_f32 v112, v108, v109
    v_cvt_pk_bf16_f32 v113, v110, v111
    buffer_store_dword v112, v2, s[20:23], s42 offen
    buffer_store_dword v113, v3, s[20:23], s42 offen
    v_sub_f32 v114, v67, v75
    v_add_f32 v115, v71, v79
    v_add_f32 v116, v67, v75
    v_sub_f32 v117, v71, v79
    v_cndmask_b32 v114, v114, v67, s[36:37]
    v_cndmask_b32 v115, v115, v71, s[36:37]
    v_cndmask_b32 v116, v116, v79, s[36:37]
    v_cndmask_b32 v117, v117, v75, s[36:37]
    v_cvt_pk_bf16_f32 v118, v114, v115
    v_cvt_pk_bf16_f32 v119, v116, v117
    buffer_store_dword v118, v2, s[20:23], s43 offen
    buffer_store_dword v119, v3, s[20:23], s43 offen
    v_sub_f32 v96, v80, v88
    v_add_f32 v97, v84, v92
    v_add_f32 v98, v80, v88
    v_sub_f32 v99, v84, v92
    v_cndmask_b32 v96, v96, v80, s[36:37]
    v_cndmask_b32 v97, v97, v84, s[36:37]
    v_cndmask_b32 v98, v98, v92, s[36:37]
    v_cndmask_b32 v99, v99, v88, s[36:37]
    v_cvt_pk_bf16_f32 v100, v96, v97
    v_cvt_pk_bf16_f32 v101, v98, v99
    v_xor_b32 v100, v11, v100
    v_xor_b32 v101, v11, v101
    buffer_store_dword v100, v2, s[20:23], s44 offen
    buffer_store_dword v101, v3, s[20:23], s44 offen
    v_sub_f32 v102, v81, v89
    v_add_f32 v103, v85, v93
    v_add_f32 v104, v81, v89
    v_sub_f32 v105, v85, v93
    v_cndmask_b32 v102, v102, v81, s[36:37]
pad0_142:
    s_cbranch_execz ka2_kernel_done
    v_cndmask_b32 v103, v103, v85, s[36:37]
    v_cndmask_b32 v104, v104, v93, s[36:37]
    v_cndmask_b32 v105, v105, v89, s[36:37]
    v_cvt_pk_bf16_f32 v106, v102, v103
    v_cvt_pk_bf16_f32 v107, v104, v105
    v_xor_b32 v106, v10, v106
    v_xor_b32 v107, v10, v107
    buffer_store_dword v106, v2, s[20:23], s45 offen
    buffer_store_dword v107, v3, s[20:23], s45 offen
    v_sub_f32 v108, v82, v90
    v_add_f32 v109, v86, v94
    v_add_f32 v110, v82, v90
    v_sub_f32 v111, v86, v94
    v_cndmask_b32 v108, v108, v82, s[36:37]
    v_cndmask_b32 v109, v109, v86, s[36:37]
    v_cndmask_b32 v110, v110, v94, s[36:37]
    v_cndmask_b32 v111, v111, v90, s[36:37]
    v_cvt_pk_bf16_f32 v112, v108, v109
    v_cvt_pk_bf16_f32 v113, v110, v111
    v_xor_b32 v112, v10, v112
    v_xor_b32 v113, v10, v113
    buffer_store_dword v112, v2, s[20:23], s46 offen
    buffer_store_dword v113, v3, s[20:23], s46 offen
    v_sub_f32 v114, v83, v91
    v_add_f32 v115, v87, v95
    v_add_f32 v116, v83, v91
    v_sub_f32 v117, v87, v95
    v_cndmask_b32 v114, v114, v83, s[36:37]
    v_cndmask_b32 v115, v115, v87, s[36:37]
    v_cndmask_b32 v116, v116, v95, s[36:37]
    v_cndmask_b32 v117, v117, v91, s[36:37]
    v_cvt_pk_bf16_f32 v118, v114, v115
    v_cvt_pk_bf16_f32 v119, v116, v117
    v_xor_b32 v118, v10, v118
    v_xor_b32 v119, v10, v119
    buffer_store_dword v118, v2, s[20:23], s47 offen
    buffer_store_dword v119, v3, s[20:23], s47 offen
ka2_kernel_fin:
ka2_kernel_done:
    s_endpgm
.section .rodata,"a"
.p2align 6
.amdhsa_kernel ka2_kernel
  .amdhsa_next_free_vgpr 256
  .amdhsa_next_free_sgpr 96
  .amdhsa_accum_offset 168
  .amdhsa_group_segment_fixed_size 0
  .amdhsa_kernarg_size 88
  .amdhsa_user_sgpr_count 2
  .amdhsa_user_sgpr_kernarg_segment_ptr 1
  .amdhsa_system_sgpr_workgroup_id_x 1
  .amdhsa_float_denorm_mode_32 3
  .amdhsa_float_denorm_mode_16_64 3
.end_amdhsa_kernel
.text
.globl k7_kernel
.p2align 8
.type k7_kernel,@function
k7_kernel:
pad0_143:
    s_cbranch_execz k7_kernel_done
    s_cmp_ge_u32 s2, 256
    s_cbranch_scc1 k7_kernel_done
    s_load_dwordx2 s[4:5], s[0:1], 80
    s_load_dwordx2 s[6:7], s[0:1], 64
    v_lshrrev_b32 v2, 6, v0
    v_and_b32 v14, 63, v0
    v_readfirstlane_b32 s8, v2
    v_lshlrev_b32 v1, 4, v14
    v_and_b32 v12, 15, v14
    v_lshrrev_b32 v13, 4, v14
    s_lshr_b32 s9, s2, 3
    s_bfe_u32 s10, s2, 0x20001
    s_and_b32 s11, s2, 1
    s_mul_i32 s32, s11, 9
    s_add_u32 s32, s32, s8
    s_mul_i32 s33, s9, 73728
    s_lshl_b32 s34, s32, 12
    s_add_u32 s33, s33, s34
    s_lshl_b32 s34, s10, 10
    s_add_u32 s33, s33, s34
    v_add_u32 v2, s33, v1
    s_mov_b32 s40, 0
    s_mov_b32 s41, 2359296
    s_mov_b32 s42, 4718592
    s_mov_b32 s43, 7077888
    s_mov_b32 s44, 9437184
    s_mov_b32 s45, 11796480
    s_mov_b32 s46, 14155776
    s_mov_b32 s47, 16515072
    s_waitcnt lgkmcnt(0)
    s_add_u32 s12, s4, 0x1400000
    s_addc_u32 s13, s5, 0
    s_and_b32 s13, s13, 0xffff
    s_mov_b32 s14, 0x1200000
    s_mov_b32 s15, 0x20000
    buffer_load_dwordx4 v[16:19], v2, s[12:15], s40 offen
    buffer_load_dwordx4 v[20:23], v2, s[12:15], s41 offen
    buffer_load_dwordx4 v[24:27], v2, s[12:15], s42 offen
    buffer_load_dwordx4 v[28:31], v2, s[12:15], s43 offen
    buffer_load_dwordx4 v[32:35], v2, s[12:15], s44 offen
    buffer_load_dwordx4 v[36:39], v2, s[12:15], s45 offen
pad0_144:
    s_cbranch_execz k7_kernel_done
    buffer_load_dwordx4 v[40:43], v2, s[12:15], s46 offen
    buffer_load_dwordx4 v[44:47], v2, s[12:15], s47 offen
    s_add_u32 s16, s6, 0x0
    s_addc_u32 s17, s7, 0
    s_and_b32 s17, s17, 0xffff
    s_mov_b32 s18, 0x240000
    s_mov_b32 s19, 0x20000
    s_and_b32 s33, s10, 1
    s_lshl_b32 s33, s33, 10
    s_add_u32 s33, s33, s9
    s_and_b32 s34, s10, 2
    s_lshl_b32 s34, s34, 4
    s_add_u32 s33, s33, s34
    v_lshl_add_u32 v3, v12, 6, s33
    v_mul_u32_u24 v3, 1152, v3
    s_lshl_b32 s33, s8, 6
    v_lshl_add_u32 v4, v13, 4, s33
    s_waitcnt vmcnt(7)
    v_lshlrev_b32 v48, 16, v16
    v_and_b32 v49, 0xffff0000, v16
    v_lshlrev_b32 v50, 16, v17
    v_and_b32 v51, 0xffff0000, v17
    v_lshlrev_b32 v52, 16, v18
    v_and_b32 v53, 0xffff0000, v18
    v_lshlrev_b32 v54, 16, v19
    v_and_b32 v55, 0xffff0000, v19
    s_waitcnt vmcnt(6)
    v_lshlrev_b32 v56, 16, v20
    v_and_b32 v57, 0xffff0000, v20
    v_pk_add_f32 v[48:49], v[48:49], v[56:57]
    v_lshlrev_b32 v58, 16, v21
    v_and_b32 v59, 0xffff0000, v21
    v_pk_add_f32 v[50:51], v[50:51], v[58:59]
    v_lshlrev_b32 v60, 16, v22
    v_and_b32 v61, 0xffff0000, v22
    v_pk_add_f32 v[52:53], v[52:53], v[60:61]
    v_lshlrev_b32 v62, 16, v23
    v_and_b32 v63, 0xffff0000, v23
    v_pk_add_f32 v[54:55], v[54:55], v[62:63]
    s_waitcnt vmcnt(5)
    v_lshlrev_b32 v56, 16, v24
    v_and_b32 v57, 0xffff0000, v24
pad0_145:
    s_cbranch_execz k7_kernel_done
    v_pk_add_f32 v[48:49], v[48:49], v[56:57]
    v_lshlrev_b32 v58, 16, v25
    v_and_b32 v59, 0xffff0000, v25
    v_pk_add_f32 v[50:51], v[50:51], v[58:59]
    v_lshlrev_b32 v60, 16, v26
    v_and_b32 v61, 0xffff0000, v26
    v_pk_add_f32 v[52:53], v[52:53], v[60:61]
    v_lshlrev_b32 v62, 16, v27
    v_and_b32 v63, 0xffff0000, v27
    v_pk_add_f32 v[54:55], v[54:55], v[62:63]
    s_waitcnt vmcnt(4)
    v_lshlrev_b32 v56, 16, v28
    v_and_b32 v57, 0xffff0000, v28
    v_pk_add_f32 v[48:49], v[48:49], v[56:57]
    v_lshlrev_b32 v58, 16, v29
    v_and_b32 v59, 0xffff0000, v29
    v_pk_add_f32 v[50:51], v[50:51], v[58:59]
    v_lshlrev_b32 v60, 16, v30
    v_and_b32 v61, 0xffff0000, v30
    v_pk_add_f32 v[52:53], v[52:53], v[60:61]
    v_lshlrev_b32 v62, 16, v31
    v_and_b32 v63, 0xffff0000, v31
    v_pk_add_f32 v[54:55], v[54:55], v[62:63]
    s_waitcnt vmcnt(3)
    v_lshlrev_b32 v56, 16, v32
    v_and_b32 v57, 0xffff0000, v32
    v_pk_add_f32 v[48:49], v[48:49], v[56:57]
    v_lshlrev_b32 v58, 16, v33
    v_and_b32 v59, 0xffff0000, v33
    v_pk_add_f32 v[50:51], v[50:51], v[58:59]
    v_lshlrev_b32 v60, 16, v34
    v_and_b32 v61, 0xffff0000, v34
    v_pk_add_f32 v[52:53], v[52:53], v[60:61]
    v_lshlrev_b32 v62, 16, v35
    v_and_b32 v63, 0xffff0000, v35
    v_pk_add_f32 v[54:55], v[54:55], v[62:63]
    s_waitcnt vmcnt(2)
    v_lshlrev_b32 v56, 16, v36
    v_and_b32 v57, 0xffff0000, v36
pad0_146:
    s_cbranch_execz k7_kernel_done
    v_pk_add_f32 v[48:49], v[48:49], v[56:57]
    v_lshlrev_b32 v58, 16, v37
    v_and_b32 v59, 0xffff0000, v37
    v_pk_add_f32 v[50:51], v[50:51], v[58:59]
    v_lshlrev_b32 v60, 16, v38
    v_and_b32 v61, 0xffff0000, v38
    v_pk_add_f32 v[52:53], v[52:53], v[60:61]
    v_lshlrev_b32 v62, 16, v39
    v_and_b32 v63, 0xffff0000, v39
    v_pk_add_f32 v[54:55], v[54:55], v[62:63]
    s_waitcnt vmcnt(1)
    v_lshlrev_b32 v56, 16, v40
    v_and_b32 v57, 0xffff0000, v40
    v_pk_add_f32 v[48:49], v[48:49], v[56:57]
    v_lshlrev_b32 v58, 16, v41
    v_and_b32 v59, 0xffff0000, v41
    v_pk_add_f32 v[50:51], v[50:51], v[58:59]
    v_lshlrev_b32 v60, 16, v42
    v_and_b32 v61, 0xffff0000, v42
    v_pk_add_f32 v[52:53], v[52:53], v[60:61]
    v_lshlrev_b32 v62, 16, v43
    v_and_b32 v63, 0xffff0000, v43
    v_pk_add_f32 v[54:55], v[54:55], v[62:63]
    s_waitcnt vmcnt(0)
    v_lshlrev_b32 v56, 16, v44
    v_and_b32 v57, 0xffff0000, v44
    v_pk_add_f32 v[48:49], v[48:49], v[56:57]
    v_lshlrev_b32 v58, 16, v45
    v_and_b32 v59, 0xffff0000, v45
    v_pk_add_f32 v[50:51], v[50:51], v[58:59]
    v_lshlrev_b32 v60, 16, v46
    v_and_b32 v61, 0xffff0000, v46
    v_pk_add_f32 v[52:53], v[52:53], v[60:61]
    v_lshlrev_b32 v62, 16, v47
    v_and_b32 v63, 0xffff0000, v47
    v_pk_add_f32 v[54:55], v[54:55], v[62:63]
    s_cmp_eq_u32 s11, 1
    s_cbranch_scc1 k7_kernel_up1
    v_cvt_pk_bf16_f32 v16, v48, v49
pad0_147:
    s_cbranch_execz k7_kernel_done
    v_cvt_pk_bf16_f32 v17, v50, v51
    v_cvt_pk_bf16_f32 v18, v52, v53
    v_cvt_pk_bf16_f32 v19, v54, v55
    v_add_u32 v3, v3, v4
    buffer_store_dwordx4 v[16:19], v3, s[16:19], 0 offen
    s_endpgm
k7_kernel_up1:
    s_nop 0
    v_cvt_pk_bf16_f32 v16, v54, v53
    v_cvt_pk_bf16_f32 v17, v52, v51
    v_cvt_pk_bf16_f32 v18, v50, v49
    v_cvt_pk_bf16_f32 v19, v55, v48
    v_cmp_eq_u32 vcc, 0, v4
    v_sub_u32 v5, v3, v4
    v_add_u32 v5, 1138, v5
    v_add_u32 v6, 14, v5
    v_add_u32 v7, 576, v3
    v_cndmask_b32 v6, v6, v7, vcc
    buffer_store_dwordx3 v[16:18], v5, s[16:19], 0 offen offset:2
    buffer_store_short v19, v5, s[16:19], 0 offen
    buffer_store_short_d16_hi v19, v6, s[16:19], 0 offen
k7_kernel_fin:
k7_kernel_done:
    s_endpgm
.section .rodata,"a"
.p2align 6
.amdhsa_kernel k7_kernel
  .amdhsa_next_free_vgpr 64
  .amdhsa_next_free_sgpr 96
  .amdhsa_accum_offset 64
  .amdhsa_group_segment_fixed_size 0
  .amdhsa_kernarg_size 88
  .amdhsa_user_sgpr_count 2
  .amdhsa_user_sgpr_kernarg_segment_ptr 1
  .amdhsa_system_sgpr_workgroup_id_x 1
  .amdhsa_float_denorm_mode_32 3
  .amdhsa_float_denorm_mode_16_64 3
.end_amdhsa_kernel
```
